```python
import torch

def _softmax(x, axis=-1):
    return torch.softmax(x, dim=axis)

def _gelu(x):
    return torch.nn.functional.gelu(x, approximate='tanh')

def _silu(x):
    return torch.nn.functional.silu(x)

def _sigmoid(x):
    return torch.sigmoid(x)

def _layernorm(x, axis=-1, eps=1e-05):
    m = x.mean(dim=axis, keepdim=True)
    v = x.var(dim=axis, keepdim=True, unbiased=False)
    return (x - m) / torch.sqrt(v + eps)

def _scatter_add(tgt, idx, src, axis=0):
    return tgt.clone().index_add_(axis, idx, src)

def _segment_sum(src, seg, n):
    out = torch.zeros((n,) + src.shape[1:], dtype=src.dtype)
    return out.index_add_(0, seg, src)

def _pad(x, pw):
    flat = tuple((v for pair in reversed(pw) for v in pair))
    return torch.nn.functional.pad(x, flat)
kernel_name = 'gated_mix__sliding_local_dilated__mixer_gmlp__prompt'

def setup_inputs():

    _w = lambda a: (lambda t: t.to(torch.bfloat16) if t.is_floating_point() else t)(torch.as_tensor(a))

    def _A_setup():
        B, S, D = (1, 2048, 448)
        return {'x': _w((lambda *s: torch.randn(*s, dtype=torch.bfloat16) * 0.05)(B, S, D)), 'wqkv': _w((lambda *s: torch.randn(*s, dtype=torch.bfloat16) * 1.6)(D, 3 * D)), 'wo': _w((lambda *s: torch.randn(*s, dtype=torch.bfloat16) * 0.05)(D, D))}
    _A_in = _A_setup()

    def _B_setup():
        B, S, D, F = (1, 2048, 448, 1792)
        Fh = F // 2
        return {'x': _w((lambda *s: torch.randn(*s, dtype=torch.bfloat16) * 0.05)(B, S, D)), 'w_in': _w((lambda *s: torch.randn(*s, dtype=torch.bfloat16) * 0.4)(D, 2 * Fh)), 'w_sp': _w(0.01 * (lambda *s: torch.randn(*s, dtype=torch.bfloat16) * 0.4)(S, S)), 'b_sp': _w(1.0 + 0.01 * (lambda *s: torch.randn(*s, dtype=torch.bfloat16) * 0.2)(S)), 'w_out': _w((lambda *s: torch.randn(*s, dtype=torch.bfloat16) * 0.2)(Fh, D))}
    _B_in = _B_setup()
    return {'A_x': _A_in['x'], 'A_wqkv': _A_in['wqkv'], 'A_wo': _A_in['wo'], 'B_x': _B_in['x'], 'B_w_in': _B_in['w_in'], 'B_w_sp': _B_in['w_sp'], 'B_b_sp': _B_in['b_sp'], 'B_w_out': _B_in['w_out'], 'gate_w': _w((lambda *s: torch.randn(*s, dtype=torch.bfloat16) * 0.05)(448) * 16.0)}

def reference(A_x, A_wqkv, A_wo, B_x, B_w_in, B_w_sp, B_b_sp, B_w_out, gate_w):

    def _A_ref(x, wqkv, wo):
        B, S, D = x.shape
        H = 16
        Dh = D // H
        W, dil = (8, 2)
        qkv = (lambda x, *d: x.permute(*d))((x @ wqkv).reshape(B, S, 3, H, Dh), 2, 0, 3, 1, 4)
        q, k, v = (qkv[0], qkv[1], qkv[2])
        scale = Dh ** (-0.5)
        pos = torch.arange(S)
        off = torch.arange(W) * dil
        idx = pos[:, None] - off[None, :]
        mask = idx >= 0
        idx_c = torch.where(mask, idx, 0).reshape(-1)
        kg = k[:, :, idx_c, :].reshape(B, H, S, W, Dh)
        vg = v[:, :, idx_c, :].reshape(B, H, S, W, Dh)
        logits = torch.einsum('bhsd,bhswd->bhsw', q, kg) * scale
        logits = torch.where(mask[None, None, :, :], logits, -1000000000.0)
        attn = _softmax(logits, axis=-1)
        o = torch.einsum('bhsw,bhswd->bhsd', attn, vg)
        return (lambda x, *d: x.permute(*d))(o, 0, 2, 1, 3).reshape(B, S, D) @ wo

    def _B_ref(x, w_in, w_sp, b_sp, w_out):
        B, S, D = x.shape
        F = w_in.shape[-1]
        Fh = F // 2
        z = _gelu(torch.einsum('bsd,df->bsf', x, w_in))
        z1 = z[..., :Fh].clone()
        z2 = _layernorm(z[..., Fh:], axis=-1)
        g = torch.einsum('ts,bsf->btf', w_sp, z2) + b_sp[None, :, None]
        return torch.einsum('bsf,fd->bsd', z1 * g, w_out)
    x = A_x
    g = _sigmoid((x * gate_w).sum(-1, keepdims=True))
    a = _A_ref(x, A_wqkv, A_wo)
    b = _B_ref(x, B_w_in, B_w_sp, B_b_sp, B_w_out)
    return g * a + (1 - g) * b
```

```asm
; @launch grid=(256,1,1) block=(256,1,1) lds=163840
.amdgcn_target "amdgcn-amd-amdhsa--gfx950"
.text
.globl gated_mix__sliding_local_dilated__mixer_gmlp__prompt_kernel
.p2align 8
.type gated_mix__sliding_local_dilated__mixer_gmlp__prompt_kernel,@function
gated_mix__sliding_local_dilated__mixer_gmlp__prompt_kernel:
  s_cmp_ge_u32 s2, 256
  s_cbranch_scc1 mega_end
  s_load_dwordx16 s[36:51], s[0:1], 0
  s_load_dwordx8 s[52:59], s[0:1], 64
  v_lshrrev_b32 v6, 6, v0
  s_getreg_b32 s20, hwreg(HW_REG_XCC_ID)
  v_readfirstlane_b32 s3, v6
  s_nop 0
  s_cmp_lg_u32 s3, 1
  s_cbranch_scc1 mega_noecp
  s_getpc_b64 s[22:23]
mega_pc0:
  v_and_b32 v10, 31, v0
  v_lshlrev_b32 v10, 7, v10
  v_bfe_u32 v11, v0, 5, 1
  v_mul_u32_u24 v11, mega_qrole-mega_pc0, v11
  v_add_u32 v10, v10, v11
  global_load_dword v56, v10, s[22:23]
mega_noecp:
  v_and_b32 v12, 63, v0
  s_and_b32 s20, s20, 7
  v_and_b32 v13, 15, v12
  v_lshrrev_b32 v14, 4, v12
  v_mov_b32 v18, 163584
  v_mov_b32 v17, 0
  s_waitcnt lgkmcnt(0)
  s_cmp_lg_u32 s3, 0
  s_cbranch_scc1 mega_notick
  s_lshl_b32 s30, s20, 5
  v_mov_b32 v10, s30
  v_mov_b32 v19, 1
  s_mov_b64 s[34:35], exec
  s_mov_b64 exec, 1
  global_atomic_add v59, v10, v19, s[56:57] sc0 sc1
  s_mov_b64 exec, s[34:35]
mega_notick:
  s_lshl_b32 s24, s2, 2
  s_add_u32 s24, s24, s3
  s_mul_i32 s25, s24, 1792
  v_min_u32 v57, 13, v12
  v_lshlrev_b32 v57, 7, v57
  v_add_u32 v58, s25, v57
  global_load_dword v56, v58, s[36:37]
  s_cmp_lt_u32 s24, 448
  s_cselect_b32 s28, s44, s38
  s_cselect_b32 s29, s45, s39
  s_cselect_b32 s26, 27, 20
  s_cselect_b32 s27, 4, 3
  s_cselect_b32 s25, 0, 448
  s_mul_i32 s27, s27, 896
  s_sub_u32 s25, s24, s25
  s_min_u32 s25, s25, 447
  s_mul_i32 s25, s25, s27
  v_min_u32 v57, s26, v12
  v_lshlrev_b32 v57, 7, v57
  v_add_u32 v58, s25, v57
  global_load_dword v56, v58, s[28:29]
  s_cmp_lg_u32 s3, 0
  s_cbranch_scc1 mega_tickd
  s_waitcnt vmcnt(2)
  v_readfirstlane_b32 s30, v59
  s_nop 1
  v_mov_b32 v59, s30
  ds_write_b32 v18, v59
  s_waitcnt lgkmcnt(0)
mega_tickd:
  s_barrier
  ds_read_b32 v19, v18
  s_cmp_lg_u32 s3, 0
  s_cbranch_scc1 mega_notag
  s_cmp_lg_u32 s2, 0
  s_cbranch_scc1 mega_notag
  s_memrealtime s[30:31]
  s_waitcnt lgkmcnt(0)
  s_or_b32 s30, s30, 1
  v_mov_b32 v60, s30
  v_mov_b32 v61, s31
  v_mov_b32 v62, 16
  s_mov_b64 s[34:35], exec
  s_mov_b64 exec, 1
  global_store_dwordx2 v62, v[60:61], s[56:57] sc1
  s_mov_b64 exec, s[34:35]
mega_notag:
  s_waitcnt lgkmcnt(0)
  v_readfirstlane_b32 s21, v19
  s_nop 0
  s_cmp_ge_u32 s21, 32
  s_cbranch_scc1 mega_end
  s_lshl_b32 s24, s21, 2
  s_add_u32 s24, s24, s3
  s_getpc_b64 s[22:23]
mega_pc:
  v_and_b32 v10, 3, v0
  s_lshl_b32 s25, s24, 2
  v_add_u32 v10, s25, v10
  v_lshlrev_b32 v10, 7, v10
  v_min_u32 v10, mega_end-mega_pc, v10
  global_load_dword v56, v10, s[22:23]
  s_lshl_b32 s2, s21, 3
  s_or_b32 s2, s2, s20
  s_lshr_b32 s33, s21, 4
  s_and_b32 s21, s21, 15
  s_lshr_b32 s22, s20, 1
  s_lshl_b32 s22, s22, 2
  s_lshr_b32 s23, s21, 2
  s_add_u32 s22, s22, s23
  s_and_b32 s20, s20, 1
  s_lshl_b32 s20, s20, 2
  s_and_b32 s21, s21, 3
  s_add_u32 s21, s21, s20
  s_mov_b32 s20, s22
  s_lshl_b32 s22, s20, 1
  s_add_u32 s22, s22, s33
  s_cmp_eq_u32 s33, 0
  s_cbranch_scc0 mega_qrole
  v_lshrrev_b32 v15, 3, v12
  v_and_b32 v16, 7, v12
  v_and_b32 v17, 3, v15
  v_xor_b32 v16, v16, v17
  v_lshlrev_b32 v16, 4, v16
  v_mul_u32_u24 v17, 896, v15
  v_add_u32 v1, v16, v17
  v_xor_b32 v18, 64, v16
  v_add_u32 v2, v18, v17
  v_add_u32 v2, 6144, v2
  v_add_u32 v3, v16, v17
  v_add_u32 v3, 12288, v3
  v_xor_b32 v18, 64, v16
  v_add_u32 v4, v18, v17
  v_add_u32 v4, 18432, v4
  v_lshrrev_b32 v15, 1, v13
  v_xor_b32 v15, v15, v14
  v_and_b32 v16, 1, v13
  v_lshlrev_b32 v16, 4, v16
  v_mul_u32_u24 v17, 3584, v14
  v_add_u32 v16, v16, v17
  v_mov_b32 v18, 2147418112
  v_lshl_add_u32 v5, v15, 5, v16
  v_cmp_eq_u32 vcc, 7, v15
  s_nop 1
  v_cndmask_b32 v5, v5, v18, vcc
  v_lshl_add_u32 v6, v15, 5, v16
  v_add_u32 v6, 13312, v6
  v_cmp_eq_u32 vcc, 7, v15
  s_nop 1
  v_cndmask_b32 v6, v6, v18, vcc
  v_xor_b32 v15, 4, v15
  v_lshl_add_u32 v7, v15, 5, v16
  v_add_u32 v7, 26624, v7
  v_cmp_eq_u32 vcc, 7, v15
  s_nop 1
  v_cndmask_b32 v7, v7, v18, vcc
  v_lshl_add_u32 v8, v15, 5, v16
  v_add_u32 v8, 39936, v8
  v_cmp_eq_u32 vcc, 7, v15
  s_nop 1
  v_cndmask_b32 v8, v8, v18, vcc
  s_lshl_b32 s72, s20, 2
  s_add_u32 s72, s72, s3
  s_mul_i32 s23, s72, 28672
  s_add_u32 s8, s36, s23
  s_addc_u32 s9, s37, 0
  s_and_b32 s9, s9, 0xffff
  s_mov_b32 s10, 28672
  s_mov_b32 s11, 0x20000
  s_mov_b32 s12, s44
  s_and_b32 s13, s45, 0xffff
  s_mov_b32 s14, 1605632
  s_mov_b32 s15, 0x20000
  s_mul_i32 s25, s3, 57344
  s_mul_i32 s23, s21, 224
  s_add_u32 s25, s25, s23
  s_add_u32 s24, s25, 1792
  s_lshl_b32 s71, s3, 12
  s_add_u32 m0, s71, 114688
  s_add_u32 s23, s24, 0
  buffer_load_dwordx4 v5, s[12:15], s23 offen offset:0 lds
  buffer_load_dwordx4 v6, s[12:15], s23 offen offset:1024 lds
  buffer_load_dwordx4 v7, s[12:15], s23 offen offset:2048 lds
  buffer_load_dwordx4 v8, s[12:15], s23 offen offset:3072 lds
  s_add_u32 m0, s71, 0
  s_mov_b32 s23, 0
  buffer_load_dwordx4 v1, s[8:11], s23 offen offset:0 lds
  buffer_load_dwordx4 v2, s[8:11], s23 offen offset:1024 lds
  buffer_load_dwordx4 v3, s[8:11], s23 offen offset:2048 lds
  buffer_load_dwordx4 v4, s[8:11], s23 offen offset:3072 lds
  s_add_u32 m0, s71, 131072
  s_add_u32 s23, s24, 229376
  buffer_load_dwordx4 v5, s[12:15], s23 offen offset:0 lds
  buffer_load_dwordx4 v6, s[12:15], s23 offen offset:1024 lds
  buffer_load_dwordx4 v7, s[12:15], s23 offen offset:2048 lds
  buffer_load_dwordx4 v8, s[12:15], s23 offen offset:3072 lds
  s_add_u32 m0, s71, 16384
  s_mov_b32 s23, 128
  buffer_load_dwordx4 v1, s[8:11], s23 offen offset:0 lds
  buffer_load_dwordx4 v2, s[8:11], s23 offen offset:1024 lds
  buffer_load_dwordx4 v3, s[8:11], s23 offen offset:2048 lds
  buffer_load_dwordx4 v4, s[8:11], s23 offen offset:3072 lds
  v_lshrrev_b32 v15, 2, v13
  v_lshlrev_b32 v15, 3, v15
  v_and_b32 v16, 3, v13
  v_add_u32 v15, v15, v16
  v_and_b32 v16, 7, v13
  v_xor_b32 v16, v16, v14
  v_lshlrev_b32 v16, 4, v16
  v_lshl_add_u32 v16, v15, 7, v16
  v_add_u32 v20, s71, v16
  v_xor_b32 v21, 64, v20
  v_add_u32 v22, 0x10000, v20
  v_add_u32 v23, 0x10000, v21
  v_lshrrev_b32 v15, 2, v13
  v_lshl_add_u32 v16, v14, 3, v15
  v_lshlrev_b32 v16, 8, v16
  v_and_b32 v17, 3, v13
  v_lshl_add_u32 v16, v17, 3, v16
  v_add_u32 v16, 114688, v16
  v_and_b32 v17, 1, v14
  v_lshl_or_b32 v17, v17, 2, v15
  v_xor_b32 v18, 0, v17
  v_lshl_add_u32 v24, v18, 5, v16
  v_xor_b32 v18, 1, v17
  v_lshl_add_u32 v25, v18, 5, v16
  v_xor_b32 v18, 2, v17
  v_lshl_add_u32 v26, v18, 5, v16
  v_xor_b32 v18, 3, v17
  v_lshl_add_u32 v27, v18, 5, v16
  v_xor_b32 v18, 4, v17
  v_lshl_add_u32 v28, v18, 5, v16
  v_xor_b32 v18, 5, v17
  v_lshl_add_u32 v29, v18, 5, v16
  v_xor_b32 v18, 6, v17
  v_lshl_add_u32 v30, v18, 5, v16
  v_mov_b32 v32, 0xc0135761
  v_mov_b32 v33, 0xc0135761
  v_mov_b32 v34, 0xbdd2d3e8
  v_mov_b32 v35, 0xbdd2d3e8
  v_mov_b32 v36, 0x3f800000
  v_mov_b32 v37, 0x3f800000
  s_waitcnt vmcnt(8)
  s_barrier
  ds_read_b128 a[144:147], v20 offset:0
  ds_read_b128 a[148:151], v20 offset:512
  ds_read_b128 a[152:155], v21 offset:0
  ds_read_b128 a[156:159], v21 offset:512
  ds_read_b64_tr_b16 v[176:177], v24 offset:0
  ds_read_b64_tr_b16 v[178:179], v24 offset:1024
  ds_read_b64_tr_b16 v[180:181], v25 offset:0
  ds_read_b64_tr_b16 v[182:183], v25 offset:1024
  ds_read_b64_tr_b16 v[184:185], v26 offset:0
  ds_read_b64_tr_b16 v[186:187], v26 offset:1024
  ds_read_b64_tr_b16 v[188:189], v27 offset:0
  ds_read_b64_tr_b16 v[190:191], v27 offset:1024
  ds_read_b64_tr_b16 v[192:193], v28 offset:0
  ds_read_b64_tr_b16 v[194:195], v28 offset:1024
  ds_read_b64_tr_b16 v[196:197], v29 offset:0
  ds_read_b64_tr_b16 v[198:199], v29 offset:1024
  ds_read_b64_tr_b16 v[200:201], v30 offset:0
  ds_read_b64_tr_b16 v[202:203], v30 offset:1024
  s_waitcnt lgkmcnt(0)
  v_mfma_f32_16x16x32_bf16 v[120:123], a[144:147], v[176:179], 0
  ds_read_b64_tr_b16 v[204:205], v24 offset:8192
  ds_read_b64_tr_b16 v[206:207], v24 offset:9216
  s_add_u32 m0, s71, 147456
  v_mfma_f32_16x16x32_bf16 v[124:127], a[148:151], v[176:179], 0
  ds_read_b64_tr_b16 v[208:209], v25 offset:8192
  ds_read_b64_tr_b16 v[210:211], v25 offset:9216
  s_add_u32 s23, s24, 458752
  v_mfma_f32_16x16x32_bf16 v[128:131], a[144:147], v[180:183], 0
  ds_read_b64_tr_b16 v[212:213], v26 offset:8192
  ds_read_b64_tr_b16 v[214:215], v26 offset:9216
  buffer_load_dwordx4 v5, s[12:15], s23 offen offset:0 lds
  v_mfma_f32_16x16x32_bf16 v[132:135], a[148:151], v[180:183], 0
  ds_read_b64_tr_b16 v[216:217], v27 offset:8192
  ds_read_b64_tr_b16 v[218:219], v27 offset:9216
  buffer_load_dwordx4 v6, s[12:15], s23 offen offset:1024 lds
  v_mfma_f32_16x16x32_bf16 v[136:139], a[144:147], v[184:187], 0
  ds_read_b64_tr_b16 v[220:221], v28 offset:8192
  ds_read_b64_tr_b16 v[222:223], v28 offset:9216
  buffer_load_dwordx4 v7, s[12:15], s23 offen offset:2048 lds
  v_mfma_f32_16x16x32_bf16 v[140:143], a[148:151], v[184:187], 0
  ds_read_b64_tr_b16 v[224:225], v29 offset:8192
  ds_read_b64_tr_b16 v[226:227], v29 offset:9216
  buffer_load_dwordx4 v8, s[12:15], s23 offen offset:3072 lds
  v_mfma_f32_16x16x32_bf16 v[144:147], a[144:147], v[188:191], 0
  ds_read_b64_tr_b16 v[228:229], v30 offset:8192
  ds_read_b64_tr_b16 v[230:231], v30 offset:9216
  s_add_u32 m0, s71, 32768
  v_mfma_f32_16x16x32_bf16 v[148:151], a[148:151], v[188:191], 0
  s_mov_b32 s23, 256
  v_mfma_f32_16x16x32_bf16 v[152:155], a[144:147], v[192:195], 0
  buffer_load_dwordx4 v1, s[8:11], s23 offen offset:0 lds
  v_mfma_f32_16x16x32_bf16 v[156:159], a[148:151], v[192:195], 0
  buffer_load_dwordx4 v2, s[8:11], s23 offen offset:1024 lds
  v_mfma_f32_16x16x32_bf16 v[160:163], a[144:147], v[196:199], 0
  buffer_load_dwordx4 v3, s[8:11], s23 offen offset:2048 lds
  v_mfma_f32_16x16x32_bf16 v[164:167], a[148:151], v[196:199], 0
  buffer_load_dwordx4 v4, s[8:11], s23 offen offset:3072 lds
  v_mfma_f32_16x16x32_bf16 v[168:171], a[144:147], v[200:203], 0
  v_mfma_f32_16x16x32_bf16 v[172:175], a[148:151], v[200:203], 0
  s_waitcnt vmcnt(8)
  s_waitcnt lgkmcnt(0)
  s_barrier
  v_mfma_f32_16x16x32_bf16 v[120:123], a[152:155], v[204:207], v[120:123]
  ds_read_b64_tr_b16 v[176:177], v24 offset:16384
  ds_read_b64_tr_b16 v[178:179], v24 offset:17408
  s_add_u32 m0, s71, 114688
  v_mfma_f32_16x16x32_bf16 v[124:127], a[156:159], v[204:207], v[124:127]
  ds_read_b128 a[160:163], v20 offset:16384
  ds_read_b128 a[164:167], v20 offset:16896
  s_add_u32 s23, s24, 688128
  v_mfma_f32_16x16x32_bf16 v[128:131], a[152:155], v[208:211], v[128:131]
  ds_read_b128 a[168:171], v21 offset:16384
  ds_read_b128 a[172:175], v21 offset:16896
  buffer_load_dwordx4 v5, s[12:15], s23 offen offset:0 lds
  v_mfma_f32_16x16x32_bf16 v[132:135], a[156:159], v[208:211], v[132:135]
  ds_read_b64_tr_b16 v[180:181], v25 offset:16384
  ds_read_b64_tr_b16 v[182:183], v25 offset:17408
  buffer_load_dwordx4 v6, s[12:15], s23 offen offset:1024 lds
  v_mfma_f32_16x16x32_bf16 v[136:139], a[152:155], v[212:215], v[136:139]
  ds_read_b64_tr_b16 v[184:185], v26 offset:16384
  ds_read_b64_tr_b16 v[186:187], v26 offset:17408
  buffer_load_dwordx4 v7, s[12:15], s23 offen offset:2048 lds
  v_mfma_f32_16x16x32_bf16 v[140:143], a[156:159], v[212:215], v[140:143]
  ds_read_b64_tr_b16 v[188:189], v27 offset:16384
  ds_read_b64_tr_b16 v[190:191], v27 offset:17408
  buffer_load_dwordx4 v8, s[12:15], s23 offen offset:3072 lds
  v_mfma_f32_16x16x32_bf16 v[144:147], a[152:155], v[216:219], v[144:147]
  ds_read_b64_tr_b16 v[192:193], v28 offset:16384
  ds_read_b64_tr_b16 v[194:195], v28 offset:17408
  v_mfma_f32_16x16x32_bf16 v[148:151], a[156:159], v[216:219], v[148:151]
  ds_read_b64_tr_b16 v[196:197], v29 offset:16384
  ds_read_b64_tr_b16 v[198:199], v29 offset:17408
  v_mfma_f32_16x16x32_bf16 v[152:155], a[152:155], v[220:223], v[152:155]
  ds_read_b64_tr_b16 v[200:201], v30 offset:16384
  ds_read_b64_tr_b16 v[202:203], v30 offset:17408
  v_mfma_f32_16x16x32_bf16 v[156:159], a[156:159], v[220:223], v[156:159]
  v_mfma_f32_16x16x32_bf16 v[160:163], a[152:155], v[224:227], v[160:163]
  v_mfma_f32_16x16x32_bf16 v[164:167], a[156:159], v[224:227], v[164:167]
  v_mfma_f32_16x16x32_bf16 v[168:171], a[152:155], v[228:231], v[168:171]
  v_mfma_f32_16x16x32_bf16 v[172:175], a[156:159], v[228:231], v[172:175]
  s_waitcnt lgkmcnt(0)
  v_mfma_f32_16x16x32_bf16 v[120:123], a[160:163], v[176:179], v[120:123]
  ds_read_b64_tr_b16 v[204:205], v24 offset:24576
  ds_read_b64_tr_b16 v[206:207], v24 offset:25600
  s_add_u32 m0, s71, 49152
  v_mfma_f32_16x16x32_bf16 v[124:127], a[164:167], v[176:179], v[124:127]
  ds_read_b64_tr_b16 v[208:209], v25 offset:24576
  ds_read_b64_tr_b16 v[210:211], v25 offset:25600
  s_mov_b32 s23, 384
  v_mfma_f32_16x16x32_bf16 v[128:131], a[160:163], v[180:183], v[128:131]
  ds_read_b64_tr_b16 v[212:213], v26 offset:24576
  ds_read_b64_tr_b16 v[214:215], v26 offset:25600
  buffer_load_dwordx4 v1, s[8:11], s23 offen offset:0 lds
  v_mfma_f32_16x16x32_bf16 v[132:135], a[164:167], v[180:183], v[132:135]
  ds_read_b64_tr_b16 v[216:217], v27 offset:24576
  ds_read_b64_tr_b16 v[218:219], v27 offset:25600
  buffer_load_dwordx4 v2, s[8:11], s23 offen offset:1024 lds
  v_mfma_f32_16x16x32_bf16 v[136:139], a[160:163], v[184:187], v[136:139]
  ds_read_b64_tr_b16 v[220:221], v28 offset:24576
  ds_read_b64_tr_b16 v[222:223], v28 offset:25600
  buffer_load_dwordx4 v3, s[8:11], s23 offen offset:2048 lds
  v_mfma_f32_16x16x32_bf16 v[140:143], a[164:167], v[184:187], v[140:143]
  ds_read_b64_tr_b16 v[224:225], v29 offset:24576
  ds_read_b64_tr_b16 v[226:227], v29 offset:25600
  buffer_load_dwordx4 v4, s[8:11], s23 offen offset:3072 lds
  v_mfma_f32_16x16x32_bf16 v[144:147], a[160:163], v[188:191], v[144:147]
  ds_read_b64_tr_b16 v[228:229], v30 offset:24576
  ds_read_b64_tr_b16 v[230:231], v30 offset:25600
  v_mfma_f32_16x16x32_bf16 v[148:151], a[164:167], v[188:191], v[148:151]
  v_mfma_f32_16x16x32_bf16 v[152:155], a[160:163], v[192:195], v[152:155]
  v_mfma_f32_16x16x32_bf16 v[156:159], a[164:167], v[192:195], v[156:159]
  v_mfma_f32_16x16x32_bf16 v[160:163], a[160:163], v[196:199], v[160:163]
  v_mfma_f32_16x16x32_bf16 v[164:167], a[164:167], v[196:199], v[164:167]
  v_mfma_f32_16x16x32_bf16 v[168:171], a[160:163], v[200:203], v[168:171]
  v_mfma_f32_16x16x32_bf16 v[172:175], a[164:167], v[200:203], v[172:175]
  s_waitcnt vmcnt(8)
  s_waitcnt lgkmcnt(0)
  s_barrier
  v_mfma_f32_16x16x32_bf16 v[120:123], a[168:171], v[204:207], v[120:123]
  ds_read_b64_tr_b16 v[176:177], v24 offset:32768
  ds_read_b64_tr_b16 v[178:179], v24 offset:33792
  s_add_u32 m0, s71, 131072
  v_mfma_f32_16x16x32_bf16 v[124:127], a[172:175], v[204:207], v[124:127]
  ds_read_b128 a[176:179], v20 offset:32768
  ds_read_b128 a[180:183], v20 offset:33280
  s_add_u32 s23, s24, 917504
  v_mfma_f32_16x16x32_bf16 v[128:131], a[168:171], v[208:211], v[128:131]
  ds_read_b128 a[184:187], v21 offset:32768
  ds_read_b128 a[188:191], v21 offset:33280
  buffer_load_dwordx4 v5, s[12:15], s23 offen offset:0 lds
  v_mfma_f32_16x16x32_bf16 v[132:135], a[172:175], v[208:211], v[132:135]
  ds_read_b64_tr_b16 v[180:181], v25 offset:32768
  ds_read_b64_tr_b16 v[182:183], v25 offset:33792
  buffer_load_dwordx4 v6, s[12:15], s23 offen offset:1024 lds
  v_mfma_f32_16x16x32_bf16 v[136:139], a[168:171], v[212:215], v[136:139]
  ds_read_b64_tr_b16 v[184:185], v26 offset:32768
  ds_read_b64_tr_b16 v[186:187], v26 offset:33792
  buffer_load_dwordx4 v7, s[12:15], s23 offen offset:2048 lds
  v_mfma_f32_16x16x32_bf16 v[140:143], a[172:175], v[212:215], v[140:143]
  ds_read_b64_tr_b16 v[188:189], v27 offset:32768
  ds_read_b64_tr_b16 v[190:191], v27 offset:33792
  buffer_load_dwordx4 v8, s[12:15], s23 offen offset:3072 lds
  v_mfma_f32_16x16x32_bf16 v[144:147], a[168:171], v[216:219], v[144:147]
  ds_read_b64_tr_b16 v[192:193], v28 offset:32768
  ds_read_b64_tr_b16 v[194:195], v28 offset:33792
  v_mfma_f32_16x16x32_bf16 v[148:151], a[172:175], v[216:219], v[148:151]
  ds_read_b64_tr_b16 v[196:197], v29 offset:32768
  ds_read_b64_tr_b16 v[198:199], v29 offset:33792
  v_mfma_f32_16x16x32_bf16 v[152:155], a[168:171], v[220:223], v[152:155]
  ds_read_b64_tr_b16 v[200:201], v30 offset:32768
  ds_read_b64_tr_b16 v[202:203], v30 offset:33792
  v_mfma_f32_16x16x32_bf16 v[156:159], a[172:175], v[220:223], v[156:159]
  v_mfma_f32_16x16x32_bf16 v[160:163], a[168:171], v[224:227], v[160:163]
  v_mfma_f32_16x16x32_bf16 v[164:167], a[172:175], v[224:227], v[164:167]
  v_mfma_f32_16x16x32_bf16 v[168:171], a[168:171], v[228:231], v[168:171]
  v_mfma_f32_16x16x32_bf16 v[172:175], a[172:175], v[228:231], v[172:175]
  s_waitcnt lgkmcnt(0)
  v_mfma_f32_16x16x32_bf16 v[120:123], a[176:179], v[176:179], v[120:123]
  ds_read_b64_tr_b16 v[204:205], v24 offset:40960
  ds_read_b64_tr_b16 v[206:207], v24 offset:41984
  s_add_u32 m0, s71, 65536
  v_mfma_f32_16x16x32_bf16 v[124:127], a[180:183], v[176:179], v[124:127]
  ds_read_b64_tr_b16 v[208:209], v25 offset:40960
  ds_read_b64_tr_b16 v[210:211], v25 offset:41984
  s_mov_b32 s23, 512
  v_mfma_f32_16x16x32_bf16 v[128:131], a[176:179], v[180:183], v[128:131]
  ds_read_b64_tr_b16 v[212:213], v26 offset:40960
  ds_read_b64_tr_b16 v[214:215], v26 offset:41984
  buffer_load_dwordx4 v1, s[8:11], s23 offen offset:0 lds
  v_mfma_f32_16x16x32_bf16 v[132:135], a[180:183], v[180:183], v[132:135]
  ds_read_b64_tr_b16 v[216:217], v27 offset:40960
  ds_read_b64_tr_b16 v[218:219], v27 offset:41984
  buffer_load_dwordx4 v2, s[8:11], s23 offen offset:1024 lds
  v_mfma_f32_16x16x32_bf16 v[136:139], a[176:179], v[184:187], v[136:139]
  ds_read_b64_tr_b16 v[220:221], v28 offset:40960
  ds_read_b64_tr_b16 v[222:223], v28 offset:41984
  buffer_load_dwordx4 v3, s[8:11], s23 offen offset:2048 lds
  v_mfma_f32_16x16x32_bf16 v[140:143], a[180:183], v[184:187], v[140:143]
  ds_read_b64_tr_b16 v[224:225], v29 offset:40960
  ds_read_b64_tr_b16 v[226:227], v29 offset:41984
  buffer_load_dwordx4 v4, s[8:11], s23 offen offset:3072 lds
  v_mfma_f32_16x16x32_bf16 v[144:147], a[176:179], v[188:191], v[144:147]
  ds_read_b64_tr_b16 v[228:229], v30 offset:40960
  ds_read_b64_tr_b16 v[230:231], v30 offset:41984
  v_mfma_f32_16x16x32_bf16 v[148:151], a[180:183], v[188:191], v[148:151]
  v_mfma_f32_16x16x32_bf16 v[152:155], a[176:179], v[192:195], v[152:155]
  v_mfma_f32_16x16x32_bf16 v[156:159], a[180:183], v[192:195], v[156:159]
  v_mfma_f32_16x16x32_bf16 v[160:163], a[176:179], v[196:199], v[160:163]
  v_mfma_f32_16x16x32_bf16 v[164:167], a[180:183], v[196:199], v[164:167]
  v_mfma_f32_16x16x32_bf16 v[168:171], a[176:179], v[200:203], v[168:171]
  v_mfma_f32_16x16x32_bf16 v[172:175], a[180:183], v[200:203], v[172:175]
  s_waitcnt vmcnt(8)
  s_waitcnt lgkmcnt(0)
  s_barrier
  v_mfma_f32_16x16x32_bf16 v[120:123], a[184:187], v[204:207], v[120:123]
  ds_read_b64_tr_b16 v[176:177], v24 offset:0
  ds_read_b64_tr_b16 v[178:179], v24 offset:1024
  s_add_u32 m0, s71, 147456
  v_mfma_f32_16x16x32_bf16 v[124:127], a[188:191], v[204:207], v[124:127]
  ds_read_b128 a[192:195], v20 offset:49152
  ds_read_b128 a[196:199], v20 offset:49664
  s_add_u32 s23, s24, 1146880
  v_mfma_f32_16x16x32_bf16 v[128:131], a[184:187], v[208:211], v[128:131]
  ds_read_b128 a[200:203], v21 offset:49152
  ds_read_b128 a[204:207], v21 offset:49664
  buffer_load_dwordx4 v5, s[12:15], s23 offen offset:0 lds
  v_mfma_f32_16x16x32_bf16 v[132:135], a[188:191], v[208:211], v[132:135]
  ds_read_b64_tr_b16 v[180:181], v25 offset:0
  ds_read_b64_tr_b16 v[182:183], v25 offset:1024
  buffer_load_dwordx4 v6, s[12:15], s23 offen offset:1024 lds
  v_mfma_f32_16x16x32_bf16 v[136:139], a[184:187], v[212:215], v[136:139]
  ds_read_b64_tr_b16 v[184:185], v26 offset:0
  ds_read_b64_tr_b16 v[186:187], v26 offset:1024
  buffer_load_dwordx4 v7, s[12:15], s23 offen offset:2048 lds
  v_mfma_f32_16x16x32_bf16 v[140:143], a[188:191], v[212:215], v[140:143]
  ds_read_b64_tr_b16 v[188:189], v27 offset:0
  ds_read_b64_tr_b16 v[190:191], v27 offset:1024
  buffer_load_dwordx4 v8, s[12:15], s23 offen offset:3072 lds
  v_mfma_f32_16x16x32_bf16 v[144:147], a[184:187], v[216:219], v[144:147]
  ds_read_b64_tr_b16 v[192:193], v28 offset:0
  ds_read_b64_tr_b16 v[194:195], v28 offset:1024
  v_mfma_f32_16x16x32_bf16 v[148:151], a[188:191], v[216:219], v[148:151]
  ds_read_b64_tr_b16 v[196:197], v29 offset:0
  ds_read_b64_tr_b16 v[198:199], v29 offset:1024
  v_mfma_f32_16x16x32_bf16 v[152:155], a[184:187], v[220:223], v[152:155]
  ds_read_b64_tr_b16 v[200:201], v30 offset:0
  ds_read_b64_tr_b16 v[202:203], v30 offset:1024
  v_mfma_f32_16x16x32_bf16 v[156:159], a[188:191], v[220:223], v[156:159]
  v_mfma_f32_16x16x32_bf16 v[160:163], a[184:187], v[224:227], v[160:163]
  v_mfma_f32_16x16x32_bf16 v[164:167], a[188:191], v[224:227], v[164:167]
  v_mfma_f32_16x16x32_bf16 v[168:171], a[184:187], v[228:231], v[168:171]
  v_mfma_f32_16x16x32_bf16 v[172:175], a[188:191], v[228:231], v[172:175]
  s_waitcnt lgkmcnt(0)
  v_mfma_f32_16x16x32_bf16 v[120:123], a[192:195], v[176:179], v[120:123]
  ds_read_b64_tr_b16 v[204:205], v24 offset:8192
  ds_read_b64_tr_b16 v[206:207], v24 offset:9216
  s_add_u32 m0, s71, 81920
  v_mfma_f32_16x16x32_bf16 v[124:127], a[196:199], v[176:179], v[124:127]
  ds_read_b64_tr_b16 v[208:209], v25 offset:8192
  ds_read_b64_tr_b16 v[210:211], v25 offset:9216
  s_mov_b32 s23, 640
  v_mfma_f32_16x16x32_bf16 v[128:131], a[192:195], v[180:183], v[128:131]
  ds_read_b64_tr_b16 v[212:213], v26 offset:8192
  ds_read_b64_tr_b16 v[214:215], v26 offset:9216
  buffer_load_dwordx4 v1, s[8:11], s23 offen offset:0 lds
  v_mfma_f32_16x16x32_bf16 v[132:135], a[196:199], v[180:183], v[132:135]
  ds_read_b64_tr_b16 v[216:217], v27 offset:8192
  ds_read_b64_tr_b16 v[218:219], v27 offset:9216
  buffer_load_dwordx4 v2, s[8:11], s23 offen offset:1024 lds
  v_mfma_f32_16x16x32_bf16 v[136:139], a[192:195], v[184:187], v[136:139]
  ds_read_b64_tr_b16 v[220:221], v28 offset:8192
  ds_read_b64_tr_b16 v[222:223], v28 offset:9216
  buffer_load_dwordx4 v3, s[8:11], s23 offen offset:2048 lds
  v_mfma_f32_16x16x32_bf16 v[140:143], a[196:199], v[184:187], v[140:143]
  ds_read_b64_tr_b16 v[224:225], v29 offset:8192
  ds_read_b64_tr_b16 v[226:227], v29 offset:9216
  buffer_load_dwordx4 v4, s[8:11], s23 offen offset:3072 lds
  v_mfma_f32_16x16x32_bf16 v[144:147], a[192:195], v[188:191], v[144:147]
  ds_read_b64_tr_b16 v[228:229], v30 offset:8192
  ds_read_b64_tr_b16 v[230:231], v30 offset:9216
  v_mfma_f32_16x16x32_bf16 v[148:151], a[196:199], v[188:191], v[148:151]
  v_mfma_f32_16x16x32_bf16 v[152:155], a[192:195], v[192:195], v[152:155]
  v_mfma_f32_16x16x32_bf16 v[156:159], a[196:199], v[192:195], v[156:159]
  v_mfma_f32_16x16x32_bf16 v[160:163], a[192:195], v[196:199], v[160:163]
  v_mfma_f32_16x16x32_bf16 v[164:167], a[196:199], v[196:199], v[164:167]
  v_mfma_f32_16x16x32_bf16 v[168:171], a[192:195], v[200:203], v[168:171]
  v_mfma_f32_16x16x32_bf16 v[172:175], a[196:199], v[200:203], v[172:175]
  s_waitcnt vmcnt(8)
  s_waitcnt lgkmcnt(0)
  s_barrier
  v_mfma_f32_16x16x32_bf16 v[120:123], a[200:203], v[204:207], v[120:123]
  ds_read_b64_tr_b16 v[176:177], v24 offset:16384
  ds_read_b64_tr_b16 v[178:179], v24 offset:17408
  s_add_u32 m0, s71, 114688
  v_mfma_f32_16x16x32_bf16 v[124:127], a[204:207], v[204:207], v[124:127]
  ds_read_b128 a[208:211], v22 offset:0
  ds_read_b128 a[212:215], v22 offset:512
  s_add_u32 s23, s24, 1376256
  v_mfma_f32_16x16x32_bf16 v[128:131], a[200:203], v[208:211], v[128:131]
  ds_read_b128 a[216:219], v23 offset:0
  ds_read_b128 a[220:223], v23 offset:512
  buffer_load_dwordx4 v5, s[12:15], s23 offen offset:0 lds
  v_mfma_f32_16x16x32_bf16 v[132:135], a[204:207], v[208:211], v[132:135]
  ds_read_b64_tr_b16 v[180:181], v25 offset:16384
  ds_read_b64_tr_b16 v[182:183], v25 offset:17408
  buffer_load_dwordx4 v6, s[12:15], s23 offen offset:1024 lds
  v_mfma_f32_16x16x32_bf16 v[136:139], a[200:203], v[212:215], v[136:139]
  ds_read_b64_tr_b16 v[184:185], v26 offset:16384
  ds_read_b64_tr_b16 v[186:187], v26 offset:17408
  buffer_load_dwordx4 v7, s[12:15], s23 offen offset:2048 lds
  v_mfma_f32_16x16x32_bf16 v[140:143], a[204:207], v[212:215], v[140:143]
  ds_read_b64_tr_b16 v[188:189], v27 offset:16384
  ds_read_b64_tr_b16 v[190:191], v27 offset:17408
  buffer_load_dwordx4 v8, s[12:15], s23 offen offset:3072 lds
  v_mfma_f32_16x16x32_bf16 v[144:147], a[200:203], v[216:219], v[144:147]
  ds_read_b64_tr_b16 v[192:193], v28 offset:16384
  ds_read_b64_tr_b16 v[194:195], v28 offset:17408
  v_mfma_f32_16x16x32_bf16 v[148:151], a[204:207], v[216:219], v[148:151]
  ds_read_b64_tr_b16 v[196:197], v29 offset:16384
  ds_read_b64_tr_b16 v[198:199], v29 offset:17408
  v_mfma_f32_16x16x32_bf16 v[152:155], a[200:203], v[220:223], v[152:155]
  ds_read_b64_tr_b16 v[200:201], v30 offset:16384
  ds_read_b64_tr_b16 v[202:203], v30 offset:17408
  v_mfma_f32_16x16x32_bf16 v[156:159], a[204:207], v[220:223], v[156:159]
  v_mfma_f32_16x16x32_bf16 v[160:163], a[200:203], v[224:227], v[160:163]
  v_mfma_f32_16x16x32_bf16 v[164:167], a[204:207], v[224:227], v[164:167]
  v_mfma_f32_16x16x32_bf16 v[168:171], a[200:203], v[228:231], v[168:171]
  v_mfma_f32_16x16x32_bf16 v[172:175], a[204:207], v[228:231], v[172:175]
  s_waitcnt lgkmcnt(0)
  v_mfma_f32_16x16x32_bf16 v[120:123], a[208:211], v[176:179], v[120:123]
  ds_read_b64_tr_b16 v[204:205], v24 offset:24576
  ds_read_b64_tr_b16 v[206:207], v24 offset:25600
  s_add_u32 m0, s71, 98304
  v_mfma_f32_16x16x32_bf16 v[124:127], a[212:215], v[176:179], v[124:127]
  ds_read_b64_tr_b16 v[208:209], v25 offset:24576
  ds_read_b64_tr_b16 v[210:211], v25 offset:25600
  s_mov_b32 s23, 768
  v_mfma_f32_16x16x32_bf16 v[128:131], a[208:211], v[180:183], v[128:131]
  ds_read_b64_tr_b16 v[212:213], v26 offset:24576
  ds_read_b64_tr_b16 v[214:215], v26 offset:25600
  buffer_load_dwordx4 v1, s[8:11], s23 offen offset:0 lds
  v_mfma_f32_16x16x32_bf16 v[132:135], a[212:215], v[180:183], v[132:135]
  ds_read_b64_tr_b16 v[216:217], v27 offset:24576
  ds_read_b64_tr_b16 v[218:219], v27 offset:25600
  buffer_load_dwordx4 v2, s[8:11], s23 offen offset:1024 lds
  v_mfma_f32_16x16x32_bf16 v[136:139], a[208:211], v[184:187], v[136:139]
  ds_read_b64_tr_b16 v[220:221], v28 offset:24576
  ds_read_b64_tr_b16 v[222:223], v28 offset:25600
  buffer_load_dwordx4 v3, s[8:11], s23 offen offset:2048 lds
  v_mfma_f32_16x16x32_bf16 v[140:143], a[212:215], v[184:187], v[140:143]
  ds_read_b64_tr_b16 v[224:225], v29 offset:24576
  ds_read_b64_tr_b16 v[226:227], v29 offset:25600
  buffer_load_dwordx4 v4, s[8:11], s23 offen offset:3072 lds
  v_mfma_f32_16x16x32_bf16 v[144:147], a[208:211], v[188:191], v[144:147]
  ds_read_b64_tr_b16 v[228:229], v30 offset:24576
  ds_read_b64_tr_b16 v[230:231], v30 offset:25600
  v_mfma_f32_16x16x32_bf16 v[148:151], a[212:215], v[188:191], v[148:151]
  v_mfma_f32_16x16x32_bf16 v[152:155], a[208:211], v[192:195], v[152:155]
  v_mfma_f32_16x16x32_bf16 v[156:159], a[212:215], v[192:195], v[156:159]
  v_mfma_f32_16x16x32_bf16 v[160:163], a[208:211], v[196:199], v[160:163]
  v_mfma_f32_16x16x32_bf16 v[164:167], a[212:215], v[196:199], v[164:167]
  v_mfma_f32_16x16x32_bf16 v[168:171], a[208:211], v[200:203], v[168:171]
  v_mfma_f32_16x16x32_bf16 v[172:175], a[212:215], v[200:203], v[172:175]
  s_waitcnt vmcnt(8)
  s_waitcnt lgkmcnt(0)
  s_barrier
  v_mfma_f32_16x16x32_bf16 v[120:123], a[216:219], v[204:207], v[120:123]
  ds_read_b64_tr_b16 v[176:177], v24 offset:32768
  ds_read_b64_tr_b16 v[178:179], v24 offset:33792
  v_mfma_f32_16x16x32_bf16 v[124:127], a[220:223], v[204:207], v[124:127]
  ds_read_b128 a[224:227], v22 offset:16384
  ds_read_b128 a[228:231], v22 offset:16896
  v_mfma_f32_16x16x32_bf16 v[128:131], a[216:219], v[208:211], v[128:131]
  ds_read_b128 a[232:235], v23 offset:16384
  ds_read_b128 a[236:239], v23 offset:16896
  v_mfma_f32_16x16x32_bf16 v[132:135], a[220:223], v[208:211], v[132:135]
  ds_read_b64_tr_b16 v[180:181], v25 offset:32768
  ds_read_b64_tr_b16 v[182:183], v25 offset:33792
  v_mfma_f32_16x16x32_bf16 v[136:139], a[216:219], v[212:215], v[136:139]
  ds_read_b64_tr_b16 v[184:185], v26 offset:32768
  ds_read_b64_tr_b16 v[186:187], v26 offset:33792
  v_mfma_f32_16x16x32_bf16 v[140:143], a[220:223], v[212:215], v[140:143]
  ds_read_b64_tr_b16 v[188:189], v27 offset:32768
  ds_read_b64_tr_b16 v[190:191], v27 offset:33792
  v_mfma_f32_16x16x32_bf16 v[144:147], a[216:219], v[216:219], v[144:147]
  ds_read_b64_tr_b16 v[192:193], v28 offset:32768
  ds_read_b64_tr_b16 v[194:195], v28 offset:33792
  v_mfma_f32_16x16x32_bf16 v[148:151], a[220:223], v[216:219], v[148:151]
  ds_read_b64_tr_b16 v[196:197], v29 offset:32768
  ds_read_b64_tr_b16 v[198:199], v29 offset:33792
  v_mfma_f32_16x16x32_bf16 v[152:155], a[216:219], v[220:223], v[152:155]
  ds_read_b64_tr_b16 v[200:201], v30 offset:32768
  ds_read_b64_tr_b16 v[202:203], v30 offset:33792
  v_mfma_f32_16x16x32_bf16 v[156:159], a[220:223], v[220:223], v[156:159]
  v_mfma_f32_16x16x32_bf16 v[160:163], a[216:219], v[224:227], v[160:163]
  v_mfma_f32_16x16x32_bf16 v[164:167], a[220:223], v[224:227], v[164:167]
  v_mfma_f32_16x16x32_bf16 v[168:171], a[216:219], v[228:231], v[168:171]
  v_mfma_f32_16x16x32_bf16 v[172:175], a[220:223], v[228:231], v[172:175]
  s_lshl_b32 s75, s22, 18
  s_lshl_b32 s100, s21, 15
  s_add_u32 s75, s75, s100
  s_lshl_b32 s100, s3, 13
  s_add_u32 s75, s75, s100
  v_lshlrev_b32 v60, 7, v12
  v_add_u32 v60, s75, v60
  global_load_dword v56, v60, s[46:47]
  s_waitcnt lgkmcnt(0)
  v_mfma_f32_16x16x32_bf16 v[120:123], a[224:227], v[176:179], v[120:123]
  ds_read_b64_tr_b16 v[204:205], v24 offset:40960
  ds_read_b64_tr_b16 v[206:207], v24 offset:41984
  v_mfma_f32_16x16x32_bf16 v[124:127], a[228:231], v[176:179], v[124:127]
  ds_read_b64_tr_b16 v[208:209], v25 offset:40960
  ds_read_b64_tr_b16 v[210:211], v25 offset:41984
  v_mfma_f32_16x16x32_bf16 v[128:131], a[224:227], v[180:183], v[128:131]
  ds_read_b64_tr_b16 v[212:213], v26 offset:40960
  ds_read_b64_tr_b16 v[214:215], v26 offset:41984
  v_mfma_f32_16x16x32_bf16 v[132:135], a[228:231], v[180:183], v[132:135]
  ds_read_b64_tr_b16 v[216:217], v27 offset:40960
  ds_read_b64_tr_b16 v[218:219], v27 offset:41984
  v_mfma_f32_16x16x32_bf16 v[136:139], a[224:227], v[184:187], v[136:139]
  ds_read_b64_tr_b16 v[220:221], v28 offset:40960
  ds_read_b64_tr_b16 v[222:223], v28 offset:41984
  v_mfma_f32_16x16x32_bf16 v[140:143], a[228:231], v[184:187], v[140:143]
  ds_read_b64_tr_b16 v[224:225], v29 offset:40960
  ds_read_b64_tr_b16 v[226:227], v29 offset:41984
  v_mfma_f32_16x16x32_bf16 v[144:147], a[224:227], v[188:191], v[144:147]
  ds_read_b64_tr_b16 v[228:229], v30 offset:40960
  ds_read_b64_tr_b16 v[230:231], v30 offset:41984
  v_mfma_f32_16x16x32_bf16 v[148:151], a[228:231], v[188:191], v[148:151]
  v_mfma_f32_16x16x32_bf16 v[152:155], a[224:227], v[192:195], v[152:155]
  v_mfma_f32_16x16x32_bf16 v[156:159], a[228:231], v[192:195], v[156:159]
  v_mfma_f32_16x16x32_bf16 v[160:163], a[224:227], v[196:199], v[160:163]
  v_mfma_f32_16x16x32_bf16 v[164:167], a[228:231], v[196:199], v[164:167]
  v_mfma_f32_16x16x32_bf16 v[168:171], a[224:227], v[200:203], v[168:171]
  v_mfma_f32_16x16x32_bf16 v[172:175], a[228:231], v[200:203], v[172:175]
  s_waitcnt vmcnt(1)
  s_waitcnt lgkmcnt(0)
  s_barrier
  v_mfma_f32_16x16x32_bf16 v[120:123], a[232:235], v[204:207], v[120:123]
  ds_read_b64_tr_b16 v[176:177], v24 offset:0
  ds_read_b64_tr_b16 v[178:179], v24 offset:1024
  v_mfma_f32_16x16x32_bf16 v[124:127], a[236:239], v[204:207], v[124:127]
  ds_read_b128 a[240:243], v22 offset:32768
  ds_read_b128 a[244:247], v22 offset:33280
  v_mfma_f32_16x16x32_bf16 v[128:131], a[232:235], v[208:211], v[128:131]
  ds_read_b128 a[248:251], v23 offset:32768
  ds_read_b128 a[252:255], v23 offset:33280
  v_mfma_f32_16x16x32_bf16 v[132:135], a[236:239], v[208:211], v[132:135]
  ds_read_b64_tr_b16 v[180:181], v25 offset:0
  ds_read_b64_tr_b16 v[182:183], v25 offset:1024
  v_mfma_f32_16x16x32_bf16 v[136:139], a[232:235], v[212:215], v[136:139]
  ds_read_b64_tr_b16 v[184:185], v26 offset:0
  ds_read_b64_tr_b16 v[186:187], v26 offset:1024
  v_mfma_f32_16x16x32_bf16 v[140:143], a[236:239], v[212:215], v[140:143]
  ds_read_b64_tr_b16 v[188:189], v27 offset:0
  ds_read_b64_tr_b16 v[190:191], v27 offset:1024
  v_mfma_f32_16x16x32_bf16 v[144:147], a[232:235], v[216:219], v[144:147]
  ds_read_b64_tr_b16 v[192:193], v28 offset:0
  ds_read_b64_tr_b16 v[194:195], v28 offset:1024
  v_mfma_f32_16x16x32_bf16 v[148:151], a[236:239], v[216:219], v[148:151]
  ds_read_b64_tr_b16 v[196:197], v29 offset:0
  ds_read_b64_tr_b16 v[198:199], v29 offset:1024
  v_mfma_f32_16x16x32_bf16 v[152:155], a[232:235], v[220:223], v[152:155]
  ds_read_b64_tr_b16 v[200:201], v30 offset:0
  ds_read_b64_tr_b16 v[202:203], v30 offset:1024
  v_mfma_f32_16x16x32_bf16 v[156:159], a[236:239], v[220:223], v[156:159]
  v_mfma_f32_16x16x32_bf16 v[160:163], a[232:235], v[224:227], v[160:163]
  v_mfma_f32_16x16x32_bf16 v[164:167], a[236:239], v[224:227], v[164:167]
  v_mfma_f32_16x16x32_bf16 v[168:171], a[232:235], v[228:231], v[168:171]
  v_mfma_f32_16x16x32_bf16 v[172:175], a[236:239], v[228:231], v[172:175]
  s_waitcnt lgkmcnt(0)
  v_mfma_f32_16x16x32_bf16 v[120:123], a[240:243], v[176:179], v[120:123]
  ds_read_b64_tr_b16 v[204:205], v24 offset:8192
  ds_read_b64_tr_b16 v[206:207], v24 offset:9216
  v_mfma_f32_16x16x32_bf16 v[124:127], a[244:247], v[176:179], v[124:127]
  ds_read_b64_tr_b16 v[208:209], v25 offset:8192
  ds_read_b64_tr_b16 v[210:211], v25 offset:9216
  v_mfma_f32_16x16x32_bf16 v[128:131], a[240:243], v[180:183], v[128:131]
  ds_read_b64_tr_b16 v[212:213], v26 offset:8192
  ds_read_b64_tr_b16 v[214:215], v26 offset:9216
  v_mfma_f32_16x16x32_bf16 v[132:135], a[244:247], v[180:183], v[132:135]
  ds_read_b64_tr_b16 v[216:217], v27 offset:8192
  ds_read_b64_tr_b16 v[218:219], v27 offset:9216
  v_mfma_f32_16x16x32_bf16 v[136:139], a[240:243], v[184:187], v[136:139]
  ds_read_b64_tr_b16 v[220:221], v28 offset:8192
  ds_read_b64_tr_b16 v[222:223], v28 offset:9216
  v_mfma_f32_16x16x32_bf16 v[140:143], a[244:247], v[184:187], v[140:143]
  ds_read_b64_tr_b16 v[224:225], v29 offset:8192
  ds_read_b64_tr_b16 v[226:227], v29 offset:9216
  v_mfma_f32_16x16x32_bf16 v[144:147], a[240:243], v[188:191], v[144:147]
  ds_read_b64_tr_b16 v[228:229], v30 offset:8192
  ds_read_b64_tr_b16 v[230:231], v30 offset:9216
  v_mfma_f32_16x16x32_bf16 v[148:151], a[244:247], v[188:191], v[148:151]
  v_mfma_f32_16x16x32_bf16 v[152:155], a[240:243], v[192:195], v[152:155]
  v_mfma_f32_16x16x32_bf16 v[156:159], a[244:247], v[192:195], v[156:159]
  v_mfma_f32_16x16x32_bf16 v[160:163], a[240:243], v[196:199], v[160:163]
  v_mfma_f32_16x16x32_bf16 v[164:167], a[244:247], v[196:199], v[164:167]
  v_mfma_f32_16x16x32_bf16 v[168:171], a[240:243], v[200:203], v[168:171]
  v_mfma_f32_16x16x32_bf16 v[172:175], a[244:247], v[200:203], v[172:175]
  s_waitcnt lgkmcnt(0)
  s_barrier
  v_mfma_f32_16x16x32_bf16 v[120:123], a[248:251], v[204:207], v[120:123]
  v_mfma_f32_16x16x32_bf16 v[124:127], a[252:255], v[204:207], v[124:127]
  v_mfma_f32_16x16x32_bf16 v[128:131], a[248:251], v[208:211], v[128:131]
  v_mfma_f32_16x16x32_bf16 v[132:135], a[252:255], v[208:211], v[132:135]
  v_mfma_f32_16x16x32_bf16 v[136:139], a[248:251], v[212:215], v[136:139]
  v_mfma_f32_16x16x32_bf16 v[140:143], a[252:255], v[212:215], v[140:143]
  v_mfma_f32_16x16x32_bf16 v[144:147], a[248:251], v[216:219], v[144:147]
  v_mfma_f32_16x16x32_bf16 v[148:151], a[252:255], v[216:219], v[148:151]
  v_mfma_f32_16x16x32_bf16 v[152:155], a[248:251], v[220:223], v[152:155]
  v_mfma_f32_16x16x32_bf16 v[156:159], a[252:255], v[220:223], v[156:159]
  v_mfma_f32_16x16x32_bf16 v[160:163], a[248:251], v[224:227], v[160:163]
  v_mfma_f32_16x16x32_bf16 v[164:167], a[252:255], v[224:227], v[164:167]
  s_add_u32 m0, s71, 0
  s_add_u32 s75, s25, 0
  buffer_load_dwordx4 v5, s[12:15], s75 offen offset:0 lds
  v_mfma_f32_16x16x32_bf16 v[168:171], a[248:251], v[228:231], v[168:171]
  v_mfma_f32_16x16x32_bf16 v[172:175], a[252:255], v[228:231], v[172:175]
  s_lshl_b32 s33, s22, 18
  s_add_u32 s60, s46, s33
  s_addc_u32 s61, s47, 0
  s_and_b32 s61, s61, 0xffff
  s_mov_b32 s62, 262144
  s_mov_b32 s63, 0x20000
  v_lshrrev_b32 v16, 3, v12
  v_and_b32 v17, 7, v12
  v_and_b32 v18, 3, v16
  v_xor_b32 v17, v17, v18
  v_lshlrev_b32 v17, 4, v17
  v_lshl_add_u32 v17, v16, 12, v17
  v_mov_b32 v232, v17
  v_xor_b32 v233, 64, v17
  v_add_u32 v233, 31744, v233
  v_mov_b32 v234, v17
  buffer_load_dwordx4 v6, s[12:15], s75 offen offset:1024 lds
  v_add_u32 v234, 63488, v234
  v_xor_b32 v235, 64, v17
  v_add_u32 v235, 95232, v235
  v_lshrrev_b32 v16, 2, v13
  v_lshlrev_b32 v16, 3, v16
  v_and_b32 v17, 3, v13
  v_add_u32 v16, v16, v17
  v_and_b32 v17, 7, v13
  v_xor_b32 v17, v17, v14
  v_lshlrev_b32 v17, 4, v17
  v_lshl_add_u32 v240, v16, 7, v17
  s_lshr_b32 s33, s3, 1
  s_lshl_b32 s68, s33, 17
  s_lshl_b32 s33, s3, 10
  s_add_u32 s68, s68, s33
  s_xor_b32 s69, s68, 0x20000
  s_mul_i32 s74, s3, 12288
  s_add_u32 s74, s74, 114688
  s_and_b32 s33, s3, 1
  s_lshl_b32 s33, s33, 9
  s_add_u32 s33, s33, s74
  v_add_u32 v236, s33, v240
  buffer_load_dwordx4 v7, s[12:15], s75 offen offset:2048 lds
  v_xor_b32 v237, 64, v236
  s_xor_b32 s33, s33, 512
  v_add_u32 v238, s33, v240
  v_xor_b32 v239, 64, v238
  v_pk_mul_f32 v[176:177], v[120:121], v[120:121]
  v_pk_mul_f32 v[180:181], v[122:123], v[122:123]
  v_pk_fma_f32 v[176:177], v[176:177], v[34:35], v[32:33]
  v_pk_fma_f32 v[180:181], v[180:181], v[34:35], v[32:33]
  v_pk_mul_f32 v[176:177], v[176:177], v[120:121]
  v_pk_mul_f32 v[180:181], v[180:181], v[122:123]
  v_exp_f32 v176, v176
  v_exp_f32 v177, v177
  v_exp_f32 v180, v180
  buffer_load_dwordx4 v8, s[12:15], s75 offen offset:3072 lds
  v_exp_f32 v181, v181
  v_pk_add_f32 v[176:177], v[176:177], v[36:37]
  v_pk_add_f32 v[180:181], v[180:181], v[36:37]
  v_rcp_f32 v176, v176
  v_rcp_f32 v177, v177
  v_rcp_f32 v180, v180
  v_rcp_f32 v181, v181
  v_pk_mul_f32 v[120:121], v[120:121], v[176:177]
  v_pk_mul_f32 v[122:123], v[122:123], v[180:181]
  v_pk_mul_f32 v[176:177], v[124:125], v[124:125]
  v_pk_mul_f32 v[180:181], v[126:127], v[126:127]
  v_pk_fma_f32 v[176:177], v[176:177], v[34:35], v[32:33]
  s_add_u32 m0, s71, 16384
  s_add_u32 s75, s25, 229376
  buffer_load_dwordx4 v5, s[12:15], s75 offen offset:0 lds
  v_pk_fma_f32 v[180:181], v[180:181], v[34:35], v[32:33]
  v_pk_mul_f32 v[176:177], v[176:177], v[124:125]
  v_pk_mul_f32 v[180:181], v[180:181], v[126:127]
  v_exp_f32 v176, v176
  v_exp_f32 v177, v177
  v_exp_f32 v180, v180
  v_exp_f32 v181, v181
  v_pk_add_f32 v[176:177], v[176:177], v[36:37]
  v_pk_add_f32 v[180:181], v[180:181], v[36:37]
  v_rcp_f32 v176, v176
  v_rcp_f32 v177, v177
  v_rcp_f32 v180, v180
  buffer_load_dwordx4 v6, s[12:15], s75 offen offset:1024 lds
  v_rcp_f32 v181, v181
  v_pk_mul_f32 v[124:125], v[124:125], v[176:177]
  v_pk_mul_f32 v[126:127], v[126:127], v[180:181]
  v_pk_mul_f32 v[176:177], v[128:129], v[128:129]
  v_pk_mul_f32 v[180:181], v[130:131], v[130:131]
  v_pk_fma_f32 v[176:177], v[176:177], v[34:35], v[32:33]
  v_pk_fma_f32 v[180:181], v[180:181], v[34:35], v[32:33]
  v_pk_mul_f32 v[176:177], v[176:177], v[128:129]
  v_pk_mul_f32 v[180:181], v[180:181], v[130:131]
  v_exp_f32 v176, v176
  v_exp_f32 v177, v177
  v_exp_f32 v180, v180
  buffer_load_dwordx4 v7, s[12:15], s75 offen offset:2048 lds
  v_exp_f32 v181, v181
  v_pk_add_f32 v[176:177], v[176:177], v[36:37]
  v_pk_add_f32 v[180:181], v[180:181], v[36:37]
  v_rcp_f32 v176, v176
  v_rcp_f32 v177, v177
  v_rcp_f32 v180, v180
  v_rcp_f32 v181, v181
  v_pk_mul_f32 v[128:129], v[128:129], v[176:177]
  v_pk_mul_f32 v[130:131], v[130:131], v[180:181]
  v_pk_mul_f32 v[176:177], v[132:133], v[132:133]
  v_pk_mul_f32 v[180:181], v[134:135], v[134:135]
  v_pk_fma_f32 v[176:177], v[176:177], v[34:35], v[32:33]
  buffer_load_dwordx4 v8, s[12:15], s75 offen offset:3072 lds
  v_pk_fma_f32 v[180:181], v[180:181], v[34:35], v[32:33]
  v_pk_mul_f32 v[176:177], v[176:177], v[132:133]
  v_pk_mul_f32 v[180:181], v[180:181], v[134:135]
  v_exp_f32 v176, v176
  v_exp_f32 v177, v177
  v_exp_f32 v180, v180
  v_exp_f32 v181, v181
  v_pk_add_f32 v[176:177], v[176:177], v[36:37]
  v_pk_add_f32 v[180:181], v[180:181], v[36:37]
  v_rcp_f32 v176, v176
  v_rcp_f32 v177, v177
  v_rcp_f32 v180, v180
  s_add_u32 m0, s71, 32768
  s_add_u32 s75, s25, 458752
  buffer_load_dwordx4 v5, s[12:15], s75 offen offset:0 lds
  v_rcp_f32 v181, v181
  v_pk_mul_f32 v[132:133], v[132:133], v[176:177]
  v_pk_mul_f32 v[134:135], v[134:135], v[180:181]
  v_pk_mul_f32 v[176:177], v[136:137], v[136:137]
  v_pk_mul_f32 v[180:181], v[138:139], v[138:139]
  v_pk_fma_f32 v[176:177], v[176:177], v[34:35], v[32:33]
  v_pk_fma_f32 v[180:181], v[180:181], v[34:35], v[32:33]
  v_pk_mul_f32 v[176:177], v[176:177], v[136:137]
  v_pk_mul_f32 v[180:181], v[180:181], v[138:139]
  v_exp_f32 v176, v176
  v_exp_f32 v177, v177
  v_exp_f32 v180, v180
  buffer_load_dwordx4 v6, s[12:15], s75 offen offset:1024 lds
  v_exp_f32 v181, v181
  v_pk_add_f32 v[176:177], v[176:177], v[36:37]
  v_pk_add_f32 v[180:181], v[180:181], v[36:37]
  v_rcp_f32 v176, v176
  v_rcp_f32 v177, v177
  v_rcp_f32 v180, v180
  v_rcp_f32 v181, v181
  v_pk_mul_f32 v[136:137], v[136:137], v[176:177]
  v_pk_mul_f32 v[138:139], v[138:139], v[180:181]
  v_pk_mul_f32 v[176:177], v[140:141], v[140:141]
  v_pk_mul_f32 v[180:181], v[142:143], v[142:143]
  v_pk_fma_f32 v[176:177], v[176:177], v[34:35], v[32:33]
  buffer_load_dwordx4 v7, s[12:15], s75 offen offset:2048 lds
  v_pk_fma_f32 v[180:181], v[180:181], v[34:35], v[32:33]
  v_pk_mul_f32 v[176:177], v[176:177], v[140:141]
  v_pk_mul_f32 v[180:181], v[180:181], v[142:143]
  v_exp_f32 v176, v176
  v_exp_f32 v177, v177
  v_exp_f32 v180, v180
  v_exp_f32 v181, v181
  v_pk_add_f32 v[176:177], v[176:177], v[36:37]
  v_pk_add_f32 v[180:181], v[180:181], v[36:37]
  v_rcp_f32 v176, v176
  v_rcp_f32 v177, v177
  v_rcp_f32 v180, v180
  buffer_load_dwordx4 v8, s[12:15], s75 offen offset:3072 lds
  v_rcp_f32 v181, v181
  v_pk_mul_f32 v[140:141], v[140:141], v[176:177]
  v_pk_mul_f32 v[142:143], v[142:143], v[180:181]
  v_pk_mul_f32 v[176:177], v[144:145], v[144:145]
  v_pk_mul_f32 v[180:181], v[146:147], v[146:147]
  v_pk_fma_f32 v[176:177], v[176:177], v[34:35], v[32:33]
  v_pk_fma_f32 v[180:181], v[180:181], v[34:35], v[32:33]
  v_pk_mul_f32 v[176:177], v[176:177], v[144:145]
  v_pk_mul_f32 v[180:181], v[180:181], v[146:147]
  v_exp_f32 v176, v176
  v_exp_f32 v177, v177
  v_exp_f32 v180, v180
  s_add_u32 m0, s71, 49152
  s_add_u32 s75, s25, 688128
  buffer_load_dwordx4 v5, s[12:15], s75 offen offset:0 lds
  v_exp_f32 v181, v181
  v_pk_add_f32 v[176:177], v[176:177], v[36:37]
  v_pk_add_f32 v[180:181], v[180:181], v[36:37]
  v_rcp_f32 v176, v176
  v_rcp_f32 v177, v177
  v_rcp_f32 v180, v180
  v_rcp_f32 v181, v181
  v_pk_mul_f32 v[144:145], v[144:145], v[176:177]
  v_pk_mul_f32 v[146:147], v[146:147], v[180:181]
  v_pk_mul_f32 v[176:177], v[148:149], v[148:149]
  v_pk_mul_f32 v[180:181], v[150:151], v[150:151]
  v_pk_fma_f32 v[176:177], v[176:177], v[34:35], v[32:33]
  buffer_load_dwordx4 v6, s[12:15], s75 offen offset:1024 lds
  v_pk_fma_f32 v[180:181], v[180:181], v[34:35], v[32:33]
  v_pk_mul_f32 v[176:177], v[176:177], v[148:149]
  v_pk_mul_f32 v[180:181], v[180:181], v[150:151]
  v_exp_f32 v176, v176
  v_exp_f32 v177, v177
  v_exp_f32 v180, v180
  v_exp_f32 v181, v181
  v_pk_add_f32 v[176:177], v[176:177], v[36:37]
  v_pk_add_f32 v[180:181], v[180:181], v[36:37]
  v_rcp_f32 v176, v176
  v_rcp_f32 v177, v177
  v_rcp_f32 v180, v180
  buffer_load_dwordx4 v7, s[12:15], s75 offen offset:2048 lds
  v_rcp_f32 v181, v181
  v_pk_mul_f32 v[148:149], v[148:149], v[176:177]
  v_pk_mul_f32 v[150:151], v[150:151], v[180:181]
  v_pk_mul_f32 v[176:177], v[152:153], v[152:153]
  v_pk_mul_f32 v[180:181], v[154:155], v[154:155]
  v_pk_fma_f32 v[176:177], v[176:177], v[34:35], v[32:33]
  v_pk_fma_f32 v[180:181], v[180:181], v[34:35], v[32:33]
  v_pk_mul_f32 v[176:177], v[176:177], v[152:153]
  v_pk_mul_f32 v[180:181], v[180:181], v[154:155]
  v_exp_f32 v176, v176
  v_exp_f32 v177, v177
  v_exp_f32 v180, v180
  buffer_load_dwordx4 v8, s[12:15], s75 offen offset:3072 lds
  v_exp_f32 v181, v181
  v_pk_add_f32 v[176:177], v[176:177], v[36:37]
  v_pk_add_f32 v[180:181], v[180:181], v[36:37]
  v_rcp_f32 v176, v176
  v_rcp_f32 v177, v177
  v_rcp_f32 v180, v180
  v_rcp_f32 v181, v181
  v_pk_mul_f32 v[152:153], v[152:153], v[176:177]
  v_pk_mul_f32 v[154:155], v[154:155], v[180:181]
  v_pk_mul_f32 v[176:177], v[156:157], v[156:157]
  v_pk_mul_f32 v[180:181], v[158:159], v[158:159]
  v_pk_fma_f32 v[176:177], v[176:177], v[34:35], v[32:33]
  s_add_u32 m0, s71, 65536
  s_add_u32 s75, s25, 917504
  buffer_load_dwordx4 v5, s[12:15], s75 offen offset:0 lds
  v_pk_fma_f32 v[180:181], v[180:181], v[34:35], v[32:33]
  v_pk_mul_f32 v[176:177], v[176:177], v[156:157]
  v_pk_mul_f32 v[180:181], v[180:181], v[158:159]
  v_exp_f32 v176, v176
  v_exp_f32 v177, v177
  v_exp_f32 v180, v180
  v_exp_f32 v181, v181
  v_pk_add_f32 v[176:177], v[176:177], v[36:37]
  v_pk_add_f32 v[180:181], v[180:181], v[36:37]
  v_rcp_f32 v176, v176
  v_rcp_f32 v177, v177
  v_rcp_f32 v180, v180
  buffer_load_dwordx4 v6, s[12:15], s75 offen offset:1024 lds
  v_rcp_f32 v181, v181
  v_pk_mul_f32 v[156:157], v[156:157], v[176:177]
  v_pk_mul_f32 v[158:159], v[158:159], v[180:181]
  v_pk_mul_f32 v[176:177], v[160:161], v[160:161]
  v_pk_mul_f32 v[180:181], v[162:163], v[162:163]
  v_pk_fma_f32 v[176:177], v[176:177], v[34:35], v[32:33]
  v_pk_fma_f32 v[180:181], v[180:181], v[34:35], v[32:33]
  v_pk_mul_f32 v[176:177], v[176:177], v[160:161]
  v_pk_mul_f32 v[180:181], v[180:181], v[162:163]
  v_exp_f32 v176, v176
  v_exp_f32 v177, v177
  v_exp_f32 v180, v180
  buffer_load_dwordx4 v7, s[12:15], s75 offen offset:2048 lds
  v_exp_f32 v181, v181
  v_pk_add_f32 v[176:177], v[176:177], v[36:37]
  v_pk_add_f32 v[180:181], v[180:181], v[36:37]
  v_rcp_f32 v176, v176
  v_rcp_f32 v177, v177
  v_rcp_f32 v180, v180
  v_rcp_f32 v181, v181
  v_pk_mul_f32 v[160:161], v[160:161], v[176:177]
  v_pk_mul_f32 v[162:163], v[162:163], v[180:181]
  v_pk_mul_f32 v[176:177], v[164:165], v[164:165]
  v_pk_mul_f32 v[180:181], v[166:167], v[166:167]
  v_pk_fma_f32 v[176:177], v[176:177], v[34:35], v[32:33]
  buffer_load_dwordx4 v8, s[12:15], s75 offen offset:3072 lds
  v_pk_fma_f32 v[180:181], v[180:181], v[34:35], v[32:33]
  v_pk_mul_f32 v[176:177], v[176:177], v[164:165]
  v_pk_mul_f32 v[180:181], v[180:181], v[166:167]
  v_exp_f32 v176, v176
  v_exp_f32 v177, v177
  v_exp_f32 v180, v180
  v_exp_f32 v181, v181
  v_pk_add_f32 v[176:177], v[176:177], v[36:37]
  v_pk_add_f32 v[180:181], v[180:181], v[36:37]
  v_rcp_f32 v176, v176
  v_rcp_f32 v177, v177
  v_rcp_f32 v180, v180
  s_add_u32 m0, s71, 81920
  s_add_u32 s75, s25, 1146880
  buffer_load_dwordx4 v5, s[12:15], s75 offen offset:0 lds
  v_rcp_f32 v181, v181
  v_pk_mul_f32 v[164:165], v[164:165], v[176:177]
  v_pk_mul_f32 v[166:167], v[166:167], v[180:181]
  v_pk_mul_f32 v[176:177], v[168:169], v[168:169]
  v_pk_mul_f32 v[180:181], v[170:171], v[170:171]
  v_pk_fma_f32 v[176:177], v[176:177], v[34:35], v[32:33]
  v_pk_fma_f32 v[180:181], v[180:181], v[34:35], v[32:33]
  v_pk_mul_f32 v[176:177], v[176:177], v[168:169]
  v_pk_mul_f32 v[180:181], v[180:181], v[170:171]
  v_exp_f32 v176, v176
  v_exp_f32 v177, v177
  v_exp_f32 v180, v180
  buffer_load_dwordx4 v6, s[12:15], s75 offen offset:1024 lds
  v_exp_f32 v181, v181
  v_pk_add_f32 v[176:177], v[176:177], v[36:37]
  v_pk_add_f32 v[180:181], v[180:181], v[36:37]
  v_rcp_f32 v176, v176
  v_rcp_f32 v177, v177
  v_rcp_f32 v180, v180
  v_rcp_f32 v181, v181
  v_pk_mul_f32 v[168:169], v[168:169], v[176:177]
  v_pk_mul_f32 v[170:171], v[170:171], v[180:181]
  v_pk_mul_f32 v[176:177], v[172:173], v[172:173]
  v_pk_mul_f32 v[180:181], v[174:175], v[174:175]
  v_pk_fma_f32 v[176:177], v[176:177], v[34:35], v[32:33]
  buffer_load_dwordx4 v7, s[12:15], s75 offen offset:2048 lds
  v_pk_fma_f32 v[180:181], v[180:181], v[34:35], v[32:33]
  v_pk_mul_f32 v[176:177], v[176:177], v[172:173]
  v_pk_mul_f32 v[180:181], v[180:181], v[174:175]
  v_exp_f32 v176, v176
  v_exp_f32 v177, v177
  v_exp_f32 v180, v180
  v_exp_f32 v181, v181
  v_pk_add_f32 v[176:177], v[176:177], v[36:37]
  v_pk_add_f32 v[180:181], v[180:181], v[36:37]
  v_rcp_f32 v176, v176
  v_rcp_f32 v177, v177
  v_rcp_f32 v180, v180
  buffer_load_dwordx4 v8, s[12:15], s75 offen offset:3072 lds
  v_rcp_f32 v181, v181
  v_pk_mul_f32 v[172:173], v[172:173], v[176:177]
  v_pk_mul_f32 v[174:175], v[174:175], v[180:181]
  v_pk_add_f32 v[192:193], v[120:121], v[128:129]
  v_pk_add_f32 v[192:193], v[192:193], v[136:137]
  v_pk_add_f32 v[192:193], v[192:193], v[144:145]
  v_pk_add_f32 v[192:193], v[192:193], v[152:153]
  v_pk_add_f32 v[192:193], v[192:193], v[160:161]
  v_pk_add_f32 v[192:193], v[192:193], v[168:169]
  v_pk_add_f32 v[194:195], v[122:123], v[130:131]
  v_pk_add_f32 v[194:195], v[194:195], v[138:139]
  v_pk_add_f32 v[194:195], v[194:195], v[146:147]
  s_add_u32 m0, s71, 98304
  s_add_u32 s75, s25, 1376256
  buffer_load_dwordx4 v5, s[12:15], s75 offen offset:0 lds
  v_pk_add_f32 v[194:195], v[194:195], v[154:155]
  v_pk_add_f32 v[194:195], v[194:195], v[162:163]
  v_pk_add_f32 v[194:195], v[194:195], v[170:171]
  v_pk_add_f32 v[196:197], v[124:125], v[132:133]
  v_pk_add_f32 v[196:197], v[196:197], v[140:141]
  v_pk_add_f32 v[196:197], v[196:197], v[148:149]
  v_pk_add_f32 v[196:197], v[196:197], v[156:157]
  v_pk_add_f32 v[196:197], v[196:197], v[164:165]
  v_pk_add_f32 v[196:197], v[196:197], v[172:173]
  v_pk_add_f32 v[198:199], v[126:127], v[134:135]
  v_pk_add_f32 v[198:199], v[198:199], v[142:143]
  v_pk_add_f32 v[198:199], v[198:199], v[150:151]
  buffer_load_dwordx4 v6, s[12:15], s75 offen offset:1024 lds
  v_pk_add_f32 v[198:199], v[198:199], v[158:159]
  v_pk_add_f32 v[198:199], v[198:199], v[166:167]
  v_pk_add_f32 v[198:199], v[198:199], v[174:175]
  v_add_f32_dpp v192, v192, v192 row_ror:8 row_mask:0xf bank_mask:0xf
  v_add_f32_dpp v193, v193, v193 row_ror:8 row_mask:0xf bank_mask:0xf
  v_add_f32_dpp v194, v194, v194 row_ror:8 row_mask:0xf bank_mask:0xf
  v_add_f32_dpp v195, v195, v195 row_ror:8 row_mask:0xf bank_mask:0xf
  v_add_f32_dpp v196, v196, v196 row_ror:8 row_mask:0xf bank_mask:0xf
  v_add_f32_dpp v197, v197, v197 row_ror:8 row_mask:0xf bank_mask:0xf
  v_add_f32_dpp v198, v198, v198 row_ror:8 row_mask:0xf bank_mask:0xf
  v_add_f32_dpp v199, v199, v199 row_ror:8 row_mask:0xf bank_mask:0xf
  v_add_f32_dpp v192, v192, v192 row_ror:4 row_mask:0xf bank_mask:0xf
  buffer_load_dwordx4 v7, s[12:15], s75 offen offset:2048 lds
  v_add_f32_dpp v193, v193, v193 row_ror:4 row_mask:0xf bank_mask:0xf
  v_add_f32_dpp v194, v194, v194 row_ror:4 row_mask:0xf bank_mask:0xf
  v_add_f32_dpp v195, v195, v195 row_ror:4 row_mask:0xf bank_mask:0xf
  v_add_f32_dpp v196, v196, v196 row_ror:4 row_mask:0xf bank_mask:0xf
  v_add_f32_dpp v197, v197, v197 row_ror:4 row_mask:0xf bank_mask:0xf
  v_add_f32_dpp v198, v198, v198 row_ror:4 row_mask:0xf bank_mask:0xf
  v_add_f32_dpp v199, v199, v199 row_ror:4 row_mask:0xf bank_mask:0xf
  v_add_f32_dpp v192, v192, v192 row_ror:2 row_mask:0xf bank_mask:0xf
  v_add_f32_dpp v193, v193, v193 row_ror:2 row_mask:0xf bank_mask:0xf
  v_add_f32_dpp v194, v194, v194 row_ror:2 row_mask:0xf bank_mask:0xf
  v_add_f32_dpp v195, v195, v195 row_ror:2 row_mask:0xf bank_mask:0xf
  v_add_f32_dpp v196, v196, v196 row_ror:2 row_mask:0xf bank_mask:0xf
  buffer_load_dwordx4 v8, s[12:15], s75 offen offset:3072 lds
  v_add_f32_dpp v197, v197, v197 row_ror:2 row_mask:0xf bank_mask:0xf
  v_add_f32_dpp v198, v198, v198 row_ror:2 row_mask:0xf bank_mask:0xf
  v_add_f32_dpp v199, v199, v199 row_ror:2 row_mask:0xf bank_mask:0xf
  v_add_f32_dpp v192, v192, v192 row_ror:1 row_mask:0xf bank_mask:0xf
  v_add_f32_dpp v193, v193, v193 row_ror:1 row_mask:0xf bank_mask:0xf
  v_add_f32_dpp v194, v194, v194 row_ror:1 row_mask:0xf bank_mask:0xf
  v_add_f32_dpp v195, v195, v195 row_ror:1 row_mask:0xf bank_mask:0xf
  v_add_f32_dpp v196, v196, v196 row_ror:1 row_mask:0xf bank_mask:0xf
  v_add_f32_dpp v197, v197, v197 row_ror:1 row_mask:0xf bank_mask:0xf
  v_add_f32_dpp v198, v198, v198 row_ror:1 row_mask:0xf bank_mask:0xf
  v_add_f32_dpp v199, v199, v199 row_ror:1 row_mask:0xf bank_mask:0xf
  v_mov_b32 v38, 0x3c124925
  v_mov_b32 v39, 0x3c124925
  v_pk_mul_f32 v[192:193], v[192:193], v[38:39]
  v_pk_mul_f32 v[194:195], v[194:195], v[38:39]
  v_pk_mul_f32 v[196:197], v[196:197], v[38:39]
  v_pk_mul_f32 v[198:199], v[198:199], v[38:39]
  v_pk_add_f32 v[176:177], v[120:121], v[192:193] neg_lo:[0,1] neg_hi:[0,1]
  v_pk_mul_f32 v[200:201], v[176:177], v[176:177]
  v_pk_add_f32 v[178:179], v[128:129], v[192:193] neg_lo:[0,1] neg_hi:[0,1]
  v_pk_fma_f32 v[200:201], v[178:179], v[178:179], v[200:201]
  v_pk_add_f32 v[176:177], v[136:137], v[192:193] neg_lo:[0,1] neg_hi:[0,1]
  v_pk_fma_f32 v[200:201], v[176:177], v[176:177], v[200:201]
  v_pk_add_f32 v[178:179], v[144:145], v[192:193] neg_lo:[0,1] neg_hi:[0,1]
  v_pk_fma_f32 v[200:201], v[178:179], v[178:179], v[200:201]
  v_pk_add_f32 v[176:177], v[152:153], v[192:193] neg_lo:[0,1] neg_hi:[0,1]
  v_pk_fma_f32 v[200:201], v[176:177], v[176:177], v[200:201]
  v_pk_add_f32 v[178:179], v[160:161], v[192:193] neg_lo:[0,1] neg_hi:[0,1]
  v_pk_fma_f32 v[200:201], v[178:179], v[178:179], v[200:201]
  v_pk_add_f32 v[176:177], v[168:169], v[192:193] neg_lo:[0,1] neg_hi:[0,1]
  v_pk_fma_f32 v[200:201], v[176:177], v[176:177], v[200:201]
  v_pk_add_f32 v[176:177], v[122:123], v[194:195] neg_lo:[0,1] neg_hi:[0,1]
  v_pk_mul_f32 v[202:203], v[176:177], v[176:177]
  v_pk_add_f32 v[178:179], v[130:131], v[194:195] neg_lo:[0,1] neg_hi:[0,1]
  v_pk_fma_f32 v[202:203], v[178:179], v[178:179], v[202:203]
  v_pk_add_f32 v[176:177], v[138:139], v[194:195] neg_lo:[0,1] neg_hi:[0,1]
  v_pk_fma_f32 v[202:203], v[176:177], v[176:177], v[202:203]
  v_pk_add_f32 v[178:179], v[146:147], v[194:195] neg_lo:[0,1] neg_hi:[0,1]
  v_pk_fma_f32 v[202:203], v[178:179], v[178:179], v[202:203]
  v_pk_add_f32 v[176:177], v[154:155], v[194:195] neg_lo:[0,1] neg_hi:[0,1]
  v_pk_fma_f32 v[202:203], v[176:177], v[176:177], v[202:203]
  v_pk_add_f32 v[178:179], v[162:163], v[194:195] neg_lo:[0,1] neg_hi:[0,1]
  v_pk_fma_f32 v[202:203], v[178:179], v[178:179], v[202:203]
  v_pk_add_f32 v[176:177], v[170:171], v[194:195] neg_lo:[0,1] neg_hi:[0,1]
  v_pk_fma_f32 v[202:203], v[176:177], v[176:177], v[202:203]
  v_pk_add_f32 v[176:177], v[124:125], v[196:197] neg_lo:[0,1] neg_hi:[0,1]
  v_pk_mul_f32 v[204:205], v[176:177], v[176:177]
  v_pk_add_f32 v[178:179], v[132:133], v[196:197] neg_lo:[0,1] neg_hi:[0,1]
  v_pk_fma_f32 v[204:205], v[178:179], v[178:179], v[204:205]
  v_pk_add_f32 v[176:177], v[140:141], v[196:197] neg_lo:[0,1] neg_hi:[0,1]
  v_pk_fma_f32 v[204:205], v[176:177], v[176:177], v[204:205]
  v_pk_add_f32 v[178:179], v[148:149], v[196:197] neg_lo:[0,1] neg_hi:[0,1]
  v_pk_fma_f32 v[204:205], v[178:179], v[178:179], v[204:205]
  v_pk_add_f32 v[176:177], v[156:157], v[196:197] neg_lo:[0,1] neg_hi:[0,1]
  v_pk_fma_f32 v[204:205], v[176:177], v[176:177], v[204:205]
  v_pk_add_f32 v[178:179], v[164:165], v[196:197] neg_lo:[0,1] neg_hi:[0,1]
  v_pk_fma_f32 v[204:205], v[178:179], v[178:179], v[204:205]
  v_pk_add_f32 v[176:177], v[172:173], v[196:197] neg_lo:[0,1] neg_hi:[0,1]
  v_pk_fma_f32 v[204:205], v[176:177], v[176:177], v[204:205]
  v_pk_add_f32 v[176:177], v[126:127], v[198:199] neg_lo:[0,1] neg_hi:[0,1]
  v_pk_mul_f32 v[206:207], v[176:177], v[176:177]
  v_pk_add_f32 v[178:179], v[134:135], v[198:199] neg_lo:[0,1] neg_hi:[0,1]
  v_pk_fma_f32 v[206:207], v[178:179], v[178:179], v[206:207]
  v_pk_add_f32 v[176:177], v[142:143], v[198:199] neg_lo:[0,1] neg_hi:[0,1]
  v_pk_fma_f32 v[206:207], v[176:177], v[176:177], v[206:207]
  v_pk_add_f32 v[178:179], v[150:151], v[198:199] neg_lo:[0,1] neg_hi:[0,1]
  v_pk_fma_f32 v[206:207], v[178:179], v[178:179], v[206:207]
  v_pk_add_f32 v[176:177], v[158:159], v[198:199] neg_lo:[0,1] neg_hi:[0,1]
  v_pk_fma_f32 v[206:207], v[176:177], v[176:177], v[206:207]
  v_pk_add_f32 v[178:179], v[166:167], v[198:199] neg_lo:[0,1] neg_hi:[0,1]
  v_pk_fma_f32 v[206:207], v[178:179], v[178:179], v[206:207]
  v_pk_add_f32 v[176:177], v[174:175], v[198:199] neg_lo:[0,1] neg_hi:[0,1]
  v_pk_fma_f32 v[206:207], v[176:177], v[176:177], v[206:207]
  v_add_f32_dpp v200, v200, v200 row_ror:8 row_mask:0xf bank_mask:0xf
  v_add_f32_dpp v201, v201, v201 row_ror:8 row_mask:0xf bank_mask:0xf
  v_add_f32_dpp v202, v202, v202 row_ror:8 row_mask:0xf bank_mask:0xf
  v_add_f32_dpp v203, v203, v203 row_ror:8 row_mask:0xf bank_mask:0xf
  v_add_f32_dpp v204, v204, v204 row_ror:8 row_mask:0xf bank_mask:0xf
  v_add_f32_dpp v205, v205, v205 row_ror:8 row_mask:0xf bank_mask:0xf
  v_add_f32_dpp v206, v206, v206 row_ror:8 row_mask:0xf bank_mask:0xf
  v_add_f32_dpp v207, v207, v207 row_ror:8 row_mask:0xf bank_mask:0xf
  v_add_f32_dpp v200, v200, v200 row_ror:4 row_mask:0xf bank_mask:0xf
  v_add_f32_dpp v201, v201, v201 row_ror:4 row_mask:0xf bank_mask:0xf
  v_add_f32_dpp v202, v202, v202 row_ror:4 row_mask:0xf bank_mask:0xf
  v_add_f32_dpp v203, v203, v203 row_ror:4 row_mask:0xf bank_mask:0xf
  v_add_f32_dpp v204, v204, v204 row_ror:4 row_mask:0xf bank_mask:0xf
  v_add_f32_dpp v205, v205, v205 row_ror:4 row_mask:0xf bank_mask:0xf
  v_add_f32_dpp v206, v206, v206 row_ror:4 row_mask:0xf bank_mask:0xf
  v_add_f32_dpp v207, v207, v207 row_ror:4 row_mask:0xf bank_mask:0xf
  v_add_f32_dpp v200, v200, v200 row_ror:2 row_mask:0xf bank_mask:0xf
  v_add_f32_dpp v201, v201, v201 row_ror:2 row_mask:0xf bank_mask:0xf
  v_add_f32_dpp v202, v202, v202 row_ror:2 row_mask:0xf bank_mask:0xf
  v_add_f32_dpp v203, v203, v203 row_ror:2 row_mask:0xf bank_mask:0xf
  v_add_f32_dpp v204, v204, v204 row_ror:2 row_mask:0xf bank_mask:0xf
  v_add_f32_dpp v205, v205, v205 row_ror:2 row_mask:0xf bank_mask:0xf
  v_add_f32_dpp v206, v206, v206 row_ror:2 row_mask:0xf bank_mask:0xf
  v_add_f32_dpp v207, v207, v207 row_ror:2 row_mask:0xf bank_mask:0xf
  v_add_f32_dpp v200, v200, v200 row_ror:1 row_mask:0xf bank_mask:0xf
  v_add_f32_dpp v201, v201, v201 row_ror:1 row_mask:0xf bank_mask:0xf
  v_add_f32_dpp v202, v202, v202 row_ror:1 row_mask:0xf bank_mask:0xf
  v_add_f32_dpp v203, v203, v203 row_ror:1 row_mask:0xf bank_mask:0xf
  v_add_f32_dpp v204, v204, v204 row_ror:1 row_mask:0xf bank_mask:0xf
  v_add_f32_dpp v205, v205, v205 row_ror:1 row_mask:0xf bank_mask:0xf
  v_add_f32_dpp v206, v206, v206 row_ror:1 row_mask:0xf bank_mask:0xf
  v_add_f32_dpp v207, v207, v207 row_ror:1 row_mask:0xf bank_mask:0xf
  v_and_b32 v16, 3, v13
  v_cmp_eq_u32 s[26:27], 1, v16
  v_cmp_eq_u32 s[28:29], 2, v16
  v_cmp_eq_u32 s[30:31], 3, v16
  v_mov_b32 v208, v192
  v_cndmask_b32 v208, v208, v194, s[26:27]
  v_cndmask_b32 v208, v208, v196, s[28:29]
  v_cndmask_b32 v208, v208, v198, s[30:31]
  v_mov_b32 v209, v200
  v_cndmask_b32 v209, v209, v202, s[26:27]
  v_cndmask_b32 v209, v209, v204, s[28:29]
  v_cndmask_b32 v209, v209, v206, s[30:31]
  v_mov_b32 v210, v193
  v_cndmask_b32 v210, v210, v195, s[26:27]
  v_cndmask_b32 v210, v210, v197, s[28:29]
  v_cndmask_b32 v210, v210, v199, s[30:31]
  v_mov_b32 v211, v201
  v_cndmask_b32 v211, v211, v203, s[26:27]
  v_cndmask_b32 v211, v211, v205, s[28:29]
  v_cndmask_b32 v211, v211, v207, s[30:31]
  s_lshl_b32 s23, s20, 3
  s_add_u32 s23, s23, s21
  s_lshl_b32 s23, s23, 7
  s_lshl_b32 s27, s3, 5
  s_add_u32 s23, s23, s27
  s_lshl_b32 s23, s23, 3
  s_mov_b32 s27, 14376960
  s_add_u32 s16, s58, s27
  s_addc_u32 s17, s59, 0
  s_and_b32 s17, s17, 0xffff
  s_mov_b32 s18, 131072
  s_mov_b32 s19, 0x20000
  v_lshlrev_b32 v19, 6, v14
  v_lshl_add_u32 v19, v16, 4, v19
  s_mov_b64 s[34:35], exec
  s_mov_b32 exec_lo, 0x000f000f
  s_mov_b32 exec_hi, 0x000f000f
  buffer_store_dwordx4 v[208:211], v19, s[16:19], s23 offen sc1
  s_mov_b64 exec, s[34:35]
  v_mov_b32 v9, 16
  global_load_dwordx2 v[10:11], v9, s[56:57] sc1
  s_waitcnt vmcnt(2)
  s_barrier
  v_subrev_u32 v24, 114688, v24
  v_subrev_u32 v25, 114688, v25
  v_subrev_u32 v26, 114688, v26
  v_subrev_u32 v27, 114688, v27
  v_subrev_u32 v28, 114688, v28
  v_subrev_u32 v29, 114688, v29
  v_subrev_u32 v30, 114688, v30
  ds_read_b64_tr_b16 v[176:177], v24 offset:0
  ds_read_b64_tr_b16 v[178:179], v24 offset:1024
  ds_read_b64_tr_b16 v[180:181], v25 offset:0
  ds_read_b64_tr_b16 v[182:183], v25 offset:1024
  ds_read_b64_tr_b16 v[184:185], v26 offset:0
  ds_read_b64_tr_b16 v[186:187], v26 offset:1024
  ds_read_b64_tr_b16 v[188:189], v27 offset:0
  ds_read_b64_tr_b16 v[190:191], v27 offset:1024
  ds_read_b64_tr_b16 v[192:193], v28 offset:0
  ds_read_b64_tr_b16 v[194:195], v28 offset:1024
  ds_read_b64_tr_b16 v[196:197], v29 offset:0
  ds_read_b64_tr_b16 v[198:199], v29 offset:1024
  ds_read_b64_tr_b16 v[200:201], v30 offset:0
  ds_read_b64_tr_b16 v[202:203], v30 offset:1024
  s_waitcnt lgkmcnt(0)
  v_mfma_f32_16x16x32_bf16 v[64:67], v[176:179], a[144:147], 0
  ds_read_b64_tr_b16 v[204:205], v24 offset:8192
  ds_read_b64_tr_b16 v[206:207], v24 offset:9216
  v_mfma_f32_16x16x32_bf16 v[68:71], v[176:179], a[148:151], 0
  ds_read_b64_tr_b16 v[208:209], v25 offset:8192
  ds_read_b64_tr_b16 v[210:211], v25 offset:9216
  v_mfma_f32_16x16x32_bf16 v[72:75], v[180:183], a[144:147], 0
  s_add_u32 m0, s74, 0
  s_add_u32 s70, s68, 0
  buffer_load_dwordx4 v232, s[60:63], s70 offen offset:0 lds
  ds_read_b64_tr_b16 v[212:213], v26 offset:8192
  ds_read_b64_tr_b16 v[214:215], v26 offset:9216
  v_mfma_f32_16x16x32_bf16 v[76:79], v[180:183], a[148:151], 0
  ds_read_b64_tr_b16 v[216:217], v27 offset:8192
  ds_read_b64_tr_b16 v[218:219], v27 offset:9216
  v_mfma_f32_16x16x32_bf16 v[80:83], v[184:187], a[144:147], 0
  ds_read_b64_tr_b16 v[220:221], v28 offset:8192
  ds_read_b64_tr_b16 v[222:223], v28 offset:9216
  v_mfma_f32_16x16x32_bf16 v[84:87], v[184:187], a[148:151], 0
  buffer_load_dwordx4 v233, s[60:63], s70 offen offset:1024 lds
  ds_read_b64_tr_b16 v[224:225], v29 offset:8192
  ds_read_b64_tr_b16 v[226:227], v29 offset:9216
  v_mfma_f32_16x16x32_bf16 v[88:91], v[188:191], a[144:147], 0
  ds_read_b64_tr_b16 v[228:229], v30 offset:8192
  ds_read_b64_tr_b16 v[230:231], v30 offset:9216
  v_mfma_f32_16x16x32_bf16 v[92:95], v[188:191], a[148:151], 0
  v_mfma_f32_16x16x32_bf16 v[96:99], v[192:195], a[144:147], 0
  buffer_load_dwordx4 v234, s[60:63], s70 offen offset:2048 lds
  v_mfma_f32_16x16x32_bf16 v[100:103], v[192:195], a[148:151], 0
  v_mfma_f32_16x16x32_bf16 v[104:107], v[196:199], a[144:147], 0
  v_mfma_f32_16x16x32_bf16 v[108:111], v[196:199], a[148:151], 0
  buffer_load_dwordx4 v235, s[60:63], s70 offen offset:3072 lds
  v_mfma_f32_16x16x32_bf16 v[112:115], v[200:203], a[144:147], 0
  v_mfma_f32_16x16x32_bf16 v[116:119], v[200:203], a[148:151], 0
  s_waitcnt lgkmcnt(0)
  v_mfma_f32_16x16x32_bf16 v[64:67], v[204:207], a[152:155], v[64:67]
  ds_read_b64_tr_b16 v[176:177], v24 offset:16384
  ds_read_b64_tr_b16 v[178:179], v24 offset:17408
  v_mfma_f32_16x16x32_bf16 v[68:71], v[204:207], a[156:159], v[68:71]
  ds_read_b64_tr_b16 v[180:181], v25 offset:16384
  ds_read_b64_tr_b16 v[182:183], v25 offset:17408
  v_mfma_f32_16x16x32_bf16 v[72:75], v[208:211], a[152:155], v[72:75]
  ds_read_b64_tr_b16 v[184:185], v26 offset:16384
  ds_read_b64_tr_b16 v[186:187], v26 offset:17408
  v_mfma_f32_16x16x32_bf16 v[76:79], v[208:211], a[156:159], v[76:79]
  ds_read_b64_tr_b16 v[188:189], v27 offset:16384
  ds_read_b64_tr_b16 v[190:191], v27 offset:17408
  v_mfma_f32_16x16x32_bf16 v[80:83], v[212:215], a[152:155], v[80:83]
  ds_read_b64_tr_b16 v[192:193], v28 offset:16384
  ds_read_b64_tr_b16 v[194:195], v28 offset:17408
  v_mfma_f32_16x16x32_bf16 v[84:87], v[212:215], a[156:159], v[84:87]
  ds_read_b64_tr_b16 v[196:197], v29 offset:16384
  ds_read_b64_tr_b16 v[198:199], v29 offset:17408
  v_mfma_f32_16x16x32_bf16 v[88:91], v[216:219], a[152:155], v[88:91]
  ds_read_b64_tr_b16 v[200:201], v30 offset:16384
  ds_read_b64_tr_b16 v[202:203], v30 offset:17408
  v_mfma_f32_16x16x32_bf16 v[92:95], v[216:219], a[156:159], v[92:95]
  v_mfma_f32_16x16x32_bf16 v[96:99], v[220:223], a[152:155], v[96:99]
  v_mfma_f32_16x16x32_bf16 v[100:103], v[220:223], a[156:159], v[100:103]
  v_mfma_f32_16x16x32_bf16 v[104:107], v[224:227], a[152:155], v[104:107]
  v_mfma_f32_16x16x32_bf16 v[108:111], v[224:227], a[156:159], v[108:111]
  v_mfma_f32_16x16x32_bf16 v[112:115], v[228:231], a[152:155], v[112:115]
  v_mfma_f32_16x16x32_bf16 v[116:119], v[228:231], a[156:159], v[116:119]
  s_waitcnt lgkmcnt(0)
  v_mfma_f32_16x16x32_bf16 v[64:67], v[176:179], a[160:163], v[64:67]
  ds_read_b64_tr_b16 v[204:205], v24 offset:24576
  ds_read_b64_tr_b16 v[206:207], v24 offset:25600
  v_mfma_f32_16x16x32_bf16 v[68:71], v[176:179], a[164:167], v[68:71]
  ds_read_b64_tr_b16 v[208:209], v25 offset:24576
  ds_read_b64_tr_b16 v[210:211], v25 offset:25600
  v_mfma_f32_16x16x32_bf16 v[72:75], v[180:183], a[160:163], v[72:75]
  s_add_u32 m0, s74, 4096
  s_add_u32 s70, s69, 0
  buffer_load_dwordx4 v232, s[60:63], s70 offen offset:0 lds
  ds_read_b64_tr_b16 v[212:213], v26 offset:24576
  ds_read_b64_tr_b16 v[214:215], v26 offset:25600
  v_mfma_f32_16x16x32_bf16 v[76:79], v[180:183], a[164:167], v[76:79]
  ds_read_b64_tr_b16 v[216:217], v27 offset:24576
  ds_read_b64_tr_b16 v[218:219], v27 offset:25600
  v_mfma_f32_16x16x32_bf16 v[80:83], v[184:187], a[160:163], v[80:83]
  ds_read_b64_tr_b16 v[220:221], v28 offset:24576
  ds_read_b64_tr_b16 v[222:223], v28 offset:25600
  v_mfma_f32_16x16x32_bf16 v[84:87], v[184:187], a[164:167], v[84:87]
  buffer_load_dwordx4 v233, s[60:63], s70 offen offset:1024 lds
  ds_read_b64_tr_b16 v[224:225], v29 offset:24576
  ds_read_b64_tr_b16 v[226:227], v29 offset:25600
  v_mfma_f32_16x16x32_bf16 v[88:91], v[188:191], a[160:163], v[88:91]
  ds_read_b64_tr_b16 v[228:229], v30 offset:24576
  ds_read_b64_tr_b16 v[230:231], v30 offset:25600
  v_mfma_f32_16x16x32_bf16 v[92:95], v[188:191], a[164:167], v[92:95]
  v_mfma_f32_16x16x32_bf16 v[96:99], v[192:195], a[160:163], v[96:99]
  buffer_load_dwordx4 v234, s[60:63], s70 offen offset:2048 lds
  v_mfma_f32_16x16x32_bf16 v[100:103], v[192:195], a[164:167], v[100:103]
  v_mfma_f32_16x16x32_bf16 v[104:107], v[196:199], a[160:163], v[104:107]
  v_mfma_f32_16x16x32_bf16 v[108:111], v[196:199], a[164:167], v[108:111]
  buffer_load_dwordx4 v235, s[60:63], s70 offen offset:3072 lds
  v_mfma_f32_16x16x32_bf16 v[112:115], v[200:203], a[160:163], v[112:115]
  v_mfma_f32_16x16x32_bf16 v[116:119], v[200:203], a[164:167], v[116:119]
  s_waitcnt lgkmcnt(0)
  v_mfma_f32_16x16x32_bf16 v[64:67], v[204:207], a[168:171], v[64:67]
  ds_read_b64_tr_b16 v[176:177], v24 offset:32768
  ds_read_b64_tr_b16 v[178:179], v24 offset:33792
  v_mfma_f32_16x16x32_bf16 v[68:71], v[204:207], a[172:175], v[68:71]
  ds_read_b64_tr_b16 v[180:181], v25 offset:32768
  ds_read_b64_tr_b16 v[182:183], v25 offset:33792
  v_mfma_f32_16x16x32_bf16 v[72:75], v[208:211], a[168:171], v[72:75]
  ds_read_b64_tr_b16 v[184:185], v26 offset:32768
  ds_read_b64_tr_b16 v[186:187], v26 offset:33792
  v_mfma_f32_16x16x32_bf16 v[76:79], v[208:211], a[172:175], v[76:79]
  ds_read_b64_tr_b16 v[188:189], v27 offset:32768
  ds_read_b64_tr_b16 v[190:191], v27 offset:33792
  v_mfma_f32_16x16x32_bf16 v[80:83], v[212:215], a[168:171], v[80:83]
  ds_read_b64_tr_b16 v[192:193], v28 offset:32768
  ds_read_b64_tr_b16 v[194:195], v28 offset:33792
  v_mfma_f32_16x16x32_bf16 v[84:87], v[212:215], a[172:175], v[84:87]
  ds_read_b64_tr_b16 v[196:197], v29 offset:32768
  ds_read_b64_tr_b16 v[198:199], v29 offset:33792
  v_mfma_f32_16x16x32_bf16 v[88:91], v[216:219], a[168:171], v[88:91]
  ds_read_b64_tr_b16 v[200:201], v30 offset:32768
  ds_read_b64_tr_b16 v[202:203], v30 offset:33792
  v_mfma_f32_16x16x32_bf16 v[92:95], v[216:219], a[172:175], v[92:95]
  v_mfma_f32_16x16x32_bf16 v[96:99], v[220:223], a[168:171], v[96:99]
  v_mfma_f32_16x16x32_bf16 v[100:103], v[220:223], a[172:175], v[100:103]
  v_mfma_f32_16x16x32_bf16 v[104:107], v[224:227], a[168:171], v[104:107]
  v_mfma_f32_16x16x32_bf16 v[108:111], v[224:227], a[172:175], v[108:111]
  v_mfma_f32_16x16x32_bf16 v[112:115], v[228:231], a[168:171], v[112:115]
  v_mfma_f32_16x16x32_bf16 v[116:119], v[228:231], a[172:175], v[116:119]
  s_waitcnt vmcnt(9)
  s_waitcnt vmcnt(8)
  v_readfirstlane_b32 s76, v10
  v_readfirstlane_b32 s77, v11
  s_cmp_lg_u32 s76, 0
  s_cbranch_scc1 mega_ztagd
  s_mov_b32 s33, 0
mega_ztagl:
  global_load_dwordx2 v[10:11], v9, s[56:57] sc1
  s_add_u32 s33, s33, 1
  s_waitcnt vmcnt(0)
  v_readfirstlane_b32 s76, v10
  v_readfirstlane_b32 s77, v11
  s_nop 1
  s_cmp_lg_u32 s76, 0
  s_cbranch_scc1 mega_ztagd
  s_cmp_lt_u32 s33, 0x20000
  s_cbranch_scc1 mega_ztagl
mega_ztagd:
  s_barrier
  s_mul_i32 s27, s20, 4352
  s_lshl_b32 s28, s21, 3
  s_add_u32 s27, s27, s28
  s_add_u32 s27, s27, 14811136
  s_cmp_lg_u32 s3, 0
  s_cbranch_scc1 mega_sigln
  v_mov_b32 v18, s27
  v_mov_b32 v16, s76
  v_mov_b32 v17, s77
  s_mov_b64 s[34:35], exec
  s_mov_b64 exec, 1
  global_store_dwordx2 v18, v[16:17], s[58:59] sc1
  s_mov_b64 exec, s[34:35]
mega_sigln:
  s_waitcnt lgkmcnt(0)
  v_mfma_f32_16x16x32_bf16 v[64:67], v[176:179], a[176:179], v[64:67]
  s_add_u32 m0, s74, 8192
  s_add_u32 s70, s68, 128
  buffer_load_dwordx4 v232, s[60:63], s70 offen offset:0 lds
  ds_read_b64_tr_b16 v[204:205], v24 offset:40960
  ds_read_b64_tr_b16 v[206:207], v24 offset:41984
  v_mfma_f32_16x16x32_bf16 v[68:71], v[176:179], a[180:183], v[68:71]
  ds_read_b64_tr_b16 v[208:209], v25 offset:40960
  ds_read_b64_tr_b16 v[210:211], v25 offset:41984
  v_mfma_f32_16x16x32_bf16 v[72:75], v[180:183], a[176:179], v[72:75]
  ds_read_b64_tr_b16 v[212:213], v26 offset:40960
  ds_read_b64_tr_b16 v[214:215], v26 offset:41984
  v_mfma_f32_16x16x32_bf16 v[76:79], v[180:183], a[180:183], v[76:79]
  buffer_load_dwordx4 v233, s[60:63], s70 offen offset:1024 lds
  ds_read_b64_tr_b16 v[216:217], v27 offset:40960
  ds_read_b64_tr_b16 v[218:219], v27 offset:41984
  v_mfma_f32_16x16x32_bf16 v[80:83], v[184:187], a[176:179], v[80:83]
  ds_read_b64_tr_b16 v[220:221], v28 offset:40960
  ds_read_b64_tr_b16 v[222:223], v28 offset:41984
  v_mfma_f32_16x16x32_bf16 v[84:87], v[184:187], a[180:183], v[84:87]
  ds_read_b64_tr_b16 v[224:225], v29 offset:40960
  ds_read_b64_tr_b16 v[226:227], v29 offset:41984
  v_mfma_f32_16x16x32_bf16 v[88:91], v[188:191], a[176:179], v[88:91]
  buffer_load_dwordx4 v234, s[60:63], s70 offen offset:2048 lds
  ds_read_b64_tr_b16 v[228:229], v30 offset:40960
  ds_read_b64_tr_b16 v[230:231], v30 offset:41984
  v_mfma_f32_16x16x32_bf16 v[92:95], v[188:191], a[180:183], v[92:95]
  v_mfma_f32_16x16x32_bf16 v[96:99], v[192:195], a[176:179], v[96:99]
  v_mfma_f32_16x16x32_bf16 v[100:103], v[192:195], a[180:183], v[100:103]
  buffer_load_dwordx4 v235, s[60:63], s70 offen offset:3072 lds
  v_mfma_f32_16x16x32_bf16 v[104:107], v[196:199], a[176:179], v[104:107]
  v_mfma_f32_16x16x32_bf16 v[108:111], v[196:199], a[180:183], v[108:111]
  v_mfma_f32_16x16x32_bf16 v[112:115], v[200:203], a[176:179], v[112:115]
  v_mfma_f32_16x16x32_bf16 v[116:119], v[200:203], a[180:183], v[116:119]
  s_waitcnt lgkmcnt(0)
  v_mfma_f32_16x16x32_bf16 v[64:67], v[204:207], a[184:187], v[64:67]
  ds_read_b64_tr_b16 v[176:177], v24 offset:49152
  ds_read_b64_tr_b16 v[178:179], v24 offset:50176
  v_mfma_f32_16x16x32_bf16 v[68:71], v[204:207], a[188:191], v[68:71]
  ds_read_b64_tr_b16 v[180:181], v25 offset:49152
  ds_read_b64_tr_b16 v[182:183], v25 offset:50176
  v_mfma_f32_16x16x32_bf16 v[72:75], v[208:211], a[184:187], v[72:75]
  ds_read_b64_tr_b16 v[184:185], v26 offset:49152
  ds_read_b64_tr_b16 v[186:187], v26 offset:50176
  v_mfma_f32_16x16x32_bf16 v[76:79], v[208:211], a[188:191], v[76:79]
  ds_read_b64_tr_b16 v[188:189], v27 offset:49152
  ds_read_b64_tr_b16 v[190:191], v27 offset:50176
  v_mfma_f32_16x16x32_bf16 v[80:83], v[212:215], a[184:187], v[80:83]
  ds_read_b64_tr_b16 v[192:193], v28 offset:49152
  ds_read_b64_tr_b16 v[194:195], v28 offset:50176
  v_mfma_f32_16x16x32_bf16 v[84:87], v[212:215], a[188:191], v[84:87]
  ds_read_b64_tr_b16 v[196:197], v29 offset:49152
  ds_read_b64_tr_b16 v[198:199], v29 offset:50176
  v_mfma_f32_16x16x32_bf16 v[88:91], v[216:219], a[184:187], v[88:91]
  ds_read_b64_tr_b16 v[200:201], v30 offset:49152
  ds_read_b64_tr_b16 v[202:203], v30 offset:50176
  v_mfma_f32_16x16x32_bf16 v[92:95], v[216:219], a[188:191], v[92:95]
  v_mfma_f32_16x16x32_bf16 v[96:99], v[220:223], a[184:187], v[96:99]
  v_mfma_f32_16x16x32_bf16 v[100:103], v[220:223], a[188:191], v[100:103]
  v_mfma_f32_16x16x32_bf16 v[104:107], v[224:227], a[184:187], v[104:107]
  v_mfma_f32_16x16x32_bf16 v[108:111], v[224:227], a[188:191], v[108:111]
  v_mfma_f32_16x16x32_bf16 v[112:115], v[228:231], a[184:187], v[112:115]
  v_mfma_f32_16x16x32_bf16 v[116:119], v[228:231], a[188:191], v[116:119]
  s_waitcnt lgkmcnt(0)
  v_mfma_f32_16x16x32_bf16 v[64:67], v[176:179], a[192:195], v[64:67]
  ds_read_b64_tr_b16 v[204:205], v24 offset:57344
  ds_read_b64_tr_b16 v[206:207], v24 offset:58368
  v_mfma_f32_16x16x32_bf16 v[68:71], v[176:179], a[196:199], v[68:71]
  ds_read_b64_tr_b16 v[208:209], v25 offset:57344
  ds_read_b64_tr_b16 v[210:211], v25 offset:58368
  v_mfma_f32_16x16x32_bf16 v[72:75], v[180:183], a[192:195], v[72:75]
  ds_read_b64_tr_b16 v[212:213], v26 offset:57344
  ds_read_b64_tr_b16 v[214:215], v26 offset:58368
  v_mfma_f32_16x16x32_bf16 v[76:79], v[180:183], a[196:199], v[76:79]
  ds_read_b64_tr_b16 v[216:217], v27 offset:57344
  ds_read_b64_tr_b16 v[218:219], v27 offset:58368
  v_mfma_f32_16x16x32_bf16 v[80:83], v[184:187], a[192:195], v[80:83]
  ds_read_b64_tr_b16 v[220:221], v28 offset:57344
  ds_read_b64_tr_b16 v[222:223], v28 offset:58368
  v_mfma_f32_16x16x32_bf16 v[84:87], v[184:187], a[196:199], v[84:87]
  ds_read_b64_tr_b16 v[224:225], v29 offset:57344
  ds_read_b64_tr_b16 v[226:227], v29 offset:58368
  v_mfma_f32_16x16x32_bf16 v[88:91], v[188:191], a[192:195], v[88:91]
  ds_read_b64_tr_b16 v[228:229], v30 offset:57344
  ds_read_b64_tr_b16 v[230:231], v30 offset:58368
  v_mfma_f32_16x16x32_bf16 v[92:95], v[188:191], a[196:199], v[92:95]
  v_mfma_f32_16x16x32_bf16 v[96:99], v[192:195], a[192:195], v[96:99]
  v_mfma_f32_16x16x32_bf16 v[100:103], v[192:195], a[196:199], v[100:103]
  v_mfma_f32_16x16x32_bf16 v[104:107], v[196:199], a[192:195], v[104:107]
  v_mfma_f32_16x16x32_bf16 v[108:111], v[196:199], a[196:199], v[108:111]
  v_mfma_f32_16x16x32_bf16 v[112:115], v[200:203], a[192:195], v[112:115]
  v_mfma_f32_16x16x32_bf16 v[116:119], v[200:203], a[196:199], v[116:119]
  s_waitcnt vmcnt(8)
  ds_read_b128 a[0:3], v236 offset:0
  ds_read_b128 a[16:19], v237 offset:0
  ds_read_b128 a[4:7], v238 offset:0
  ds_read_b128 a[20:23], v239 offset:0
  v_add_u32 v24, 0x10000, v24
  v_add_u32 v25, 0x10000, v25
  v_add_u32 v26, 0x10000, v26
  v_add_u32 v27, 0x10000, v27
  v_add_u32 v28, 0x10000, v28
  v_add_u32 v29, 0x10000, v29
  v_add_u32 v30, 0x10000, v30
  s_waitcnt lgkmcnt(4)
  v_mfma_f32_16x16x32_bf16 v[64:67], v[204:207], a[200:203], v[64:67]
  ds_read_b64_tr_b16 v[176:177], v24 offset:0
  ds_read_b64_tr_b16 v[178:179], v24 offset:1024
  v_mfma_f32_16x16x32_bf16 v[68:71], v[204:207], a[204:207], v[68:71]
  ds_read_b64_tr_b16 v[180:181], v25 offset:0
  ds_read_b64_tr_b16 v[182:183], v25 offset:1024
  v_mfma_f32_16x16x32_bf16 v[72:75], v[208:211], a[200:203], v[72:75]
  ds_read_b64_tr_b16 v[184:185], v26 offset:0
  ds_read_b64_tr_b16 v[186:187], v26 offset:1024
  v_mfma_f32_16x16x32_bf16 v[76:79], v[208:211], a[204:207], v[76:79]
  ds_read_b64_tr_b16 v[188:189], v27 offset:0
  ds_read_b64_tr_b16 v[190:191], v27 offset:1024
  v_mfma_f32_16x16x32_bf16 v[80:83], v[212:215], a[200:203], v[80:83]
  ds_read_b64_tr_b16 v[192:193], v28 offset:0
  ds_read_b64_tr_b16 v[194:195], v28 offset:1024
  v_mfma_f32_16x16x32_bf16 v[84:87], v[212:215], a[204:207], v[84:87]
  ds_read_b64_tr_b16 v[196:197], v29 offset:0
  ds_read_b64_tr_b16 v[198:199], v29 offset:1024
  v_mfma_f32_16x16x32_bf16 v[88:91], v[216:219], a[200:203], v[88:91]
  ds_read_b64_tr_b16 v[200:201], v30 offset:0
  ds_read_b64_tr_b16 v[202:203], v30 offset:1024
  v_mfma_f32_16x16x32_bf16 v[92:95], v[216:219], a[204:207], v[92:95]
  v_mfma_f32_16x16x32_bf16 v[96:99], v[220:223], a[200:203], v[96:99]
  v_mfma_f32_16x16x32_bf16 v[100:103], v[220:223], a[204:207], v[100:103]
  v_mfma_f32_16x16x32_bf16 v[104:107], v[224:227], a[200:203], v[104:107]
  v_mfma_f32_16x16x32_bf16 v[108:111], v[224:227], a[204:207], v[108:111]
  v_mfma_f32_16x16x32_bf16 v[112:115], v[228:231], a[200:203], v[112:115]
  v_mfma_f32_16x16x32_bf16 v[116:119], v[228:231], a[204:207], v[116:119]
  s_waitcnt lgkmcnt(14)
  s_waitcnt lgkmcnt(0)
  v_mfma_f32_16x16x32_bf16 v[64:67], v[176:179], a[208:211], v[64:67]
  ds_read_b64_tr_b16 v[204:205], v24 offset:8192
  ds_read_b64_tr_b16 v[206:207], v24 offset:9216
  v_mfma_f32_16x16x32_bf16 v[68:71], v[176:179], a[212:215], v[68:71]
  ds_read_b64_tr_b16 v[208:209], v25 offset:8192
  ds_read_b64_tr_b16 v[210:211], v25 offset:9216
  v_mfma_f32_16x16x32_bf16 v[72:75], v[180:183], a[208:211], v[72:75]
  s_add_u32 m0, s74, 0
  s_add_u32 s70, s69, 128
  buffer_load_dwordx4 v232, s[60:63], s70 offen offset:0 lds
  ds_read_b64_tr_b16 v[212:213], v26 offset:8192
  ds_read_b64_tr_b16 v[214:215], v26 offset:9216
  v_mfma_f32_16x16x32_bf16 v[76:79], v[180:183], a[212:215], v[76:79]
  ds_read_b64_tr_b16 v[216:217], v27 offset:8192
  ds_read_b64_tr_b16 v[218:219], v27 offset:9216
  v_mfma_f32_16x16x32_bf16 v[80:83], v[184:187], a[208:211], v[80:83]
  ds_read_b64_tr_b16 v[220:221], v28 offset:8192
  ds_read_b64_tr_b16 v[222:223], v28 offset:9216
  v_mfma_f32_16x16x32_bf16 v[84:87], v[184:187], a[212:215], v[84:87]
  buffer_load_dwordx4 v233, s[60:63], s70 offen offset:1024 lds
  ds_read_b64_tr_b16 v[224:225], v29 offset:8192
  ds_read_b64_tr_b16 v[226:227], v29 offset:9216
  v_mfma_f32_16x16x32_bf16 v[88:91], v[188:191], a[208:211], v[88:91]
  ds_read_b64_tr_b16 v[228:229], v30 offset:8192
  ds_read_b64_tr_b16 v[230:231], v30 offset:9216
  v_mfma_f32_16x16x32_bf16 v[92:95], v[188:191], a[212:215], v[92:95]
  v_mfma_f32_16x16x32_bf16 v[96:99], v[192:195], a[208:211], v[96:99]
  buffer_load_dwordx4 v234, s[60:63], s70 offen offset:2048 lds
  v_mfma_f32_16x16x32_bf16 v[100:103], v[192:195], a[212:215], v[100:103]
  v_mfma_f32_16x16x32_bf16 v[104:107], v[196:199], a[208:211], v[104:107]
  v_mfma_f32_16x16x32_bf16 v[108:111], v[196:199], a[212:215], v[108:111]
  buffer_load_dwordx4 v235, s[60:63], s70 offen offset:3072 lds
  v_mfma_f32_16x16x32_bf16 v[112:115], v[200:203], a[208:211], v[112:115]
  v_mfma_f32_16x16x32_bf16 v[116:119], v[200:203], a[212:215], v[116:119]
  s_waitcnt vmcnt(8)
  ds_read_b128 a[8:11], v236 offset:4096
  ds_read_b128 a[24:27], v237 offset:4096
  ds_read_b128 a[12:15], v238 offset:4096
  ds_read_b128 a[28:31], v239 offset:4096
  s_waitcnt lgkmcnt(4)
  v_mfma_f32_16x16x32_bf16 v[64:67], v[204:207], a[216:219], v[64:67]
  ds_read_b64_tr_b16 v[176:177], v24 offset:16384
  ds_read_b64_tr_b16 v[178:179], v24 offset:17408
  v_mfma_f32_16x16x32_bf16 v[68:71], v[204:207], a[220:223], v[68:71]
  ds_read_b64_tr_b16 v[180:181], v25 offset:16384
  ds_read_b64_tr_b16 v[182:183], v25 offset:17408
  v_mfma_f32_16x16x32_bf16 v[72:75], v[208:211], a[216:219], v[72:75]
  ds_read_b64_tr_b16 v[184:185], v26 offset:16384
  ds_read_b64_tr_b16 v[186:187], v26 offset:17408
  v_mfma_f32_16x16x32_bf16 v[76:79], v[208:211], a[220:223], v[76:79]
  ds_read_b64_tr_b16 v[188:189], v27 offset:16384
  ds_read_b64_tr_b16 v[190:191], v27 offset:17408
  v_mfma_f32_16x16x32_bf16 v[80:83], v[212:215], a[216:219], v[80:83]
  ds_read_b64_tr_b16 v[192:193], v28 offset:16384
  ds_read_b64_tr_b16 v[194:195], v28 offset:17408
  v_mfma_f32_16x16x32_bf16 v[84:87], v[212:215], a[220:223], v[84:87]
  ds_read_b64_tr_b16 v[196:197], v29 offset:16384
  ds_read_b64_tr_b16 v[198:199], v29 offset:17408
  v_mfma_f32_16x16x32_bf16 v[88:91], v[216:219], a[216:219], v[88:91]
  ds_read_b64_tr_b16 v[200:201], v30 offset:16384
  ds_read_b64_tr_b16 v[202:203], v30 offset:17408
  v_mfma_f32_16x16x32_bf16 v[92:95], v[216:219], a[220:223], v[92:95]
  v_mfma_f32_16x16x32_bf16 v[96:99], v[220:223], a[216:219], v[96:99]
  v_mfma_f32_16x16x32_bf16 v[100:103], v[220:223], a[220:223], v[100:103]
  v_mfma_f32_16x16x32_bf16 v[104:107], v[224:227], a[216:219], v[104:107]
  v_mfma_f32_16x16x32_bf16 v[108:111], v[224:227], a[220:223], v[108:111]
  v_mfma_f32_16x16x32_bf16 v[112:115], v[228:231], a[216:219], v[112:115]
  v_mfma_f32_16x16x32_bf16 v[116:119], v[228:231], a[220:223], v[116:119]
  s_waitcnt lgkmcnt(14)
  s_mul_i32 s27, s20, 4352
  s_add_u32 s27, s27, 14811136
  v_and_b32 v17, 7, v12
  v_lshl_add_u32 v17, v17, 3, s27
  global_load_dwordx2 v[18:19], v17, s[58:59] sc1
  s_waitcnt lgkmcnt(0)
  v_mfma_f32_16x16x32_bf16 v[64:67], v[176:179], a[224:227], v[64:67]
  s_add_u32 m0, s74, 4096
  s_add_u32 s70, s68, 256
  buffer_load_dwordx4 v232, s[60:63], s70 offen offset:0 lds
  ds_read_b64_tr_b16 v[204:205], v24 offset:24576
  ds_read_b64_tr_b16 v[206:207], v24 offset:25600
  v_mfma_f32_16x16x32_bf16 v[68:71], v[176:179], a[228:231], v[68:71]
  ds_read_b64_tr_b16 v[208:209], v25 offset:24576
  ds_read_b64_tr_b16 v[210:211], v25 offset:25600
  v_mfma_f32_16x16x32_bf16 v[72:75], v[180:183], a[224:227], v[72:75]
  ds_read_b64_tr_b16 v[212:213], v26 offset:24576
  ds_read_b64_tr_b16 v[214:215], v26 offset:25600
  v_mfma_f32_16x16x32_bf16 v[76:79], v[180:183], a[228:231], v[76:79]
  buffer_load_dwordx4 v233, s[60:63], s70 offen offset:1024 lds
  ds_read_b64_tr_b16 v[216:217], v27 offset:24576
  ds_read_b64_tr_b16 v[218:219], v27 offset:25600
  v_mfma_f32_16x16x32_bf16 v[80:83], v[184:187], a[224:227], v[80:83]
  ds_read_b64_tr_b16 v[220:221], v28 offset:24576
  ds_read_b64_tr_b16 v[222:223], v28 offset:25600
  v_mfma_f32_16x16x32_bf16 v[84:87], v[184:187], a[228:231], v[84:87]
  ds_read_b64_tr_b16 v[224:225], v29 offset:24576
  ds_read_b64_tr_b16 v[226:227], v29 offset:25600
  v_mfma_f32_16x16x32_bf16 v[88:91], v[188:191], a[224:227], v[88:91]
  buffer_load_dwordx4 v234, s[60:63], s70 offen offset:2048 lds
  ds_read_b64_tr_b16 v[228:229], v30 offset:24576
  ds_read_b64_tr_b16 v[230:231], v30 offset:25600
  v_mfma_f32_16x16x32_bf16 v[92:95], v[188:191], a[228:231], v[92:95]
  v_mfma_f32_16x16x32_bf16 v[96:99], v[192:195], a[224:227], v[96:99]
  v_mfma_f32_16x16x32_bf16 v[100:103], v[192:195], a[228:231], v[100:103]
  buffer_load_dwordx4 v235, s[60:63], s70 offen offset:3072 lds
  v_mfma_f32_16x16x32_bf16 v[104:107], v[196:199], a[224:227], v[104:107]
  v_mfma_f32_16x16x32_bf16 v[108:111], v[196:199], a[228:231], v[108:111]
  v_mfma_f32_16x16x32_bf16 v[112:115], v[200:203], a[224:227], v[112:115]
  v_mfma_f32_16x16x32_bf16 v[116:119], v[200:203], a[228:231], v[116:119]
  s_waitcnt vmcnt(9)
  ds_read_b128 a[32:35], v236 offset:8192
  ds_read_b128 a[48:51], v237 offset:8192
  ds_read_b128 a[36:39], v238 offset:8192
  ds_read_b128 a[52:55], v239 offset:8192
  s_waitcnt lgkmcnt(4)
  v_mfma_f32_16x16x32_bf16 v[64:67], v[204:207], a[232:235], v[64:67]
  ds_read_b64_tr_b16 v[176:177], v24 offset:32768
  ds_read_b64_tr_b16 v[178:179], v24 offset:33792
  v_mfma_f32_16x16x32_bf16 v[68:71], v[204:207], a[236:239], v[68:71]
  ds_read_b64_tr_b16 v[180:181], v25 offset:32768
  ds_read_b64_tr_b16 v[182:183], v25 offset:33792
  v_mfma_f32_16x16x32_bf16 v[72:75], v[208:211], a[232:235], v[72:75]
  ds_read_b64_tr_b16 v[184:185], v26 offset:32768
  ds_read_b64_tr_b16 v[186:187], v26 offset:33792
  v_mfma_f32_16x16x32_bf16 v[76:79], v[208:211], a[236:239], v[76:79]
  ds_read_b64_tr_b16 v[188:189], v27 offset:32768
  ds_read_b64_tr_b16 v[190:191], v27 offset:33792
  v_mfma_f32_16x16x32_bf16 v[80:83], v[212:215], a[232:235], v[80:83]
  ds_read_b64_tr_b16 v[192:193], v28 offset:32768
  ds_read_b64_tr_b16 v[194:195], v28 offset:33792
  v_mfma_f32_16x16x32_bf16 v[84:87], v[212:215], a[236:239], v[84:87]
  ds_read_b64_tr_b16 v[196:197], v29 offset:32768
  ds_read_b64_tr_b16 v[198:199], v29 offset:33792
  v_mfma_f32_16x16x32_bf16 v[88:91], v[216:219], a[232:235], v[88:91]
  ds_read_b64_tr_b16 v[200:201], v30 offset:32768
  ds_read_b64_tr_b16 v[202:203], v30 offset:33792
  v_mfma_f32_16x16x32_bf16 v[92:95], v[216:219], a[236:239], v[92:95]
  v_mfma_f32_16x16x32_bf16 v[96:99], v[220:223], a[232:235], v[96:99]
  v_mfma_f32_16x16x32_bf16 v[100:103], v[220:223], a[236:239], v[100:103]
  v_mfma_f32_16x16x32_bf16 v[104:107], v[224:227], a[232:235], v[104:107]
  v_mfma_f32_16x16x32_bf16 v[108:111], v[224:227], a[236:239], v[108:111]
  v_mfma_f32_16x16x32_bf16 v[112:115], v[228:231], a[232:235], v[112:115]
  v_mfma_f32_16x16x32_bf16 v[116:119], v[228:231], a[236:239], v[116:119]
  s_waitcnt lgkmcnt(14)
  s_waitcnt lgkmcnt(0)
  v_mfma_f32_16x16x32_bf16 v[64:67], v[176:179], a[240:243], v[64:67]
  ds_read_b64_tr_b16 v[204:205], v24 offset:40960
  ds_read_b64_tr_b16 v[206:207], v24 offset:41984
  v_mfma_f32_16x16x32_bf16 v[68:71], v[176:179], a[244:247], v[68:71]
  ds_read_b64_tr_b16 v[208:209], v25 offset:40960
  ds_read_b64_tr_b16 v[210:211], v25 offset:41984
  v_mfma_f32_16x16x32_bf16 v[72:75], v[180:183], a[240:243], v[72:75]
  s_add_u32 m0, s74, 8192
  s_add_u32 s70, s69, 256
  buffer_load_dwordx4 v232, s[60:63], s70 offen offset:0 lds
  ds_read_b64_tr_b16 v[212:213], v26 offset:40960
  ds_read_b64_tr_b16 v[214:215], v26 offset:41984
  v_mfma_f32_16x16x32_bf16 v[76:79], v[180:183], a[244:247], v[76:79]
  ds_read_b64_tr_b16 v[216:217], v27 offset:40960
  ds_read_b64_tr_b16 v[218:219], v27 offset:41984
  v_mfma_f32_16x16x32_bf16 v[80:83], v[184:187], a[240:243], v[80:83]
  ds_read_b64_tr_b16 v[220:221], v28 offset:40960
  ds_read_b64_tr_b16 v[222:223], v28 offset:41984
  v_mfma_f32_16x16x32_bf16 v[84:87], v[184:187], a[244:247], v[84:87]
  buffer_load_dwordx4 v233, s[60:63], s70 offen offset:1024 lds
  ds_read_b64_tr_b16 v[224:225], v29 offset:40960
  ds_read_b64_tr_b16 v[226:227], v29 offset:41984
  v_mfma_f32_16x16x32_bf16 v[88:91], v[188:191], a[240:243], v[88:91]
  ds_read_b64_tr_b16 v[228:229], v30 offset:40960
  ds_read_b64_tr_b16 v[230:231], v30 offset:41984
  v_mfma_f32_16x16x32_bf16 v[92:95], v[188:191], a[244:247], v[92:95]
  v_mfma_f32_16x16x32_bf16 v[96:99], v[192:195], a[240:243], v[96:99]
  buffer_load_dwordx4 v234, s[60:63], s70 offen offset:2048 lds
  v_mfma_f32_16x16x32_bf16 v[100:103], v[192:195], a[244:247], v[100:103]
  v_mfma_f32_16x16x32_bf16 v[104:107], v[196:199], a[240:243], v[104:107]
  v_mfma_f32_16x16x32_bf16 v[108:111], v[196:199], a[244:247], v[108:111]
  buffer_load_dwordx4 v235, s[60:63], s70 offen offset:3072 lds
  v_mfma_f32_16x16x32_bf16 v[112:115], v[200:203], a[240:243], v[112:115]
  v_mfma_f32_16x16x32_bf16 v[116:119], v[200:203], a[244:247], v[116:119]
  s_waitcnt vmcnt(8)
  v_xor_b32 v18, s76, v18
  v_xor_b32 v19, s77, v19
  v_or_b32 v18, v18, v19
  v_cmp_eq_u32 vcc, 0, v18
  s_nop 1
  s_cmp_eq_u64 vcc, exec
  s_cbranch_scc1 mega_lnok
  s_mov_b32 s33, 0
mega_plnw_loop:
  global_load_dwordx2 v[18:19], v17, s[58:59] sc1
  s_add_u32 s33, s33, 1
  s_waitcnt vmcnt(0)
  v_xor_b32 v18, s76, v18
  v_xor_b32 v19, s77, v19
  v_or_b32 v18, v18, v19
  v_cmp_eq_u32 vcc, 0, v18
  s_nop 1
  s_cmp_eq_u64 vcc, exec
  s_cbranch_scc1 mega_plnw_out
  s_sleep 2
  s_cmp_lt_u32 s33, 0x20000
  s_cbranch_scc1 mega_plnw_loop
mega_plnw_out:
mega_lnok:
  s_lshl_b32 s23, s20, 10
  s_lshl_b32 s27, s3, 5
  s_add_u32 s23, s23, s27
  s_lshl_b32 s23, s23, 3
  s_mov_b32 s27, 14376960
  s_add_u32 s16, s58, s27
  s_addc_u32 s17, s59, 0
  s_and_b32 s17, s17, 0xffff
  s_mov_b32 s18, 131072
  s_mov_b32 s19, 0x20000
  v_and_b32 v18, 7, v12
  v_lshlrev_b32 v18, 10, v18
  v_lshl_add_u32 v18, v14, 6, v18
  buffer_load_dwordx4 v[40:43], v18, s[16:19], s23 offen offset:0 sc1
  buffer_load_dwordx4 v[44:47], v18, s[16:19], s23 offen offset:16 sc1
  buffer_load_dwordx4 v[48:51], v18, s[16:19], s23 offen offset:32 sc1
  buffer_load_dwordx4 v[52:55], v18, s[16:19], s23 offen offset:48 sc1
  s_waitcnt lgkmcnt(0)
  v_mfma_f32_16x16x32_bf16 v[64:67], v[204:207], a[248:251], v[64:67]
  v_mfma_f32_16x16x32_bf16 v[68:71], v[204:207], a[252:255], v[68:71]
  v_mfma_f32_16x16x32_bf16 v[72:75], v[208:211], a[248:251], v[72:75]
  v_mfma_f32_16x16x32_bf16 v[76:79], v[208:211], a[252:255], v[76:79]
  v_mfma_f32_16x16x32_bf16 v[80:83], v[212:215], a[248:251], v[80:83]
  v_mfma_f32_16x16x32_bf16 v[84:87], v[212:215], a[252:255], v[84:87]
  v_mfma_f32_16x16x32_bf16 v[88:91], v[216:219], a[248:251], v[88:91]
  v_mfma_f32_16x16x32_bf16 v[92:95], v[216:219], a[252:255], v[92:95]
  v_mfma_f32_16x16x32_bf16 v[96:99], v[220:223], a[248:251], v[96:99]
  v_mfma_f32_16x16x32_bf16 v[100:103], v[220:223], a[252:255], v[100:103]
  v_mfma_f32_16x16x32_bf16 v[104:107], v[224:227], a[248:251], v[104:107]
  v_mfma_f32_16x16x32_bf16 v[108:111], v[224:227], a[252:255], v[108:111]
  v_mfma_f32_16x16x32_bf16 v[112:115], v[228:231], a[248:251], v[112:115]
  v_mfma_f32_16x16x32_bf16 v[116:119], v[228:231], a[252:255], v[116:119]
  s_waitcnt vmcnt(8)
  ds_read_b128 a[40:43], v236 offset:0
  ds_read_b128 a[56:59], v237 offset:0
  ds_read_b128 a[44:47], v238 offset:0
  ds_read_b128 a[60:63], v239 offset:0
  ds_read_b128 a[64:67], v236 offset:4096
  ds_read_b128 a[80:83], v237 offset:4096
  ds_read_b128 a[68:71], v238 offset:4096
  ds_read_b128 a[84:87], v239 offset:4096
  s_mul_i32 s75, s3, 28672
  s_add_u32 s75, s75, 0
  s_and_b32 s33, s3, 1
  s_lshl_b32 s33, s33, 9
  s_add_u32 s33, s33, s75
  v_add_u32 v241, s33, v240
  v_xor_b32 v242, 64, v241
  s_xor_b32 s33, s33, 512
  v_add_u32 v243, s33, v240
  v_xor_b32 v244, 64, v243
  s_waitcnt lgkmcnt(0)
  s_barrier
  s_waitcnt vmcnt(0)
  v_mov_b32 v216, v40
  v_mov_b32 v217, v42
  v_mov_b32 v218, v44
  v_mov_b32 v219, v46
  v_mov_b32 v220, v48
  v_mov_b32 v221, v50
  v_mov_b32 v222, v52
  v_mov_b32 v223, v54
  v_add_f32_dpp v216, v216, v216 quad_perm:[1,0,3,2] row_mask:0xf bank_mask:0xf
  v_add_f32_dpp v217, v217, v217 quad_perm:[1,0,3,2] row_mask:0xf bank_mask:0xf
  s_add_u32 m0, s74, 0
  s_add_u32 s70, s69, 768
  buffer_load_dwordx4 v232, s[60:63], s70 offen offset:0 lds
  v_add_f32_dpp v218, v218, v218 quad_perm:[1,0,3,2] row_mask:0xf bank_mask:0xf
  v_add_f32_dpp v219, v219, v219 quad_perm:[1,0,3,2] row_mask:0xf bank_mask:0xf
  v_add_f32_dpp v220, v220, v220 quad_perm:[1,0,3,2] row_mask:0xf bank_mask:0xf
  v_add_f32_dpp v221, v221, v221 quad_perm:[1,0,3,2] row_mask:0xf bank_mask:0xf
  v_add_f32_dpp v222, v222, v222 quad_perm:[1,0,3,2] row_mask:0xf bank_mask:0xf
  v_add_f32_dpp v223, v223, v223 quad_perm:[1,0,3,2] row_mask:0xf bank_mask:0xf
  v_add_f32_dpp v216, v216, v216 quad_perm:[2,3,0,1] row_mask:0xf bank_mask:0xf
  v_add_f32_dpp v217, v217, v217 quad_perm:[2,3,0,1] row_mask:0xf bank_mask:0xf
  v_add_f32_dpp v218, v218, v218 quad_perm:[2,3,0,1] row_mask:0xf bank_mask:0xf
  v_add_f32_dpp v219, v219, v219 quad_perm:[2,3,0,1] row_mask:0xf bank_mask:0xf
  buffer_load_dwordx4 v233, s[60:63], s70 offen offset:1024 lds
  v_add_f32_dpp v220, v220, v220 quad_perm:[2,3,0,1] row_mask:0xf bank_mask:0xf
  v_add_f32_dpp v221, v221, v221 quad_perm:[2,3,0,1] row_mask:0xf bank_mask:0xf
  v_add_f32_dpp v222, v222, v222 quad_perm:[2,3,0,1] row_mask:0xf bank_mask:0xf
  v_add_f32_dpp v223, v223, v223 quad_perm:[2,3,0,1] row_mask:0xf bank_mask:0xf
  v_add_f32_dpp v216, v216, v216 row_half_mirror row_mask:0xf bank_mask:0xf
  v_add_f32_dpp v217, v217, v217 row_half_mirror row_mask:0xf bank_mask:0xf
  v_add_f32_dpp v218, v218, v218 row_half_mirror row_mask:0xf bank_mask:0xf
  v_add_f32_dpp v219, v219, v219 row_half_mirror row_mask:0xf bank_mask:0xf
  v_add_f32_dpp v220, v220, v220 row_half_mirror row_mask:0xf bank_mask:0xf
  v_add_f32_dpp v221, v221, v221 row_half_mirror row_mask:0xf bank_mask:0xf
  buffer_load_dwordx4 v234, s[60:63], s70 offen offset:2048 lds
  v_add_f32_dpp v222, v222, v222 row_half_mirror row_mask:0xf bank_mask:0xf
  v_add_f32_dpp v223, v223, v223 row_half_mirror row_mask:0xf bank_mask:0xf
  v_mul_f32 v216, 0.125, v216
  v_mul_f32 v217, 0.125, v217
  v_mul_f32 v218, 0.125, v218
  v_mul_f32 v219, 0.125, v219
  v_mul_f32 v220, 0.125, v220
  v_mul_f32 v221, 0.125, v221
  v_mul_f32 v222, 0.125, v222
  v_mul_f32 v223, 0.125, v223
  buffer_load_dwordx4 v235, s[60:63], s70 offen offset:3072 lds
  v_mov_b32 v38, 0x42e00000
  v_sub_f32 v40, v40, v216
  v_mul_f32 v40, v40, v40
  v_fma_f32 v224, v40, v38, v41
  v_sub_f32 v42, v42, v217
  v_mul_f32 v42, v42, v42
  v_fma_f32 v225, v42, v38, v43
  v_sub_f32 v44, v44, v218
  v_mul_f32 v44, v44, v44
  v_fma_f32 v226, v44, v38, v45
  s_add_u32 m0, s74, 4096
  s_add_u32 s70, s68, 896
  buffer_load_dwordx4 v232, s[60:63], s70 offen offset:0 lds
  v_sub_f32 v46, v46, v219
  v_mul_f32 v46, v46, v46
  v_fma_f32 v227, v46, v38, v47
  v_sub_f32 v48, v48, v220
  v_mul_f32 v48, v48, v48
  v_fma_f32 v228, v48, v38, v49
  v_sub_f32 v50, v50, v221
  v_mul_f32 v50, v50, v50
  v_fma_f32 v229, v50, v38, v51
  v_sub_f32 v52, v52, v222
  buffer_load_dwordx4 v233, s[60:63], s70 offen offset:1024 lds
  v_mul_f32 v52, v52, v52
  v_fma_f32 v230, v52, v38, v53
  v_sub_f32 v54, v54, v223
  v_mul_f32 v54, v54, v54
  v_fma_f32 v231, v54, v38, v55
  v_add_f32_dpp v224, v224, v224 quad_perm:[1,0,3,2] row_mask:0xf bank_mask:0xf
  v_add_f32_dpp v225, v225, v225 quad_perm:[1,0,3,2] row_mask:0xf bank_mask:0xf
  v_add_f32_dpp v226, v226, v226 quad_perm:[1,0,3,2] row_mask:0xf bank_mask:0xf
  v_add_f32_dpp v227, v227, v227 quad_perm:[1,0,3,2] row_mask:0xf bank_mask:0xf
  v_add_f32_dpp v228, v228, v228 quad_perm:[1,0,3,2] row_mask:0xf bank_mask:0xf
  buffer_load_dwordx4 v234, s[60:63], s70 offen offset:2048 lds
  v_add_f32_dpp v229, v229, v229 quad_perm:[1,0,3,2] row_mask:0xf bank_mask:0xf
  v_add_f32_dpp v230, v230, v230 quad_perm:[1,0,3,2] row_mask:0xf bank_mask:0xf
  v_add_f32_dpp v231, v231, v231 quad_perm:[1,0,3,2] row_mask:0xf bank_mask:0xf
  v_add_f32_dpp v224, v224, v224 quad_perm:[2,3,0,1] row_mask:0xf bank_mask:0xf
  v_add_f32_dpp v225, v225, v225 quad_perm:[2,3,0,1] row_mask:0xf bank_mask:0xf
  v_add_f32_dpp v226, v226, v226 quad_perm:[2,3,0,1] row_mask:0xf bank_mask:0xf
  v_add_f32_dpp v227, v227, v227 quad_perm:[2,3,0,1] row_mask:0xf bank_mask:0xf
  v_add_f32_dpp v228, v228, v228 quad_perm:[2,3,0,1] row_mask:0xf bank_mask:0xf
  v_add_f32_dpp v229, v229, v229 quad_perm:[2,3,0,1] row_mask:0xf bank_mask:0xf
  v_add_f32_dpp v230, v230, v230 quad_perm:[2,3,0,1] row_mask:0xf bank_mask:0xf
  buffer_load_dwordx4 v235, s[60:63], s70 offen offset:3072 lds
  v_add_f32_dpp v231, v231, v231 quad_perm:[2,3,0,1] row_mask:0xf bank_mask:0xf
  v_add_f32_dpp v224, v224, v224 row_half_mirror row_mask:0xf bank_mask:0xf
  v_add_f32_dpp v225, v225, v225 row_half_mirror row_mask:0xf bank_mask:0xf
  v_add_f32_dpp v226, v226, v226 row_half_mirror row_mask:0xf bank_mask:0xf
  v_add_f32_dpp v227, v227, v227 row_half_mirror row_mask:0xf bank_mask:0xf
  v_add_f32_dpp v228, v228, v228 row_half_mirror row_mask:0xf bank_mask:0xf
  v_add_f32_dpp v229, v229, v229 row_half_mirror row_mask:0xf bank_mask:0xf
  v_add_f32_dpp v230, v230, v230 row_half_mirror row_mask:0xf bank_mask:0xf
  v_add_f32_dpp v231, v231, v231 row_half_mirror row_mask:0xf bank_mask:0xf
  v_mov_b32 v38, 0x3a924925
  s_add_u32 m0, s75, 0
  s_add_u32 s70, s68, 384
  buffer_load_dwordx4 v232, s[60:63], s70 offen offset:0 lds
  v_mov_b32 v39, 0x3727c5ac
  v_fma_f32 v224, v224, v38, v39
  v_fma_f32 v225, v225, v38, v39
  v_fma_f32 v226, v226, v38, v39
  v_fma_f32 v227, v227, v38, v39
  v_fma_f32 v228, v228, v38, v39
  v_fma_f32 v229, v229, v38, v39
  v_fma_f32 v230, v230, v38, v39
  v_fma_f32 v231, v231, v38, v39
  v_rsq_f32 v224, v224
  buffer_load_dwordx4 v233, s[60:63], s70 offen offset:1024 lds
  v_rsq_f32 v225, v225
  v_rsq_f32 v226, v226
  v_rsq_f32 v227, v227
  v_rsq_f32 v228, v228
  v_rsq_f32 v229, v229
  v_rsq_f32 v230, v230
  v_rsq_f32 v231, v231
  v_mul_f32 v216, v216, v224
  v_mul_f32 v217, v217, v225
  v_mul_f32 v218, v218, v226
  buffer_load_dwordx4 v234, s[60:63], s70 offen offset:2048 lds
  v_mul_f32 v219, v219, v227
  v_mul_f32 v220, v220, v228
  v_mul_f32 v221, v221, v229
  v_mul_f32 v222, v222, v230
  v_mul_f32 v223, v223, v231
  s_mul_i32 s23, s21, 458752
  s_mul_i32 s27, s72, 7168
  s_add_u32 s23, s23, s27
  s_add_u32 s16, s58, s23
  s_addc_u32 s17, s59, 0
  s_and_b32 s17, s17, 0xffff
  s_mov_b32 s18, 7168
  s_mov_b32 s19, 0x20000
  v_lshlrev_b32 v18, 4, v12
  v_add_u32 v19, 4096, v18
  v_pk_fma_f32 v[120:121], v[120:121], v[224:225], v[216:217] neg_lo:[0,0,1] neg_hi:[0,0,1]
  v_pk_fma_f32 v[122:123], v[122:123], v[226:227], v[218:219] neg_lo:[0,0,1] neg_hi:[0,0,1]
  v_cvt_pk_bf16_f32 v200, v120, v121
  buffer_load_dwordx4 v235, s[60:63], s70 offen offset:3072 lds
  v_cvt_pk_bf16_f32 v201, v122, v123
  v_pk_fma_f32 v[124:125], v[124:125], v[228:229], v[220:221] neg_lo:[0,0,1] neg_hi:[0,0,1]
  v_pk_fma_f32 v[126:127], v[126:127], v[230:231], v[222:223] neg_lo:[0,0,1] neg_hi:[0,0,1]
  v_cvt_pk_bf16_f32 v202, v124, v125
  v_cvt_pk_bf16_f32 v203, v126, v127
  buffer_store_dwordx4 v[200:203], v18, s[16:19], 0 offen offset:0 sc1
  v_pk_fma_f32 v[128:129], v[128:129], v[224:225], v[216:217] neg_lo:[0,0,1] neg_hi:[0,0,1]
  v_pk_fma_f32 v[130:131], v[130:131], v[226:227], v[218:219] neg_lo:[0,0,1] neg_hi:[0,0,1]
  v_cvt_pk_bf16_f32 v204, v128, v129
  v_cvt_pk_bf16_f32 v205, v130, v131
  v_pk_fma_f32 v[132:133], v[132:133], v[228:229], v[220:221] neg_lo:[0,0,1] neg_hi:[0,0,1]
  s_add_u32 m0, s75, 4096
  s_add_u32 s70, s69, 384
  buffer_load_dwordx4 v232, s[60:63], s70 offen offset:0 lds
  v_pk_fma_f32 v[134:135], v[134:135], v[230:231], v[222:223] neg_lo:[0,0,1] neg_hi:[0,0,1]
  v_cvt_pk_bf16_f32 v206, v132, v133
  v_cvt_pk_bf16_f32 v207, v134, v135
  buffer_store_dwordx4 v[204:207], v18, s[16:19], 0 offen offset:1024 sc1
  v_pk_fma_f32 v[136:137], v[136:137], v[224:225], v[216:217] neg_lo:[0,0,1] neg_hi:[0,0,1]
  v_pk_fma_f32 v[138:139], v[138:139], v[226:227], v[218:219] neg_lo:[0,0,1] neg_hi:[0,0,1]
  v_cvt_pk_bf16_f32 v208, v136, v137
  v_cvt_pk_bf16_f32 v209, v138, v139
  v_pk_fma_f32 v[140:141], v[140:141], v[228:229], v[220:221] neg_lo:[0,0,1] neg_hi:[0,0,1]
  v_pk_fma_f32 v[142:143], v[142:143], v[230:231], v[222:223] neg_lo:[0,0,1] neg_hi:[0,0,1]
  v_cvt_pk_bf16_f32 v210, v140, v141
  buffer_load_dwordx4 v233, s[60:63], s70 offen offset:1024 lds
  v_cvt_pk_bf16_f32 v211, v142, v143
  buffer_store_dwordx4 v[208:211], v18, s[16:19], 0 offen offset:2048 sc1
  v_pk_fma_f32 v[144:145], v[144:145], v[224:225], v[216:217] neg_lo:[0,0,1] neg_hi:[0,0,1]
  v_pk_fma_f32 v[146:147], v[146:147], v[226:227], v[218:219] neg_lo:[0,0,1] neg_hi:[0,0,1]
  v_cvt_pk_bf16_f32 v212, v144, v145
  v_cvt_pk_bf16_f32 v213, v146, v147
  v_pk_fma_f32 v[148:149], v[148:149], v[228:229], v[220:221] neg_lo:[0,0,1] neg_hi:[0,0,1]
  v_pk_fma_f32 v[150:151], v[150:151], v[230:231], v[222:223] neg_lo:[0,0,1] neg_hi:[0,0,1]
  v_cvt_pk_bf16_f32 v214, v148, v149
  v_cvt_pk_bf16_f32 v215, v150, v151
  buffer_store_dwordx4 v[212:215], v18, s[16:19], 0 offen offset:3072 sc1
  v_pk_fma_f32 v[152:153], v[152:153], v[224:225], v[216:217] neg_lo:[0,0,1] neg_hi:[0,0,1]
  buffer_load_dwordx4 v234, s[60:63], s70 offen offset:2048 lds
  v_pk_fma_f32 v[154:155], v[154:155], v[226:227], v[218:219] neg_lo:[0,0,1] neg_hi:[0,0,1]
  v_cvt_pk_bf16_f32 v200, v152, v153
  v_cvt_pk_bf16_f32 v201, v154, v155
  v_pk_fma_f32 v[156:157], v[156:157], v[228:229], v[220:221] neg_lo:[0,0,1] neg_hi:[0,0,1]
  v_pk_fma_f32 v[158:159], v[158:159], v[230:231], v[222:223] neg_lo:[0,0,1] neg_hi:[0,0,1]
  v_cvt_pk_bf16_f32 v202, v156, v157
  v_cvt_pk_bf16_f32 v203, v158, v159
  buffer_store_dwordx4 v[200:203], v19, s[16:19], 0 offen offset:0 sc1
  v_pk_fma_f32 v[160:161], v[160:161], v[224:225], v[216:217] neg_lo:[0,0,1] neg_hi:[0,0,1]
  v_pk_fma_f32 v[162:163], v[162:163], v[226:227], v[218:219] neg_lo:[0,0,1] neg_hi:[0,0,1]
  v_cvt_pk_bf16_f32 v204, v160, v161
  buffer_load_dwordx4 v235, s[60:63], s70 offen offset:3072 lds
  v_cvt_pk_bf16_f32 v205, v162, v163
  v_pk_fma_f32 v[164:165], v[164:165], v[228:229], v[220:221] neg_lo:[0,0,1] neg_hi:[0,0,1]
  v_pk_fma_f32 v[166:167], v[166:167], v[230:231], v[222:223] neg_lo:[0,0,1] neg_hi:[0,0,1]
  v_cvt_pk_bf16_f32 v206, v164, v165
  v_cvt_pk_bf16_f32 v207, v166, v167
  buffer_store_dwordx4 v[204:207], v19, s[16:19], 0 offen offset:1024 sc1
  v_pk_fma_f32 v[168:169], v[168:169], v[224:225], v[216:217] neg_lo:[0,0,1] neg_hi:[0,0,1]
  v_pk_fma_f32 v[170:171], v[170:171], v[226:227], v[218:219] neg_lo:[0,0,1] neg_hi:[0,0,1]
  v_cvt_pk_bf16_f32 v208, v168, v169
  v_cvt_pk_bf16_f32 v209, v170, v171
  v_pk_fma_f32 v[172:173], v[172:173], v[228:229], v[220:221] neg_lo:[0,0,1] neg_hi:[0,0,1]
  s_add_u32 m0, s75, 8192
  s_add_u32 s70, s68, 512
  buffer_load_dwordx4 v232, s[60:63], s70 offen offset:0 lds
  v_pk_fma_f32 v[174:175], v[174:175], v[230:231], v[222:223] neg_lo:[0,0,1] neg_hi:[0,0,1]
  v_cvt_pk_bf16_f32 v210, v172, v173
  v_cvt_pk_bf16_f32 v211, v174, v175
  buffer_store_dwordx4 v[208:211], v19, s[16:19], 0 offen offset:2048 sc1
  v_lshlrev_b32 v3, 4, v12
  v_add_u32 v4, 4096, v3
  s_mul_i32 s23, s21, 458752
  s_add_u32 s12, s58, s23
  s_addc_u32 s13, s59, 0
  s_and_b32 s13, s13, 0xffff
  s_mov_b32 s14, 458752
  s_mov_b32 s15, 0x20000
  s_mul_i32 s26, s3, 114688
  s_mov_b32 s25, 0
  s_and_b32 s23, s22, 7
  s_mul_i32 s23, s23, 896
  v_and_b32 v31, 7, v12
  v_min_u32 v31, 6, v31
  v_lshlrev_b32 v31, 7, v31
  v_bfe_u32 v30, v12, 3, 2
  v_mul_u32_u24 v30, 7168, v30
  buffer_load_dwordx4 v233, s[60:63], s70 offen offset:1024 lds
  v_add3_u32 v31, v31, v30, s23
  s_mul_i32 s27, s21, 4352
  s_lshl_b32 s23, s3, 5
  s_add_u32 s27, s27, s23
  s_add_u32 s27, s27, 14942208
  v_and_b32 v9, 3, v12
  v_lshl_add_u32 v9, v9, 3, s27
  v_pk_mul_f32 v[216:217], v[64:65], v[64:65]
  v_pk_mul_f32 v[220:221], v[66:67], v[66:67]
  v_pk_fma_f32 v[216:217], v[216:217], v[34:35], v[32:33]
  v_pk_fma_f32 v[220:221], v[220:221], v[34:35], v[32:33]
  v_pk_mul_f32 v[216:217], v[216:217], v[64:65]
  v_pk_mul_f32 v[220:221], v[220:221], v[66:67]
  v_exp_f32 v216, v216
  buffer_load_dwordx4 v234, s[60:63], s70 offen offset:2048 lds
  v_exp_f32 v217, v217
  v_exp_f32 v220, v220
  v_exp_f32 v221, v221
  v_pk_add_f32 v[216:217], v[216:217], v[36:37]
  v_pk_add_f32 v[220:221], v[220:221], v[36:37]
  v_rcp_f32 v216, v216
  v_rcp_f32 v217, v217
  v_rcp_f32 v220, v220
  v_rcp_f32 v221, v221
  v_pk_mul_f32 v[64:65], v[64:65], v[216:217]
  buffer_load_dwordx4 v235, s[60:63], s70 offen offset:3072 lds
  v_pk_mul_f32 v[66:67], v[66:67], v[220:221]
  v_pk_mul_f32 v[216:217], v[68:69], v[68:69]
  v_pk_mul_f32 v[220:221], v[70:71], v[70:71]
  v_pk_fma_f32 v[216:217], v[216:217], v[34:35], v[32:33]
  v_pk_fma_f32 v[220:221], v[220:221], v[34:35], v[32:33]
  v_pk_mul_f32 v[216:217], v[216:217], v[68:69]
  v_pk_mul_f32 v[220:221], v[220:221], v[70:71]
  v_exp_f32 v216, v216
  v_exp_f32 v217, v217
  v_exp_f32 v220, v220
  s_add_u32 m0, s75, 12288
  s_add_u32 s70, s69, 512
  buffer_load_dwordx4 v232, s[60:63], s70 offen offset:0 lds
  v_exp_f32 v221, v221
  v_pk_add_f32 v[216:217], v[216:217], v[36:37]
  v_pk_add_f32 v[220:221], v[220:221], v[36:37]
  v_rcp_f32 v216, v216
  v_rcp_f32 v217, v217
  v_rcp_f32 v220, v220
  v_rcp_f32 v221, v221
  v_pk_mul_f32 v[68:69], v[68:69], v[216:217]
  v_pk_mul_f32 v[70:71], v[70:71], v[220:221]
  v_pk_mul_f32 v[216:217], v[72:73], v[72:73]
  buffer_load_dwordx4 v233, s[60:63], s70 offen offset:1024 lds
  v_pk_mul_f32 v[220:221], v[74:75], v[74:75]
  v_pk_fma_f32 v[216:217], v[216:217], v[34:35], v[32:33]
  v_pk_fma_f32 v[220:221], v[220:221], v[34:35], v[32:33]
  v_pk_mul_f32 v[216:217], v[216:217], v[72:73]
  v_pk_mul_f32 v[220:221], v[220:221], v[74:75]
  v_exp_f32 v216, v216
  v_exp_f32 v217, v217
  v_exp_f32 v220, v220
  v_exp_f32 v221, v221
  v_pk_add_f32 v[216:217], v[216:217], v[36:37]
  buffer_load_dwordx4 v234, s[60:63], s70 offen offset:2048 lds
  v_pk_add_f32 v[220:221], v[220:221], v[36:37]
  v_rcp_f32 v216, v216
  v_rcp_f32 v217, v217
  v_rcp_f32 v220, v220
  v_rcp_f32 v221, v221
  v_pk_mul_f32 v[72:73], v[72:73], v[216:217]
  v_pk_mul_f32 v[74:75], v[74:75], v[220:221]
  v_pk_mul_f32 v[216:217], v[76:77], v[76:77]
  v_pk_mul_f32 v[220:221], v[78:79], v[78:79]
  v_pk_fma_f32 v[216:217], v[216:217], v[34:35], v[32:33]
  buffer_load_dwordx4 v235, s[60:63], s70 offen offset:3072 lds
  v_pk_fma_f32 v[220:221], v[220:221], v[34:35], v[32:33]
  v_pk_mul_f32 v[216:217], v[216:217], v[76:77]
  v_pk_mul_f32 v[220:221], v[220:221], v[78:79]
  v_exp_f32 v216, v216
  v_exp_f32 v217, v217
  v_exp_f32 v220, v220
  v_exp_f32 v221, v221
  v_pk_add_f32 v[216:217], v[216:217], v[36:37]
  v_pk_add_f32 v[220:221], v[220:221], v[36:37]
  v_rcp_f32 v216, v216
  s_add_u32 m0, s75, 16384
  s_add_u32 s70, s68, 640
  buffer_load_dwordx4 v232, s[60:63], s70 offen offset:0 lds
  v_rcp_f32 v217, v217
  v_rcp_f32 v220, v220
  v_rcp_f32 v221, v221
  v_pk_mul_f32 v[76:77], v[76:77], v[216:217]
  v_pk_mul_f32 v[78:79], v[78:79], v[220:221]
  s_waitcnt vmcnt(8)
  s_barrier
  s_mul_i32 s27, s21, 4352
  s_lshl_b32 s28, s20, 3
  s_add_u32 s27, s27, s28
  s_add_u32 s27, s27, 14942208
  s_cmp_lg_u32 s3, 0
  s_cbranch_scc1 mega_sigzd
  v_mov_b32 v18, s27
  v_mov_b32 v16, s76
  v_mov_b32 v17, s77
  s_mov_b64 s[34:35], exec
  s_mov_b64 exec, 1
  global_store_dwordx2 v18, v[16:17], s[58:59] sc1
  s_mov_b64 exec, s[34:35]
mega_sigzd:
  ds_read_b128 a[72:75], v236 offset:8192
  ds_read_b128 a[88:91], v237 offset:8192
  ds_read_b128 a[76:79], v238 offset:8192
  ds_read_b128 a[92:95], v239 offset:8192
  s_waitcnt lgkmcnt(0)
  v_pk_mul_f32 v[216:217], v[80:81], v[80:81]
  v_pk_mul_f32 v[220:221], v[82:83], v[82:83]
  v_pk_fma_f32 v[216:217], v[216:217], v[34:35], v[32:33]
  v_pk_fma_f32 v[220:221], v[220:221], v[34:35], v[32:33]
  v_pk_mul_f32 v[216:217], v[216:217], v[80:81]
  buffer_load_dwordx4 v233, s[60:63], s70 offen offset:1024 lds
  v_pk_mul_f32 v[220:221], v[220:221], v[82:83]
  v_exp_f32 v216, v216
  v_exp_f32 v217, v217
  v_exp_f32 v220, v220
  v_exp_f32 v221, v221
  v_pk_add_f32 v[216:217], v[216:217], v[36:37]
  v_pk_add_f32 v[220:221], v[220:221], v[36:37]
  v_rcp_f32 v216, v216
  v_rcp_f32 v217, v217
  v_rcp_f32 v220, v220
  buffer_load_dwordx4 v234, s[60:63], s70 offen offset:2048 lds
  v_rcp_f32 v221, v221
  v_pk_mul_f32 v[80:81], v[80:81], v[216:217]
  v_pk_mul_f32 v[82:83], v[82:83], v[220:221]
  v_pk_mul_f32 v[216:217], v[84:85], v[84:85]
  v_pk_mul_f32 v[220:221], v[86:87], v[86:87]
  v_pk_fma_f32 v[216:217], v[216:217], v[34:35], v[32:33]
  v_pk_fma_f32 v[220:221], v[220:221], v[34:35], v[32:33]
  v_pk_mul_f32 v[216:217], v[216:217], v[84:85]
  v_pk_mul_f32 v[220:221], v[220:221], v[86:87]
  v_exp_f32 v216, v216
  buffer_load_dwordx4 v235, s[60:63], s70 offen offset:3072 lds
  v_exp_f32 v217, v217
  v_exp_f32 v220, v220
  v_exp_f32 v221, v221
  v_pk_add_f32 v[216:217], v[216:217], v[36:37]
  v_pk_add_f32 v[220:221], v[220:221], v[36:37]
  v_rcp_f32 v216, v216
  v_rcp_f32 v217, v217
  v_rcp_f32 v220, v220
  v_rcp_f32 v221, v221
  v_pk_mul_f32 v[84:85], v[84:85], v[216:217]
  s_add_u32 m0, s75, 20480
  s_add_u32 s70, s69, 640
  buffer_load_dwordx4 v232, s[60:63], s70 offen offset:0 lds
  v_pk_mul_f32 v[86:87], v[86:87], v[220:221]
  v_pk_mul_f32 v[216:217], v[88:89], v[88:89]
  v_pk_mul_f32 v[220:221], v[90:91], v[90:91]
  v_pk_fma_f32 v[216:217], v[216:217], v[34:35], v[32:33]
  v_pk_fma_f32 v[220:221], v[220:221], v[34:35], v[32:33]
  v_pk_mul_f32 v[216:217], v[216:217], v[88:89]
  v_pk_mul_f32 v[220:221], v[220:221], v[90:91]
  v_exp_f32 v216, v216
  v_exp_f32 v217, v217
  v_exp_f32 v220, v220
  buffer_load_dwordx4 v233, s[60:63], s70 offen offset:1024 lds
  v_exp_f32 v221, v221
  v_pk_add_f32 v[216:217], v[216:217], v[36:37]
  v_pk_add_f32 v[220:221], v[220:221], v[36:37]
  v_rcp_f32 v216, v216
  v_rcp_f32 v217, v217
  v_rcp_f32 v220, v220
  v_rcp_f32 v221, v221
  v_pk_mul_f32 v[88:89], v[88:89], v[216:217]
  v_pk_mul_f32 v[90:91], v[90:91], v[220:221]
  v_pk_mul_f32 v[216:217], v[92:93], v[92:93]
  buffer_load_dwordx4 v234, s[60:63], s70 offen offset:2048 lds
  v_pk_mul_f32 v[220:221], v[94:95], v[94:95]
  v_pk_fma_f32 v[216:217], v[216:217], v[34:35], v[32:33]
  v_pk_fma_f32 v[220:221], v[220:221], v[34:35], v[32:33]
  v_pk_mul_f32 v[216:217], v[216:217], v[92:93]
  v_pk_mul_f32 v[220:221], v[220:221], v[94:95]
  v_exp_f32 v216, v216
  v_exp_f32 v217, v217
  v_exp_f32 v220, v220
  v_exp_f32 v221, v221
  v_pk_add_f32 v[216:217], v[216:217], v[36:37]
  buffer_load_dwordx4 v235, s[60:63], s70 offen offset:3072 lds
  v_pk_add_f32 v[220:221], v[220:221], v[36:37]
  v_rcp_f32 v216, v216
  v_rcp_f32 v217, v217
  v_rcp_f32 v220, v220
  v_rcp_f32 v221, v221
  v_pk_mul_f32 v[92:93], v[92:93], v[216:217]
  v_pk_mul_f32 v[94:95], v[94:95], v[220:221]
  v_pk_mul_f32 v[216:217], v[96:97], v[96:97]
  v_pk_mul_f32 v[220:221], v[98:99], v[98:99]
  v_pk_fma_f32 v[216:217], v[216:217], v[34:35], v[32:33]
  s_add_u32 m0, s75, 24576
  s_add_u32 s70, s68, 768
  buffer_load_dwordx4 v232, s[60:63], s70 offen offset:0 lds
  v_pk_fma_f32 v[220:221], v[220:221], v[34:35], v[32:33]
  v_pk_mul_f32 v[216:217], v[216:217], v[96:97]
  v_pk_mul_f32 v[220:221], v[220:221], v[98:99]
  v_exp_f32 v216, v216
  v_exp_f32 v217, v217
  v_exp_f32 v220, v220
  v_exp_f32 v221, v221
  v_pk_add_f32 v[216:217], v[216:217], v[36:37]
  v_pk_add_f32 v[220:221], v[220:221], v[36:37]
  v_rcp_f32 v216, v216
  buffer_load_dwordx4 v233, s[60:63], s70 offen offset:1024 lds
  v_rcp_f32 v217, v217
  v_rcp_f32 v220, v220
  v_rcp_f32 v221, v221
  v_pk_mul_f32 v[96:97], v[96:97], v[216:217]
  v_pk_mul_f32 v[98:99], v[98:99], v[220:221]
  v_pk_mul_f32 v[216:217], v[100:101], v[100:101]
  v_pk_mul_f32 v[220:221], v[102:103], v[102:103]
  v_pk_fma_f32 v[216:217], v[216:217], v[34:35], v[32:33]
  v_pk_fma_f32 v[220:221], v[220:221], v[34:35], v[32:33]
  v_pk_mul_f32 v[216:217], v[216:217], v[100:101]
  buffer_load_dwordx4 v234, s[60:63], s70 offen offset:2048 lds
  v_pk_mul_f32 v[220:221], v[220:221], v[102:103]
  v_exp_f32 v216, v216
  v_exp_f32 v217, v217
  v_exp_f32 v220, v220
  v_exp_f32 v221, v221
  v_pk_add_f32 v[216:217], v[216:217], v[36:37]
  v_pk_add_f32 v[220:221], v[220:221], v[36:37]
  v_rcp_f32 v216, v216
  v_rcp_f32 v217, v217
  v_rcp_f32 v220, v220
  buffer_load_dwordx4 v235, s[60:63], s70 offen offset:3072 lds
  v_rcp_f32 v221, v221
  v_pk_mul_f32 v[100:101], v[100:101], v[216:217]
  v_pk_mul_f32 v[102:103], v[102:103], v[220:221]
  v_pk_mul_f32 v[216:217], v[104:105], v[104:105]
  v_pk_mul_f32 v[220:221], v[106:107], v[106:107]
  v_pk_fma_f32 v[216:217], v[216:217], v[34:35], v[32:33]
  v_pk_fma_f32 v[220:221], v[220:221], v[34:35], v[32:33]
  v_pk_mul_f32 v[216:217], v[216:217], v[104:105]
  v_pk_mul_f32 v[220:221], v[220:221], v[106:107]
  v_exp_f32 v216, v216
  s_add_u32 m0, s74, 8192
  s_add_u32 s70, s69, 896
  buffer_load_dwordx4 v232, s[60:63], s70 offen offset:0 lds
  v_exp_f32 v217, v217
  v_exp_f32 v220, v220
  v_exp_f32 v221, v221
  v_pk_add_f32 v[216:217], v[216:217], v[36:37]
  v_pk_add_f32 v[220:221], v[220:221], v[36:37]
  v_rcp_f32 v216, v216
  v_rcp_f32 v217, v217
  v_rcp_f32 v220, v220
  v_rcp_f32 v221, v221
  v_pk_mul_f32 v[104:105], v[104:105], v[216:217]
  buffer_load_dwordx4 v233, s[60:63], s70 offen offset:1024 lds
  v_pk_mul_f32 v[106:107], v[106:107], v[220:221]
  v_pk_mul_f32 v[216:217], v[108:109], v[108:109]
  v_pk_mul_f32 v[220:221], v[110:111], v[110:111]
  v_pk_fma_f32 v[216:217], v[216:217], v[34:35], v[32:33]
  v_pk_fma_f32 v[220:221], v[220:221], v[34:35], v[32:33]
  v_pk_mul_f32 v[216:217], v[216:217], v[108:109]
  v_pk_mul_f32 v[220:221], v[220:221], v[110:111]
  v_exp_f32 v216, v216
  v_exp_f32 v217, v217
  v_exp_f32 v220, v220
  buffer_load_dwordx4 v234, s[60:63], s70 offen offset:2048 lds
  v_exp_f32 v221, v221
  v_pk_add_f32 v[216:217], v[216:217], v[36:37]
  v_pk_add_f32 v[220:221], v[220:221], v[36:37]
  v_rcp_f32 v216, v216
  v_rcp_f32 v217, v217
  v_rcp_f32 v220, v220
  v_rcp_f32 v221, v221
  v_pk_mul_f32 v[108:109], v[108:109], v[216:217]
  v_pk_mul_f32 v[110:111], v[110:111], v[220:221]
  v_pk_mul_f32 v[216:217], v[112:113], v[112:113]
  buffer_load_dwordx4 v235, s[60:63], s70 offen offset:3072 lds
  v_pk_mul_f32 v[220:221], v[114:115], v[114:115]
  v_pk_fma_f32 v[216:217], v[216:217], v[34:35], v[32:33]
  v_pk_fma_f32 v[220:221], v[220:221], v[34:35], v[32:33]
  v_pk_mul_f32 v[216:217], v[216:217], v[112:113]
  v_pk_mul_f32 v[220:221], v[220:221], v[114:115]
  v_exp_f32 v216, v216
  v_exp_f32 v217, v217
  v_exp_f32 v220, v220
  v_exp_f32 v221, v221
  v_pk_add_f32 v[216:217], v[216:217], v[36:37]
  v_pk_add_f32 v[220:221], v[220:221], v[36:37]
  v_rcp_f32 v216, v216
  v_rcp_f32 v217, v217
  v_rcp_f32 v220, v220
  v_rcp_f32 v221, v221
  v_pk_mul_f32 v[112:113], v[112:113], v[216:217]
  v_pk_mul_f32 v[114:115], v[114:115], v[220:221]
  v_pk_mul_f32 v[216:217], v[116:117], v[116:117]
  v_pk_mul_f32 v[220:221], v[118:119], v[118:119]
  v_pk_fma_f32 v[216:217], v[216:217], v[34:35], v[32:33]
  v_pk_fma_f32 v[220:221], v[220:221], v[34:35], v[32:33]
  v_pk_mul_f32 v[216:217], v[216:217], v[116:117]
  v_pk_mul_f32 v[220:221], v[220:221], v[118:119]
  v_exp_f32 v216, v216
  v_exp_f32 v217, v217
  v_exp_f32 v220, v220
  v_exp_f32 v221, v221
  v_pk_add_f32 v[216:217], v[216:217], v[36:37]
  v_pk_add_f32 v[220:221], v[220:221], v[36:37]
  v_rcp_f32 v216, v216
  v_rcp_f32 v217, v217
  v_rcp_f32 v220, v220
  v_rcp_f32 v221, v221
  v_pk_mul_f32 v[116:117], v[116:117], v[216:217]
  v_pk_mul_f32 v[118:119], v[118:119], v[220:221]
  global_load_dwordx2 v[10:11], v9, s[58:59] sc1
  s_lshl_b32 s23, s72, 1
  s_mul_i32 s23, s23, 56
  s_mul_i32 s28, s21, 7
  s_add_u32 s23, s23, s28
  s_lshl_b32 s23, s23, 9
  s_add_u32 s23, s23, 3670016
  s_add_u32 s16, s58, s23
  s_addc_u32 s17, s59, 0
  s_and_b32 s17, s17, 0xffff
  s_mov_b32 s18, 32256
  s_mov_b32 s19, 0x20000
  v_lshlrev_b32 v18, 3, v12
  v_cvt_pk_bf16_f32 v40, v64, v65
  v_cvt_pk_bf16_f32 v41, v66, v67
  buffer_store_dwordx2 v[40:41], v18, s[16:19], 0 offen offset:0 sc1
  v_cvt_pk_bf16_f32 v42, v72, v73
  v_cvt_pk_bf16_f32 v43, v74, v75
  buffer_store_dwordx2 v[42:43], v18, s[16:19], 0 offen offset:512 sc1
  v_cvt_pk_bf16_f32 v44, v80, v81
  v_cvt_pk_bf16_f32 v45, v82, v83
  buffer_store_dwordx2 v[44:45], v18, s[16:19], 0 offen offset:1024 sc1
  v_cvt_pk_bf16_f32 v46, v88, v89
  v_cvt_pk_bf16_f32 v47, v90, v91
  buffer_store_dwordx2 v[46:47], v18, s[16:19], 0 offen offset:1536 sc1
  v_cvt_pk_bf16_f32 v40, v96, v97
  v_cvt_pk_bf16_f32 v41, v98, v99
  buffer_store_dwordx2 v[40:41], v18, s[16:19], 0 offen offset:2048 sc1
  v_cvt_pk_bf16_f32 v42, v104, v105
  v_cvt_pk_bf16_f32 v43, v106, v107
  buffer_store_dwordx2 v[42:43], v18, s[16:19], 0 offen offset:2560 sc1
  v_cvt_pk_bf16_f32 v44, v112, v113
  v_cvt_pk_bf16_f32 v45, v114, v115
  buffer_store_dwordx2 v[44:45], v18, s[16:19], 0 offen offset:3072 sc1
  s_mov_b32 s23, 28672
  v_cvt_pk_bf16_f32 v40, v68, v69
  v_cvt_pk_bf16_f32 v41, v70, v71
  buffer_store_dwordx2 v[40:41], v18, s[16:19], s23 offen offset:0 sc1
  v_cvt_pk_bf16_f32 v42, v76, v77
  v_cvt_pk_bf16_f32 v43, v78, v79
  buffer_store_dwordx2 v[42:43], v18, s[16:19], s23 offen offset:512 sc1
  v_cvt_pk_bf16_f32 v44, v84, v85
  v_cvt_pk_bf16_f32 v45, v86, v87
  buffer_store_dwordx2 v[44:45], v18, s[16:19], s23 offen offset:1024 sc1
  v_cvt_pk_bf16_f32 v46, v92, v93
  v_cvt_pk_bf16_f32 v47, v94, v95
  buffer_store_dwordx2 v[46:47], v18, s[16:19], s23 offen offset:1536 sc1
  v_cvt_pk_bf16_f32 v40, v100, v101
  v_cvt_pk_bf16_f32 v41, v102, v103
  buffer_store_dwordx2 v[40:41], v18, s[16:19], s23 offen offset:2048 sc1
  v_cvt_pk_bf16_f32 v42, v108, v109
  v_cvt_pk_bf16_f32 v43, v110, v111
  buffer_store_dwordx2 v[42:43], v18, s[16:19], s23 offen offset:2560 sc1
  v_cvt_pk_bf16_f32 v44, v116, v117
  v_cvt_pk_bf16_f32 v45, v118, v119
  buffer_store_dwordx2 v[44:45], v18, s[16:19], s23 offen offset:3072 sc1
  s_waitcnt vmcnt(14)
  v_xor_b32 v10, s76, v10
  v_xor_b32 v11, s77, v11
  v_or_b32 v10, v10, v11
  v_cmp_eq_u32 vcc, 0, v10
  s_nop 1
  s_cmp_eq_u64 vcc, exec
  s_cbranch_scc1 mega_zfaok
  s_mov_b32 s33, 0
mega_zpaw_loop:
  global_load_dwordx2 v[18:19], v9, s[58:59] sc1
  s_add_u32 s33, s33, 1
  s_waitcnt vmcnt(0)
  v_xor_b32 v18, s76, v18
  v_xor_b32 v19, s77, v19
  v_or_b32 v18, v18, v19
  v_cmp_eq_u32 vcc, 0, v18
  s_nop 1
  s_cmp_eq_u64 vcc, exec
  s_cbranch_scc1 mega_zpaw_out
  s_sleep 2
  s_cmp_lt_u32 s33, 0x20000
  s_cbranch_scc1 mega_zpaw_loop
mega_zpaw_out:
mega_zfaok:
  s_add_u32 s27, s26, 0
  buffer_load_dwordx4 v[144:147], v3, s[12:15], s27 offen offset:0 sc1
  buffer_load_dwordx4 v[148:151], v3, s[12:15], s27 offen offset:1024 sc1
  buffer_load_dwordx4 v[152:155], v3, s[12:15], s27 offen offset:2048 sc1
  buffer_load_dwordx4 v[156:159], v3, s[12:15], s27 offen offset:3072 sc1
  buffer_load_dwordx4 v[160:163], v4, s[12:15], s27 offen offset:0 sc1
  buffer_load_dwordx4 v[164:167], v4, s[12:15], s27 offen offset:1024 sc1
  buffer_load_dwordx4 v[168:171], v4, s[12:15], s27 offen offset:2048 sc1
  ds_read_b128 a[200:203], v236 offset:0
  ds_read_b128 a[216:219], v237 offset:0
  ds_read_b128 a[204:207], v238 offset:0
  ds_read_b128 a[220:223], v239 offset:0
  ds_read_b128 a[224:227], v236 offset:4096
  ds_read_b128 a[240:243], v237 offset:4096
  ds_read_b128 a[228:231], v238 offset:4096
  ds_read_b128 a[244:247], v239 offset:4096
  ds_read_b128 a[232:235], v236 offset:8192
  ds_read_b128 a[248:251], v237 offset:8192
  ds_read_b128 a[236:239], v238 offset:8192
  ds_read_b128 a[252:255], v239 offset:8192
  ds_read_b128 a[96:99], v241 offset:0
  ds_read_b128 a[112:115], v242 offset:0
  ds_read_b128 a[100:103], v243 offset:0
  ds_read_b128 a[116:119], v244 offset:0
  ds_read_b128 a[104:107], v241 offset:4096
  ds_read_b128 a[120:123], v242 offset:4096
  ds_read_b128 a[108:111], v243 offset:4096
  ds_read_b128 a[124:127], v244 offset:4096
  ds_read_b128 a[128:131], v241 offset:8192
  ds_read_b128 a[144:147], v242 offset:8192
  ds_read_b128 a[132:135], v243 offset:8192
  ds_read_b128 a[148:151], v244 offset:8192
  ds_read_b128 a[136:139], v241 offset:12288
  ds_read_b128 a[152:155], v242 offset:12288
  ds_read_b128 a[140:143], v243 offset:12288
  ds_read_b128 a[156:159], v244 offset:12288
  ds_read_b128 a[160:163], v241 offset:16384
  ds_read_b128 a[176:179], v242 offset:16384
  ds_read_b128 a[164:167], v243 offset:16384
  ds_read_b128 a[180:183], v244 offset:16384
  ds_read_b128 a[168:171], v241 offset:20480
  ds_read_b128 a[184:187], v242 offset:20480
  ds_read_b128 a[172:175], v243 offset:20480
  ds_read_b128 a[188:191], v244 offset:20480
  ds_read_b128 a[192:195], v241 offset:24576
  ds_read_b128 a[208:211], v242 offset:24576
  ds_read_b128 a[196:199], v243 offset:24576
  ds_read_b128 a[212:215], v244 offset:24576
  s_add_u32 s24, s26, 21504
  buffer_load_dword v30, v31, s[12:15], s24 offen sc1
  s_add_u32 s27, s26, 7168
  buffer_load_dwordx4 v[172:175], v3, s[12:15], s27 offen offset:0 sc1
  buffer_load_dwordx4 v[176:179], v3, s[12:15], s27 offen offset:1024 sc1
  buffer_load_dwordx4 v[180:183], v3, s[12:15], s27 offen offset:2048 sc1
  buffer_load_dwordx4 v[184:187], v3, s[12:15], s27 offen offset:3072 sc1
  buffer_load_dwordx4 v[188:191], v4, s[12:15], s27 offen offset:0 sc1
  buffer_load_dwordx4 v[192:195], v4, s[12:15], s27 offen offset:1024 sc1
  buffer_load_dwordx4 v[196:199], v4, s[12:15], s27 offen offset:2048 sc1
  s_add_u32 s27, s26, 14336
  buffer_load_dwordx4 v[200:203], v3, s[12:15], s27 offen offset:0 sc1
  buffer_load_dwordx4 v[204:207], v3, s[12:15], s27 offen offset:1024 sc1
  buffer_load_dwordx4 v[208:211], v3, s[12:15], s27 offen offset:2048 sc1
  buffer_load_dwordx4 v[212:215], v3, s[12:15], s27 offen offset:3072 sc1
  buffer_load_dwordx4 v[216:219], v4, s[12:15], s27 offen offset:0 sc1
  buffer_load_dwordx4 v[220:223], v4, s[12:15], s27 offen offset:1024 sc1
  buffer_load_dwordx4 v[224:227], v4, s[12:15], s27 offen offset:2048 sc1
  s_waitcnt lgkmcnt(0)
  s_waitcnt vmcnt(15)
  v_mfma_f32_16x16x32_bf16 v[32:35], v[144:147], a[0:3], 0
  s_mul_i32 s33, s21, 180224
  s_add_u32 s33, s33, 13107200
  s_add_u32 s8, s58, s33
  s_addc_u32 s9, s59, 0
  s_and_b32 s9, s9, 0xffff
  s_mov_b32 s10, 180224
  s_mov_b32 s11, 0x20000
  s_cmp_eq_u32 s21, 7
  s_cselect_b32 s10, 0, s10
  s_add_u32 s27, s26, 21504
  buffer_load_dwordx4 v[228:231], v3, s[12:15], s27 offen offset:0 sc1
  v_mfma_f32_16x16x32_bf16 v[36:39], v[144:147], a[4:7], 0
  s_mul_i32 s33, s22, 180224
  s_add_u32 s33, s33, 7340032
  s_add_u32 s16, s58, s33
  s_addc_u32 s17, s59, 0
  s_and_b32 s17, s17, 0xffff
  s_mov_b32 s18, 180224
  s_mov_b32 s19, 0x20000
  v_mfma_f32_16x16x32_bf16 v[40:43], v[144:147], a[8:11], 0
  s_xor_b32 s33, s3, 0
  s_lshl_b32 s33, s33, 10
  v_add_u32 v5, s33, v3
  buffer_load_dwordx4 v[232:235], v3, s[12:15], s27 offen offset:1024 sc1
  v_mfma_f32_16x16x32_bf16 v[44:47], v[144:147], a[12:15], 0
  s_xor_b32 s33, s3, 1
  s_lshl_b32 s33, s33, 10
  v_add_u32 v6, s33, v3
  v_mfma_f32_16x16x32_bf16 v[48:51], v[148:151], a[0:3], 0
  s_xor_b32 s33, s3, 2
  s_lshl_b32 s33, s33, 10
  v_add_u32 v7, s33, v3
  buffer_load_dwordx4 v[236:239], v3, s[12:15], s27 offen offset:2048 sc1
  v_mfma_f32_16x16x32_bf16 v[52:55], v[148:151], a[4:7], 0
  s_xor_b32 s33, s3, 3
  s_lshl_b32 s33, s33, 10
  v_add_u32 v8, s33, v3
  v_mfma_f32_16x16x32_bf16 v[56:59], v[148:151], a[8:11], 0
  s_lshl_b32 s28, s3, 14
  buffer_load_dwordx4 v[240:243], v3, s[12:15], s27 offen offset:3072 sc1
  v_mfma_f32_16x16x32_bf16 v[60:63], v[148:151], a[12:15], 0
  s_mul_i32 s29, s3, 28672
  s_add_u32 s29, s29, 65536
  v_mfma_f32_16x16x32_bf16 v[64:67], v[152:155], a[0:3], 0
  s_lshl_b32 s30, s22, 2
  s_add_u32 s30, s30, s3
  s_mul_i32 s31, s30, 56
  s_mul_i32 s32, s21, 7
  s_add_u32 s31, s31, s32
  s_lshl_b32 s31, s31, 9
  s_add_u32 s31, s31, 3670016
  s_add_u32 s64, s58, s31
  s_addc_u32 s65, s59, 0
  s_and_b32 s65, s65, 0xffff
  s_mov_b32 s66, 3584
  s_mov_b32 s67, 0x20000
  buffer_load_dwordx4 v[244:247], v4, s[12:15], s27 offen offset:0 sc1
  v_mfma_f32_16x16x32_bf16 v[68:71], v[152:155], a[4:7], 0
  v_lshlrev_b32 v10, 3, v12
  v_mfma_f32_16x16x32_bf16 v[72:75], v[152:155], a[8:11], 0
  s_lshl_b32 s31, s22, 6
  s_lshr_b32 s32, s3, 1
  s_lshl_b32 s32, s32, 5
  s_add_u32 s31, s31, s32
  s_and_b32 s32, s3, 1
  s_lshl_b32 s32, s32, 2
  s_add_u32 s31, s31, s32
  buffer_load_dwordx4 v[248:251], v4, s[12:15], s27 offen offset:1024 sc1
  v_mfma_f32_16x16x32_bf16 v[76:79], v[152:155], a[12:15], 0
  v_lshrrev_b32 v11, 2, v13
  v_mfma_f32_16x16x32_bf16 v[80:83], v[156:159], a[0:3], 0
  v_lshlrev_b32 v11, 3, v11
  buffer_load_dwordx4 v[252:255], v4, s[12:15], s27 offen offset:2048 sc1
  v_mfma_f32_16x16x32_bf16 v[84:87], v[156:159], a[4:7], 0
  v_and_b32 v1, 3, v13
  v_mfma_f32_16x16x32_bf16 v[88:91], v[156:159], a[8:11], 0
  v_add_u32 v11, v11, v1
  v_mfma_f32_16x16x32_bf16 v[92:95], v[156:159], a[12:15], 0
  v_add_u32 v11, s31, v11
  v_mfma_f32_16x16x32_bf16 v[96:99], v[160:163], a[0:3], 0
  v_lshlrev_b32 v15, 2, v11
  v_mfma_f32_16x16x32_bf16 v[100:103], v[160:163], a[4:7], 0
  v_add_u32 v15, 14368768, v15
  v_mfma_f32_16x16x32_bf16 v[104:107], v[160:163], a[8:11], 0
  v_lshlrev_b32 v11, 1, v11
  v_mfma_f32_16x16x32_bf16 v[108:111], v[160:163], a[12:15], 0
  s_mul_i32 s33, s21, 11
  v_mfma_f32_16x16x32_bf16 v[112:115], v[164:167], a[0:3], 0
  v_subrev_u32 v1, 8, v12
  v_mfma_f32_16x16x32_bf16 v[116:119], v[164:167], a[4:7], 0
  v_min_u32 v1, 11, v1
  v_mfma_f32_16x16x32_bf16 v[120:123], v[164:167], a[8:11], 0
  v_add_u32 v1, s33, v1
  v_mfma_f32_16x16x32_bf16 v[124:127], v[164:167], a[12:15], 0
  v_min_u32 v1, 76, v1
  v_mfma_f32_16x16x32_bf16 v[128:131], v[168:171], a[0:3], 0
  s_lshl_b32 s33, s20, 3
  v_mfma_f32_16x16x32_bf16 v[132:135], v[168:171], a[4:7], 0
  v_add_u32 v2, s33, v12
  v_mfma_f32_16x16x32_bf16 v[136:139], v[168:171], a[8:11], 0
  v_cmp_gt_u32 vcc, 8, v12
  v_mfma_f32_16x16x32_bf16 v[140:143], v[168:171], a[12:15], 0
  s_nop 0
  v_cndmask_b32 v1, v1, v2, vcc
  s_waitcnt vmcnt(14)
  s_add_u32 s24, s26, 50176
  buffer_load_dword v30, v31, s[12:15], s24 offen sc1
  v_mfma_f32_16x16x32_bf16 v[32:35], v[172:175], a[16:19], v[32:35]
  v_lshrrev_b32 v2, 3, v1
  s_add_u32 s27, s26, 28672
  buffer_load_dwordx4 v[144:147], v3, s[12:15], s27 offen offset:0 sc1
  v_mfma_f32_16x16x32_bf16 v[36:39], v[172:175], a[20:23], v[36:39]
  v_mul_u32_u24 v2, 4352, v2
  v_mfma_f32_16x16x32_bf16 v[40:43], v[172:175], a[24:27], v[40:43]
  v_and_b32 v1, 7, v1
  v_mfma_f32_16x16x32_bf16 v[44:47], v[172:175], a[28:31], v[44:47]
  v_lshl_add_u32 v2, v1, 3, v2
  v_mfma_f32_16x16x32_bf16 v[48:51], v[176:179], a[16:19], v[48:51]
  v_add_u32 v2, 15073280, v2
  buffer_load_dwordx4 v[148:151], v3, s[12:15], s27 offen offset:1024 sc1
  v_mfma_f32_16x16x32_bf16 v[52:55], v[176:179], a[20:23], v[52:55]
  s_mul_i32 s33, s20, 4352
  s_lshl_b32 s32, s21, 3
  s_add_u32 s33, s33, s32
  s_add_u32 s33, s33, 15466496
  v_mov_b32 v9, s33
  v_mfma_f32_16x16x32_bf16 v[56:59], v[176:179], a[24:27], v[56:59]
  v_mfma_f32_16x16x32_bf16 v[60:63], v[176:179], a[28:31], v[60:63]
  v_mfma_f32_16x16x32_bf16 v[64:67], v[180:183], a[16:19], v[64:67]
  buffer_load_dwordx4 v[152:155], v3, s[12:15], s27 offen offset:2048 sc1
  v_mfma_f32_16x16x32_bf16 v[68:71], v[180:183], a[20:23], v[68:71]
  v_mfma_f32_16x16x32_bf16 v[72:75], v[180:183], a[24:27], v[72:75]
  v_mfma_f32_16x16x32_bf16 v[76:79], v[180:183], a[28:31], v[76:79]
  v_mfma_f32_16x16x32_bf16 v[80:83], v[184:187], a[16:19], v[80:83]
  buffer_load_dwordx4 v[156:159], v3, s[12:15], s27 offen offset:3072 sc1
  v_mfma_f32_16x16x32_bf16 v[84:87], v[184:187], a[20:23], v[84:87]
  v_mfma_f32_16x16x32_bf16 v[88:91], v[184:187], a[24:27], v[88:91]
  v_mfma_f32_16x16x32_bf16 v[92:95], v[184:187], a[28:31], v[92:95]
  v_mfma_f32_16x16x32_bf16 v[96:99], v[188:191], a[16:19], v[96:99]
  buffer_load_dwordx4 v[160:163], v4, s[12:15], s27 offen offset:0 sc1
  v_mfma_f32_16x16x32_bf16 v[100:103], v[188:191], a[20:23], v[100:103]
  v_mfma_f32_16x16x32_bf16 v[104:107], v[188:191], a[24:27], v[104:107]
  v_mfma_f32_16x16x32_bf16 v[108:111], v[188:191], a[28:31], v[108:111]
  v_mfma_f32_16x16x32_bf16 v[112:115], v[192:195], a[16:19], v[112:115]
  buffer_load_dwordx4 v[164:167], v4, s[12:15], s27 offen offset:1024 sc1
  v_mfma_f32_16x16x32_bf16 v[116:119], v[192:195], a[20:23], v[116:119]
  v_mfma_f32_16x16x32_bf16 v[120:123], v[192:195], a[24:27], v[120:123]
  v_mfma_f32_16x16x32_bf16 v[124:127], v[192:195], a[28:31], v[124:127]
  v_mfma_f32_16x16x32_bf16 v[128:131], v[196:199], a[16:19], v[128:131]
  buffer_load_dwordx4 v[168:171], v4, s[12:15], s27 offen offset:2048 sc1
  v_mfma_f32_16x16x32_bf16 v[132:135], v[196:199], a[20:23], v[132:135]
  v_mfma_f32_16x16x32_bf16 v[136:139], v[196:199], a[24:27], v[136:139]
  v_mfma_f32_16x16x32_bf16 v[140:143], v[196:199], a[28:31], v[140:143]
  s_waitcnt vmcnt(15)
  v_mfma_f32_16x16x32_bf16 v[32:35], v[200:203], a[32:35], v[32:35]
  s_add_u32 s27, s26, 35840
  buffer_load_dwordx4 v[172:175], v3, s[12:15], s27 offen offset:0 sc1
  v_mfma_f32_16x16x32_bf16 v[36:39], v[200:203], a[36:39], v[36:39]
  v_mfma_f32_16x16x32_bf16 v[40:43], v[200:203], a[40:43], v[40:43]
  v_mfma_f32_16x16x32_bf16 v[44:47], v[200:203], a[44:47], v[44:47]
  v_mfma_f32_16x16x32_bf16 v[48:51], v[204:207], a[32:35], v[48:51]
  buffer_load_dwordx4 v[176:179], v3, s[12:15], s27 offen offset:1024 sc1
  v_mfma_f32_16x16x32_bf16 v[52:55], v[204:207], a[36:39], v[52:55]
  v_mfma_f32_16x16x32_bf16 v[56:59], v[204:207], a[40:43], v[56:59]
  v_mfma_f32_16x16x32_bf16 v[60:63], v[204:207], a[44:47], v[60:63]
  v_mfma_f32_16x16x32_bf16 v[64:67], v[208:211], a[32:35], v[64:67]
  buffer_load_dwordx4 v[180:183], v3, s[12:15], s27 offen offset:2048 sc1
  v_mfma_f32_16x16x32_bf16 v[68:71], v[208:211], a[36:39], v[68:71]
  v_mfma_f32_16x16x32_bf16 v[72:75], v[208:211], a[40:43], v[72:75]
  v_mfma_f32_16x16x32_bf16 v[76:79], v[208:211], a[44:47], v[76:79]
  v_mfma_f32_16x16x32_bf16 v[80:83], v[212:215], a[32:35], v[80:83]
  buffer_load_dwordx4 v[184:187], v3, s[12:15], s27 offen offset:3072 sc1
  v_mfma_f32_16x16x32_bf16 v[84:87], v[212:215], a[36:39], v[84:87]
  v_mfma_f32_16x16x32_bf16 v[88:91], v[212:215], a[40:43], v[88:91]
  v_mfma_f32_16x16x32_bf16 v[92:95], v[212:215], a[44:47], v[92:95]
  v_mfma_f32_16x16x32_bf16 v[96:99], v[216:219], a[32:35], v[96:99]
  buffer_load_dwordx4 v[188:191], v4, s[12:15], s27 offen offset:0 sc1
  v_mfma_f32_16x16x32_bf16 v[100:103], v[216:219], a[36:39], v[100:103]
  v_mfma_f32_16x16x32_bf16 v[104:107], v[216:219], a[40:43], v[104:107]
  v_mfma_f32_16x16x32_bf16 v[108:111], v[216:219], a[44:47], v[108:111]
  v_mfma_f32_16x16x32_bf16 v[112:115], v[220:223], a[32:35], v[112:115]
  buffer_load_dwordx4 v[192:195], v4, s[12:15], s27 offen offset:1024 sc1
  v_mfma_f32_16x16x32_bf16 v[116:119], v[220:223], a[36:39], v[116:119]
  v_mfma_f32_16x16x32_bf16 v[120:123], v[220:223], a[40:43], v[120:123]
  v_mfma_f32_16x16x32_bf16 v[124:127], v[220:223], a[44:47], v[124:127]
  v_mfma_f32_16x16x32_bf16 v[128:131], v[224:227], a[32:35], v[128:131]
  buffer_load_dwordx4 v[196:199], v4, s[12:15], s27 offen offset:2048 sc1
  v_mfma_f32_16x16x32_bf16 v[132:135], v[224:227], a[36:39], v[132:135]
  v_mfma_f32_16x16x32_bf16 v[136:139], v[224:227], a[40:43], v[136:139]
  v_mfma_f32_16x16x32_bf16 v[140:143], v[224:227], a[44:47], v[140:143]
  s_waitcnt vmcnt(15)
  v_mfma_f32_16x16x32_bf16 v[32:35], v[228:231], a[48:51], v[32:35]
  s_add_u32 s27, s26, 43008
  buffer_load_dwordx4 v[200:203], v3, s[12:15], s27 offen offset:0 sc1
  v_mfma_f32_16x16x32_bf16 v[36:39], v[228:231], a[52:55], v[36:39]
  v_mfma_f32_16x16x32_bf16 v[40:43], v[228:231], a[56:59], v[40:43]
  v_mfma_f32_16x16x32_bf16 v[44:47], v[228:231], a[60:63], v[44:47]
  v_mfma_f32_16x16x32_bf16 v[48:51], v[232:235], a[48:51], v[48:51]
  buffer_load_dwordx4 v[204:207], v3, s[12:15], s27 offen offset:1024 sc1
  v_mfma_f32_16x16x32_bf16 v[52:55], v[232:235], a[52:55], v[52:55]
  v_mfma_f32_16x16x32_bf16 v[56:59], v[232:235], a[56:59], v[56:59]
  v_mfma_f32_16x16x32_bf16 v[60:63], v[232:235], a[60:63], v[60:63]
  v_mfma_f32_16x16x32_bf16 v[64:67], v[236:239], a[48:51], v[64:67]
  buffer_load_dwordx4 v[208:211], v3, s[12:15], s27 offen offset:2048 sc1
  v_mfma_f32_16x16x32_bf16 v[68:71], v[236:239], a[52:55], v[68:71]
  v_mfma_f32_16x16x32_bf16 v[72:75], v[236:239], a[56:59], v[72:75]
  v_mfma_f32_16x16x32_bf16 v[76:79], v[236:239], a[60:63], v[76:79]
  v_mfma_f32_16x16x32_bf16 v[80:83], v[240:243], a[48:51], v[80:83]
  buffer_load_dwordx4 v[212:215], v3, s[12:15], s27 offen offset:3072 sc1
  v_mfma_f32_16x16x32_bf16 v[84:87], v[240:243], a[52:55], v[84:87]
  v_mfma_f32_16x16x32_bf16 v[88:91], v[240:243], a[56:59], v[88:91]
  v_mfma_f32_16x16x32_bf16 v[92:95], v[240:243], a[60:63], v[92:95]
  v_mfma_f32_16x16x32_bf16 v[96:99], v[244:247], a[48:51], v[96:99]
  buffer_load_dwordx4 v[216:219], v4, s[12:15], s27 offen offset:0 sc1
  v_mfma_f32_16x16x32_bf16 v[100:103], v[244:247], a[52:55], v[100:103]
  v_mfma_f32_16x16x32_bf16 v[104:107], v[244:247], a[56:59], v[104:107]
  v_mfma_f32_16x16x32_bf16 v[108:111], v[244:247], a[60:63], v[108:111]
  v_mfma_f32_16x16x32_bf16 v[112:115], v[248:251], a[48:51], v[112:115]
  buffer_load_dwordx4 v[220:223], v4, s[12:15], s27 offen offset:1024 sc1
  v_mfma_f32_16x16x32_bf16 v[116:119], v[248:251], a[52:55], v[116:119]
  v_mfma_f32_16x16x32_bf16 v[120:123], v[248:251], a[56:59], v[120:123]
  v_mfma_f32_16x16x32_bf16 v[124:127], v[248:251], a[60:63], v[124:127]
  v_mfma_f32_16x16x32_bf16 v[128:131], v[252:255], a[48:51], v[128:131]
  buffer_load_dwordx4 v[224:227], v4, s[12:15], s27 offen offset:2048 sc1
  v_mfma_f32_16x16x32_bf16 v[132:135], v[252:255], a[52:55], v[132:135]
  v_mfma_f32_16x16x32_bf16 v[136:139], v[252:255], a[56:59], v[136:139]
  v_mfma_f32_16x16x32_bf16 v[140:143], v[252:255], a[60:63], v[140:143]
  s_waitcnt vmcnt(14)
  s_barrier
  s_mul_i32 s24, s20, 4352
  s_lshl_b32 s23, s21, 3
  s_add_u32 s24, s24, s23
  s_add_u32 s24, s24, 15466496
  s_cmp_lg_u32 s3, 0
  s_cbranch_scc1 mega_zsigz1
  v_mov_b32 v22, s24
  v_mov_b32 v20, s76
  v_mov_b32 v21, s77
  s_mov_b64 s[34:35], exec
  s_mov_b64 exec, 1
  global_store_dwordx2 v22, v[20:21], s[58:59] sc1
  s_mov_b64 exec, s[34:35]
mega_zsigz1:
  v_mfma_f32_16x16x32_bf16 v[32:35], v[144:147], a[64:67], v[32:35]
  s_add_u32 s27, s26, 50176
  buffer_load_dwordx4 v[228:231], v3, s[12:15], s27 offen offset:0 sc1
  v_mfma_f32_16x16x32_bf16 v[36:39], v[144:147], a[68:71], v[36:39]
  v_mfma_f32_16x16x32_bf16 v[40:43], v[144:147], a[72:75], v[40:43]
  v_mfma_f32_16x16x32_bf16 v[44:47], v[144:147], a[76:79], v[44:47]
  v_mfma_f32_16x16x32_bf16 v[48:51], v[148:151], a[64:67], v[48:51]
  buffer_load_dwordx4 v[232:235], v3, s[12:15], s27 offen offset:1024 sc1
  v_mfma_f32_16x16x32_bf16 v[52:55], v[148:151], a[68:71], v[52:55]
  v_mfma_f32_16x16x32_bf16 v[56:59], v[148:151], a[72:75], v[56:59]
  v_mfma_f32_16x16x32_bf16 v[60:63], v[148:151], a[76:79], v[60:63]
  v_mfma_f32_16x16x32_bf16 v[64:67], v[152:155], a[64:67], v[64:67]
  buffer_load_dwordx4 v[236:239], v3, s[12:15], s27 offen offset:2048 sc1
  v_mfma_f32_16x16x32_bf16 v[68:71], v[152:155], a[68:71], v[68:71]
  v_mfma_f32_16x16x32_bf16 v[72:75], v[152:155], a[72:75], v[72:75]
  v_mfma_f32_16x16x32_bf16 v[76:79], v[152:155], a[76:79], v[76:79]
  v_mfma_f32_16x16x32_bf16 v[80:83], v[156:159], a[64:67], v[80:83]
  buffer_load_dwordx4 v[240:243], v3, s[12:15], s27 offen offset:3072 sc1
  v_mfma_f32_16x16x32_bf16 v[84:87], v[156:159], a[68:71], v[84:87]
  v_mfma_f32_16x16x32_bf16 v[88:91], v[156:159], a[72:75], v[88:91]
  v_mfma_f32_16x16x32_bf16 v[92:95], v[156:159], a[76:79], v[92:95]
  v_mfma_f32_16x16x32_bf16 v[96:99], v[160:163], a[64:67], v[96:99]
  buffer_load_dwordx4 v[244:247], v4, s[12:15], s27 offen offset:0 sc1
  v_mfma_f32_16x16x32_bf16 v[100:103], v[160:163], a[68:71], v[100:103]
  v_mfma_f32_16x16x32_bf16 v[104:107], v[160:163], a[72:75], v[104:107]
  v_mfma_f32_16x16x32_bf16 v[108:111], v[160:163], a[76:79], v[108:111]
  v_mfma_f32_16x16x32_bf16 v[112:115], v[164:167], a[64:67], v[112:115]
  buffer_load_dwordx4 v[248:251], v4, s[12:15], s27 offen offset:1024 sc1
  v_mfma_f32_16x16x32_bf16 v[116:119], v[164:167], a[68:71], v[116:119]
  v_mfma_f32_16x16x32_bf16 v[120:123], v[164:167], a[72:75], v[120:123]
  v_mfma_f32_16x16x32_bf16 v[124:127], v[164:167], a[76:79], v[124:127]
  v_mfma_f32_16x16x32_bf16 v[128:131], v[168:171], a[64:67], v[128:131]
  buffer_load_dwordx4 v[252:255], v4, s[12:15], s27 offen offset:2048 sc1
  v_mfma_f32_16x16x32_bf16 v[132:135], v[168:171], a[68:71], v[132:135]
  v_mfma_f32_16x16x32_bf16 v[136:139], v[168:171], a[72:75], v[136:139]
  v_mfma_f32_16x16x32_bf16 v[140:143], v[168:171], a[76:79], v[140:143]
  s_waitcnt vmcnt(14)
  s_add_u32 s24, s26, 78848
  buffer_load_dword v30, v31, s[12:15], s24 offen sc1
  v_mfma_f32_16x16x32_bf16 v[32:35], v[172:175], a[80:83], v[32:35]
  s_add_u32 s27, s26, 57344
  buffer_load_dwordx4 v[144:147], v3, s[12:15], s27 offen offset:0 sc1
  v_mfma_f32_16x16x32_bf16 v[36:39], v[172:175], a[84:87], v[36:39]
  v_mfma_f32_16x16x32_bf16 v[40:43], v[172:175], a[88:91], v[40:43]
  v_mfma_f32_16x16x32_bf16 v[44:47], v[172:175], a[92:95], v[44:47]
  v_mfma_f32_16x16x32_bf16 v[48:51], v[176:179], a[80:83], v[48:51]
  buffer_load_dwordx4 v[148:151], v3, s[12:15], s27 offen offset:1024 sc1
  v_mfma_f32_16x16x32_bf16 v[52:55], v[176:179], a[84:87], v[52:55]
  v_mfma_f32_16x16x32_bf16 v[56:59], v[176:179], a[88:91], v[56:59]
  v_mfma_f32_16x16x32_bf16 v[60:63], v[176:179], a[92:95], v[60:63]
  v_mfma_f32_16x16x32_bf16 v[64:67], v[180:183], a[80:83], v[64:67]
  buffer_load_dwordx4 v[152:155], v3, s[12:15], s27 offen offset:2048 sc1
  v_mfma_f32_16x16x32_bf16 v[68:71], v[180:183], a[84:87], v[68:71]
  v_mfma_f32_16x16x32_bf16 v[72:75], v[180:183], a[88:91], v[72:75]
  v_mfma_f32_16x16x32_bf16 v[76:79], v[180:183], a[92:95], v[76:79]
  v_mfma_f32_16x16x32_bf16 v[80:83], v[184:187], a[80:83], v[80:83]
  buffer_load_dwordx4 v[156:159], v3, s[12:15], s27 offen offset:3072 sc1
  v_mfma_f32_16x16x32_bf16 v[84:87], v[184:187], a[84:87], v[84:87]
  v_mfma_f32_16x16x32_bf16 v[88:91], v[184:187], a[88:91], v[88:91]
  v_mfma_f32_16x16x32_bf16 v[92:95], v[184:187], a[92:95], v[92:95]
  v_mfma_f32_16x16x32_bf16 v[96:99], v[188:191], a[80:83], v[96:99]
  buffer_load_dwordx4 v[160:163], v4, s[12:15], s27 offen offset:0 sc1
  v_mfma_f32_16x16x32_bf16 v[100:103], v[188:191], a[84:87], v[100:103]
  v_mfma_f32_16x16x32_bf16 v[104:107], v[188:191], a[88:91], v[104:107]
  v_mfma_f32_16x16x32_bf16 v[108:111], v[188:191], a[92:95], v[108:111]
  v_mfma_f32_16x16x32_bf16 v[112:115], v[192:195], a[80:83], v[112:115]
  buffer_load_dwordx4 v[164:167], v4, s[12:15], s27 offen offset:1024 sc1
  v_mfma_f32_16x16x32_bf16 v[116:119], v[192:195], a[84:87], v[116:119]
  v_mfma_f32_16x16x32_bf16 v[120:123], v[192:195], a[88:91], v[120:123]
  v_mfma_f32_16x16x32_bf16 v[124:127], v[192:195], a[92:95], v[124:127]
  v_mfma_f32_16x16x32_bf16 v[128:131], v[196:199], a[80:83], v[128:131]
  buffer_load_dwordx4 v[168:171], v4, s[12:15], s27 offen offset:2048 sc1
  v_mfma_f32_16x16x32_bf16 v[132:135], v[196:199], a[84:87], v[132:135]
  v_mfma_f32_16x16x32_bf16 v[136:139], v[196:199], a[88:91], v[136:139]
  v_mfma_f32_16x16x32_bf16 v[140:143], v[196:199], a[92:95], v[140:143]
  s_waitcnt vmcnt(15)
  v_mfma_f32_16x16x32_bf16 v[32:35], v[200:203], a[96:99], v[32:35]
  s_add_u32 s27, s26, 64512
  buffer_load_dwordx4 v[172:175], v3, s[12:15], s27 offen offset:0 sc1
  v_mfma_f32_16x16x32_bf16 v[36:39], v[200:203], a[100:103], v[36:39]
  v_mfma_f32_16x16x32_bf16 v[40:43], v[200:203], a[104:107], v[40:43]
  v_mfma_f32_16x16x32_bf16 v[44:47], v[200:203], a[108:111], v[44:47]
  v_mfma_f32_16x16x32_bf16 v[48:51], v[204:207], a[96:99], v[48:51]
  buffer_load_dwordx4 v[176:179], v3, s[12:15], s27 offen offset:1024 sc1
  v_mfma_f32_16x16x32_bf16 v[52:55], v[204:207], a[100:103], v[52:55]
  v_mfma_f32_16x16x32_bf16 v[56:59], v[204:207], a[104:107], v[56:59]
  v_mfma_f32_16x16x32_bf16 v[60:63], v[204:207], a[108:111], v[60:63]
  v_mfma_f32_16x16x32_bf16 v[64:67], v[208:211], a[96:99], v[64:67]
  buffer_load_dwordx4 v[180:183], v3, s[12:15], s27 offen offset:2048 sc1
  v_mfma_f32_16x16x32_bf16 v[68:71], v[208:211], a[100:103], v[68:71]
  v_mfma_f32_16x16x32_bf16 v[72:75], v[208:211], a[104:107], v[72:75]
  v_mfma_f32_16x16x32_bf16 v[76:79], v[208:211], a[108:111], v[76:79]
  v_mfma_f32_16x16x32_bf16 v[80:83], v[212:215], a[96:99], v[80:83]
  buffer_load_dwordx4 v[184:187], v3, s[12:15], s27 offen offset:3072 sc1
  v_mfma_f32_16x16x32_bf16 v[84:87], v[212:215], a[100:103], v[84:87]
  v_mfma_f32_16x16x32_bf16 v[88:91], v[212:215], a[104:107], v[88:91]
  v_mfma_f32_16x16x32_bf16 v[92:95], v[212:215], a[108:111], v[92:95]
  v_mfma_f32_16x16x32_bf16 v[96:99], v[216:219], a[96:99], v[96:99]
  buffer_load_dwordx4 v[188:191], v4, s[12:15], s27 offen offset:0 sc1
  v_mfma_f32_16x16x32_bf16 v[100:103], v[216:219], a[100:103], v[100:103]
  v_mfma_f32_16x16x32_bf16 v[104:107], v[216:219], a[104:107], v[104:107]
  v_mfma_f32_16x16x32_bf16 v[108:111], v[216:219], a[108:111], v[108:111]
  v_mfma_f32_16x16x32_bf16 v[112:115], v[220:223], a[96:99], v[112:115]
  buffer_load_dwordx4 v[192:195], v4, s[12:15], s27 offen offset:1024 sc1
  v_mfma_f32_16x16x32_bf16 v[116:119], v[220:223], a[100:103], v[116:119]
  v_mfma_f32_16x16x32_bf16 v[120:123], v[220:223], a[104:107], v[120:123]
  v_mfma_f32_16x16x32_bf16 v[124:127], v[220:223], a[108:111], v[124:127]
  v_mfma_f32_16x16x32_bf16 v[128:131], v[224:227], a[96:99], v[128:131]
  buffer_load_dwordx4 v[196:199], v4, s[12:15], s27 offen offset:2048 sc1
  v_mfma_f32_16x16x32_bf16 v[132:135], v[224:227], a[100:103], v[132:135]
  v_mfma_f32_16x16x32_bf16 v[136:139], v[224:227], a[104:107], v[136:139]
  v_mfma_f32_16x16x32_bf16 v[140:143], v[224:227], a[108:111], v[140:143]
  s_waitcnt vmcnt(15)
  v_mfma_f32_16x16x32_bf16 v[32:35], v[228:231], a[112:115], v[32:35]
  s_add_u32 s27, s26, 71680
  buffer_load_dwordx4 v[200:203], v3, s[12:15], s27 offen offset:0 sc1
  v_mfma_f32_16x16x32_bf16 v[36:39], v[228:231], a[116:119], v[36:39]
  v_mfma_f32_16x16x32_bf16 v[40:43], v[228:231], a[120:123], v[40:43]
  v_mfma_f32_16x16x32_bf16 v[44:47], v[228:231], a[124:127], v[44:47]
  v_mfma_f32_16x16x32_bf16 v[48:51], v[232:235], a[112:115], v[48:51]
  buffer_load_dwordx4 v[204:207], v3, s[12:15], s27 offen offset:1024 sc1
  v_mfma_f32_16x16x32_bf16 v[52:55], v[232:235], a[116:119], v[52:55]
  v_mfma_f32_16x16x32_bf16 v[56:59], v[232:235], a[120:123], v[56:59]
  v_mfma_f32_16x16x32_bf16 v[60:63], v[232:235], a[124:127], v[60:63]
  v_mfma_f32_16x16x32_bf16 v[64:67], v[236:239], a[112:115], v[64:67]
  buffer_load_dwordx4 v[208:211], v3, s[12:15], s27 offen offset:2048 sc1
  v_mfma_f32_16x16x32_bf16 v[68:71], v[236:239], a[116:119], v[68:71]
  v_mfma_f32_16x16x32_bf16 v[72:75], v[236:239], a[120:123], v[72:75]
  v_mfma_f32_16x16x32_bf16 v[76:79], v[236:239], a[124:127], v[76:79]
  v_mfma_f32_16x16x32_bf16 v[80:83], v[240:243], a[112:115], v[80:83]
  buffer_load_dwordx4 v[212:215], v3, s[12:15], s27 offen offset:3072 sc1
  v_mfma_f32_16x16x32_bf16 v[84:87], v[240:243], a[116:119], v[84:87]
  v_mfma_f32_16x16x32_bf16 v[88:91], v[240:243], a[120:123], v[88:91]
  v_mfma_f32_16x16x32_bf16 v[92:95], v[240:243], a[124:127], v[92:95]
  v_mfma_f32_16x16x32_bf16 v[96:99], v[244:247], a[112:115], v[96:99]
  buffer_load_dwordx4 v[216:219], v4, s[12:15], s27 offen offset:0 sc1
  v_mfma_f32_16x16x32_bf16 v[100:103], v[244:247], a[116:119], v[100:103]
  v_mfma_f32_16x16x32_bf16 v[104:107], v[244:247], a[120:123], v[104:107]
  v_mfma_f32_16x16x32_bf16 v[108:111], v[244:247], a[124:127], v[108:111]
  v_mfma_f32_16x16x32_bf16 v[112:115], v[248:251], a[112:115], v[112:115]
  buffer_load_dwordx4 v[220:223], v4, s[12:15], s27 offen offset:1024 sc1
  v_mfma_f32_16x16x32_bf16 v[116:119], v[248:251], a[116:119], v[116:119]
  v_mfma_f32_16x16x32_bf16 v[120:123], v[248:251], a[120:123], v[120:123]
  v_mfma_f32_16x16x32_bf16 v[124:127], v[248:251], a[124:127], v[124:127]
  v_mfma_f32_16x16x32_bf16 v[128:131], v[252:255], a[112:115], v[128:131]
  buffer_load_dwordx4 v[224:227], v4, s[12:15], s27 offen offset:2048 sc1
  v_mfma_f32_16x16x32_bf16 v[132:135], v[252:255], a[116:119], v[132:135]
  v_mfma_f32_16x16x32_bf16 v[136:139], v[252:255], a[120:123], v[136:139]
  v_mfma_f32_16x16x32_bf16 v[140:143], v[252:255], a[124:127], v[140:143]
  s_waitcnt vmcnt(14)
  global_load_dwordx2 v[16:17], v2, s[58:59] sc1
  v_mov_b32 v18, s76
  v_mov_b32 v19, s77
  v_mfma_f32_16x16x32_bf16 v[32:35], v[144:147], a[128:131], v[32:35]
  s_add_u32 s27, s26, 78848
  buffer_load_dwordx4 v[228:231], v3, s[12:15], s27 offen offset:0 sc1
  v_mfma_f32_16x16x32_bf16 v[36:39], v[144:147], a[132:135], v[36:39]
  v_mfma_f32_16x16x32_bf16 v[40:43], v[144:147], a[136:139], v[40:43]
  v_mfma_f32_16x16x32_bf16 v[44:47], v[144:147], a[140:143], v[44:47]
  v_mfma_f32_16x16x32_bf16 v[48:51], v[148:151], a[128:131], v[48:51]
  buffer_load_dwordx4 v[232:235], v3, s[12:15], s27 offen offset:1024 sc1
  v_mfma_f32_16x16x32_bf16 v[52:55], v[148:151], a[132:135], v[52:55]
  v_mfma_f32_16x16x32_bf16 v[56:59], v[148:151], a[136:139], v[56:59]
  v_mfma_f32_16x16x32_bf16 v[60:63], v[148:151], a[140:143], v[60:63]
  v_mfma_f32_16x16x32_bf16 v[64:67], v[152:155], a[128:131], v[64:67]
  buffer_load_dwordx4 v[236:239], v3, s[12:15], s27 offen offset:2048 sc1
  v_mfma_f32_16x16x32_bf16 v[68:71], v[152:155], a[132:135], v[68:71]
  v_mfma_f32_16x16x32_bf16 v[72:75], v[152:155], a[136:139], v[72:75]
  v_mfma_f32_16x16x32_bf16 v[76:79], v[152:155], a[140:143], v[76:79]
  v_mfma_f32_16x16x32_bf16 v[80:83], v[156:159], a[128:131], v[80:83]
  buffer_load_dwordx4 v[240:243], v3, s[12:15], s27 offen offset:3072 sc1
  v_mfma_f32_16x16x32_bf16 v[84:87], v[156:159], a[132:135], v[84:87]
  v_mfma_f32_16x16x32_bf16 v[88:91], v[156:159], a[136:139], v[88:91]
  v_mfma_f32_16x16x32_bf16 v[92:95], v[156:159], a[140:143], v[92:95]
  v_mfma_f32_16x16x32_bf16 v[96:99], v[160:163], a[128:131], v[96:99]
  buffer_load_dwordx4 v[244:247], v4, s[12:15], s27 offen offset:0 sc1
  v_mfma_f32_16x16x32_bf16 v[100:103], v[160:163], a[132:135], v[100:103]
  v_mfma_f32_16x16x32_bf16 v[104:107], v[160:163], a[136:139], v[104:107]
  v_mfma_f32_16x16x32_bf16 v[108:111], v[160:163], a[140:143], v[108:111]
  v_mfma_f32_16x16x32_bf16 v[112:115], v[164:167], a[128:131], v[112:115]
  buffer_load_dwordx4 v[248:251], v4, s[12:15], s27 offen offset:1024 sc1
  v_mfma_f32_16x16x32_bf16 v[116:119], v[164:167], a[132:135], v[116:119]
  v_mfma_f32_16x16x32_bf16 v[120:123], v[164:167], a[136:139], v[120:123]
  v_mfma_f32_16x16x32_bf16 v[124:127], v[164:167], a[140:143], v[124:127]
  v_mfma_f32_16x16x32_bf16 v[128:131], v[168:171], a[128:131], v[128:131]
  buffer_load_dwordx4 v[252:255], v4, s[12:15], s27 offen offset:2048 sc1
  v_mfma_f32_16x16x32_bf16 v[132:135], v[168:171], a[132:135], v[132:135]
  v_mfma_f32_16x16x32_bf16 v[136:139], v[168:171], a[136:139], v[136:139]
  v_mfma_f32_16x16x32_bf16 v[140:143], v[168:171], a[140:143], v[140:143]
  s_waitcnt vmcnt(15)
  s_add_u32 s24, s26, 107520
  buffer_load_dword v30, v31, s[12:15], s24 offen sc1
  v_mfma_f32_16x16x32_bf16 v[32:35], v[172:175], a[144:147], v[32:35]
  s_add_u32 s27, s26, 86016
  buffer_load_dwordx4 v[144:147], v3, s[12:15], s27 offen offset:0 sc1
  v_mfma_f32_16x16x32_bf16 v[36:39], v[172:175], a[148:151], v[36:39]
  v_mfma_f32_16x16x32_bf16 v[40:43], v[172:175], a[152:155], v[40:43]
  v_mfma_f32_16x16x32_bf16 v[44:47], v[172:175], a[156:159], v[44:47]
  v_mfma_f32_16x16x32_bf16 v[48:51], v[176:179], a[144:147], v[48:51]
  buffer_load_dwordx4 v[148:151], v3, s[12:15], s27 offen offset:1024 sc1
  v_mfma_f32_16x16x32_bf16 v[52:55], v[176:179], a[148:151], v[52:55]
  v_mfma_f32_16x16x32_bf16 v[56:59], v[176:179], a[152:155], v[56:59]
  v_mfma_f32_16x16x32_bf16 v[60:63], v[176:179], a[156:159], v[60:63]
  v_mfma_f32_16x16x32_bf16 v[64:67], v[180:183], a[144:147], v[64:67]
  buffer_load_dwordx4 v[152:155], v3, s[12:15], s27 offen offset:2048 sc1
  v_mfma_f32_16x16x32_bf16 v[68:71], v[180:183], a[148:151], v[68:71]
  v_mfma_f32_16x16x32_bf16 v[72:75], v[180:183], a[152:155], v[72:75]
  v_mfma_f32_16x16x32_bf16 v[76:79], v[180:183], a[156:159], v[76:79]
  v_mfma_f32_16x16x32_bf16 v[80:83], v[184:187], a[144:147], v[80:83]
  buffer_load_dwordx4 v[156:159], v3, s[12:15], s27 offen offset:3072 sc1
  v_mfma_f32_16x16x32_bf16 v[84:87], v[184:187], a[148:151], v[84:87]
  v_mfma_f32_16x16x32_bf16 v[88:91], v[184:187], a[152:155], v[88:91]
  v_mfma_f32_16x16x32_bf16 v[92:95], v[184:187], a[156:159], v[92:95]
  v_mfma_f32_16x16x32_bf16 v[96:99], v[188:191], a[144:147], v[96:99]
  buffer_load_dwordx4 v[160:163], v4, s[12:15], s27 offen offset:0 sc1
  v_mfma_f32_16x16x32_bf16 v[100:103], v[188:191], a[148:151], v[100:103]
  v_mfma_f32_16x16x32_bf16 v[104:107], v[188:191], a[152:155], v[104:107]
  v_mfma_f32_16x16x32_bf16 v[108:111], v[188:191], a[156:159], v[108:111]
  v_mfma_f32_16x16x32_bf16 v[112:115], v[192:195], a[144:147], v[112:115]
  buffer_load_dwordx4 v[164:167], v4, s[12:15], s27 offen offset:1024 sc1
  v_mfma_f32_16x16x32_bf16 v[116:119], v[192:195], a[148:151], v[116:119]
  v_mfma_f32_16x16x32_bf16 v[120:123], v[192:195], a[152:155], v[120:123]
  v_mfma_f32_16x16x32_bf16 v[124:127], v[192:195], a[156:159], v[124:127]
  v_mfma_f32_16x16x32_bf16 v[128:131], v[196:199], a[144:147], v[128:131]
  buffer_load_dwordx4 v[168:171], v4, s[12:15], s27 offen offset:2048 sc1
  v_mfma_f32_16x16x32_bf16 v[132:135], v[196:199], a[148:151], v[132:135]
  v_mfma_f32_16x16x32_bf16 v[136:139], v[196:199], a[152:155], v[136:139]
  v_mfma_f32_16x16x32_bf16 v[140:143], v[196:199], a[156:159], v[140:143]
  s_waitcnt vmcnt(16)
  v_mfma_f32_16x16x32_bf16 v[32:35], v[200:203], a[160:163], v[32:35]
  s_add_u32 s27, s26, 93184
  buffer_load_dwordx4 v[172:175], v3, s[12:15], s27 offen offset:0 sc1
  v_mfma_f32_16x16x32_bf16 v[36:39], v[200:203], a[164:167], v[36:39]
  v_mfma_f32_16x16x32_bf16 v[40:43], v[200:203], a[168:171], v[40:43]
  v_mfma_f32_16x16x32_bf16 v[44:47], v[200:203], a[172:175], v[44:47]
  v_mfma_f32_16x16x32_bf16 v[48:51], v[204:207], a[160:163], v[48:51]
  buffer_load_dwordx4 v[176:179], v3, s[12:15], s27 offen offset:1024 sc1
  v_mfma_f32_16x16x32_bf16 v[52:55], v[204:207], a[164:167], v[52:55]
  v_mfma_f32_16x16x32_bf16 v[56:59], v[204:207], a[168:171], v[56:59]
  v_mfma_f32_16x16x32_bf16 v[60:63], v[204:207], a[172:175], v[60:63]
  v_mfma_f32_16x16x32_bf16 v[64:67], v[208:211], a[160:163], v[64:67]
  buffer_load_dwordx4 v[180:183], v3, s[12:15], s27 offen offset:2048 sc1
  v_mfma_f32_16x16x32_bf16 v[68:71], v[208:211], a[164:167], v[68:71]
  v_mfma_f32_16x16x32_bf16 v[72:75], v[208:211], a[168:171], v[72:75]
  v_mfma_f32_16x16x32_bf16 v[76:79], v[208:211], a[172:175], v[76:79]
  v_mfma_f32_16x16x32_bf16 v[80:83], v[212:215], a[160:163], v[80:83]
  buffer_load_dwordx4 v[184:187], v3, s[12:15], s27 offen offset:3072 sc1
  v_mfma_f32_16x16x32_bf16 v[84:87], v[212:215], a[164:167], v[84:87]
  v_mfma_f32_16x16x32_bf16 v[88:91], v[212:215], a[168:171], v[88:91]
  v_mfma_f32_16x16x32_bf16 v[92:95], v[212:215], a[172:175], v[92:95]
  v_mfma_f32_16x16x32_bf16 v[96:99], v[216:219], a[160:163], v[96:99]
  buffer_load_dwordx4 v[188:191], v4, s[12:15], s27 offen offset:0 sc1
  v_mfma_f32_16x16x32_bf16 v[100:103], v[216:219], a[164:167], v[100:103]
  v_mfma_f32_16x16x32_bf16 v[104:107], v[216:219], a[168:171], v[104:107]
  v_mfma_f32_16x16x32_bf16 v[108:111], v[216:219], a[172:175], v[108:111]
  v_mfma_f32_16x16x32_bf16 v[112:115], v[220:223], a[160:163], v[112:115]
  buffer_load_dwordx4 v[192:195], v4, s[12:15], s27 offen offset:1024 sc1
  v_mfma_f32_16x16x32_bf16 v[116:119], v[220:223], a[164:167], v[116:119]
  v_mfma_f32_16x16x32_bf16 v[120:123], v[220:223], a[168:171], v[120:123]
  v_mfma_f32_16x16x32_bf16 v[124:127], v[220:223], a[172:175], v[124:127]
  v_mfma_f32_16x16x32_bf16 v[128:131], v[224:227], a[160:163], v[128:131]
  buffer_load_dwordx4 v[196:199], v4, s[12:15], s27 offen offset:2048 sc1
  v_mfma_f32_16x16x32_bf16 v[132:135], v[224:227], a[164:167], v[132:135]
  v_mfma_f32_16x16x32_bf16 v[136:139], v[224:227], a[168:171], v[136:139]
  v_mfma_f32_16x16x32_bf16 v[140:143], v[224:227], a[172:175], v[140:143]
  s_waitcnt vmcnt(15)
  v_mfma_f32_16x16x32_bf16 v[32:35], v[228:231], a[176:179], v[32:35]
  s_add_u32 s27, s26, 100352
  buffer_load_dwordx4 v[200:203], v3, s[12:15], s27 offen offset:0 sc1
  v_mfma_f32_16x16x32_bf16 v[36:39], v[228:231], a[180:183], v[36:39]
  v_mfma_f32_16x16x32_bf16 v[40:43], v[228:231], a[184:187], v[40:43]
  v_mfma_f32_16x16x32_bf16 v[44:47], v[228:231], a[188:191], v[44:47]
  v_mfma_f32_16x16x32_bf16 v[48:51], v[232:235], a[176:179], v[48:51]
  buffer_load_dwordx4 v[204:207], v3, s[12:15], s27 offen offset:1024 sc1
  v_mfma_f32_16x16x32_bf16 v[52:55], v[232:235], a[180:183], v[52:55]
  v_mfma_f32_16x16x32_bf16 v[56:59], v[232:235], a[184:187], v[56:59]
  v_mfma_f32_16x16x32_bf16 v[60:63], v[232:235], a[188:191], v[60:63]
  v_mfma_f32_16x16x32_bf16 v[64:67], v[236:239], a[176:179], v[64:67]
  buffer_load_dwordx4 v[208:211], v3, s[12:15], s27 offen offset:2048 sc1
  v_mfma_f32_16x16x32_bf16 v[68:71], v[236:239], a[180:183], v[68:71]
  v_mfma_f32_16x16x32_bf16 v[72:75], v[236:239], a[184:187], v[72:75]
  v_mfma_f32_16x16x32_bf16 v[76:79], v[236:239], a[188:191], v[76:79]
  v_mfma_f32_16x16x32_bf16 v[80:83], v[240:243], a[176:179], v[80:83]
  buffer_load_dwordx4 v[212:215], v3, s[12:15], s27 offen offset:3072 sc1
  v_mfma_f32_16x16x32_bf16 v[84:87], v[240:243], a[180:183], v[84:87]
  v_mfma_f32_16x16x32_bf16 v[88:91], v[240:243], a[184:187], v[88:91]
  v_mfma_f32_16x16x32_bf16 v[92:95], v[240:243], a[188:191], v[92:95]
  v_mfma_f32_16x16x32_bf16 v[96:99], v[244:247], a[176:179], v[96:99]
  buffer_load_dwordx4 v[216:219], v4, s[12:15], s27 offen offset:0 sc1
  v_mfma_f32_16x16x32_bf16 v[100:103], v[244:247], a[180:183], v[100:103]
  v_mfma_f32_16x16x32_bf16 v[104:107], v[244:247], a[184:187], v[104:107]
  v_mfma_f32_16x16x32_bf16 v[108:111], v[244:247], a[188:191], v[108:111]
  v_mfma_f32_16x16x32_bf16 v[112:115], v[248:251], a[176:179], v[112:115]
  buffer_load_dwordx4 v[220:223], v4, s[12:15], s27 offen offset:1024 sc1
  v_mfma_f32_16x16x32_bf16 v[116:119], v[248:251], a[180:183], v[116:119]
  v_mfma_f32_16x16x32_bf16 v[120:123], v[248:251], a[184:187], v[120:123]
  v_mfma_f32_16x16x32_bf16 v[124:127], v[248:251], a[188:191], v[124:127]
  v_mfma_f32_16x16x32_bf16 v[128:131], v[252:255], a[176:179], v[128:131]
  buffer_load_dwordx4 v[224:227], v4, s[12:15], s27 offen offset:2048 sc1
  v_mfma_f32_16x16x32_bf16 v[132:135], v[252:255], a[180:183], v[132:135]
  v_mfma_f32_16x16x32_bf16 v[136:139], v[252:255], a[184:187], v[136:139]
  v_mfma_f32_16x16x32_bf16 v[140:143], v[252:255], a[188:191], v[140:143]
  s_waitcnt vmcnt(14)
  v_xor_b32 v16, s76, v16
  v_xor_b32 v17, s77, v17
  v_xor_b32 v18, s76, v18
  v_xor_b32 v19, s77, v19
  v_or3_b32 v16, v16, v17, v18
  v_or_b32 v16, v16, v19
  v_cmp_eq_u32 vcc, 0, v16
  s_nop 1
  s_cmp_eq_u64 vcc, exec
  s_cbranch_scc1 mega_zallok
  s_mov_b32 s33, 0
mega_zallloop:
  global_load_dwordx2 v[16:17], v2, s[58:59] sc1
  global_load_dwordx2 v[18:19], v9, s[58:59] sc1
  s_add_u32 s33, s33, 1
  s_waitcnt vmcnt(0)
  v_xor_b32 v16, s76, v16
  v_xor_b32 v17, s77, v17
  v_xor_b32 v18, s76, v18
  v_xor_b32 v19, s77, v19
  v_or3_b32 v16, v16, v17, v18
  v_or_b32 v16, v16, v19
  v_cmp_eq_u32 vcc, 0, v16
  s_nop 1
  s_cmp_eq_u64 vcc, exec
  s_cbranch_scc1 mega_zallok
  s_sleep 2
  s_cmp_lt_u32 s33, 0x20000
  s_cbranch_scc1 mega_zallloop
mega_zallok:
  v_mfma_f32_16x16x32_bf16 v[32:35], v[144:147], a[192:195], v[32:35]
  s_add_u32 s27, s26, 107520
  buffer_load_dwordx4 v[228:231], v3, s[12:15], s27 offen offset:0 sc1
  v_mfma_f32_16x16x32_bf16 v[36:39], v[144:147], a[196:199], v[36:39]
  v_mfma_f32_16x16x32_bf16 v[40:43], v[144:147], a[200:203], v[40:43]
  v_mfma_f32_16x16x32_bf16 v[44:47], v[144:147], a[204:207], v[44:47]
  v_mfma_f32_16x16x32_bf16 v[48:51], v[148:151], a[192:195], v[48:51]
  buffer_load_dwordx4 v[232:235], v3, s[12:15], s27 offen offset:1024 sc1
  v_mfma_f32_16x16x32_bf16 v[52:55], v[148:151], a[196:199], v[52:55]
  v_mfma_f32_16x16x32_bf16 v[56:59], v[148:151], a[200:203], v[56:59]
  v_mfma_f32_16x16x32_bf16 v[60:63], v[148:151], a[204:207], v[60:63]
  v_mfma_f32_16x16x32_bf16 v[64:67], v[152:155], a[192:195], v[64:67]
  buffer_load_dwordx4 v[236:239], v3, s[12:15], s27 offen offset:2048 sc1
  v_mfma_f32_16x16x32_bf16 v[68:71], v[152:155], a[196:199], v[68:71]
  v_mfma_f32_16x16x32_bf16 v[72:75], v[152:155], a[200:203], v[72:75]
  v_mfma_f32_16x16x32_bf16 v[76:79], v[152:155], a[204:207], v[76:79]
  v_mfma_f32_16x16x32_bf16 v[80:83], v[156:159], a[192:195], v[80:83]
  buffer_load_dwordx4 v[240:243], v3, s[12:15], s27 offen offset:3072 sc1
  v_mfma_f32_16x16x32_bf16 v[84:87], v[156:159], a[196:199], v[84:87]
  v_mfma_f32_16x16x32_bf16 v[88:91], v[156:159], a[200:203], v[88:91]
  v_mfma_f32_16x16x32_bf16 v[92:95], v[156:159], a[204:207], v[92:95]
  v_mfma_f32_16x16x32_bf16 v[96:99], v[160:163], a[192:195], v[96:99]
  buffer_load_dwordx4 v[244:247], v4, s[12:15], s27 offen offset:0 sc1
  v_mfma_f32_16x16x32_bf16 v[100:103], v[160:163], a[196:199], v[100:103]
  v_mfma_f32_16x16x32_bf16 v[104:107], v[160:163], a[200:203], v[104:107]
  v_mfma_f32_16x16x32_bf16 v[108:111], v[160:163], a[204:207], v[108:111]
  v_mfma_f32_16x16x32_bf16 v[112:115], v[164:167], a[192:195], v[112:115]
  buffer_load_dwordx4 v[248:251], v4, s[12:15], s27 offen offset:1024 sc1
  v_mfma_f32_16x16x32_bf16 v[116:119], v[164:167], a[196:199], v[116:119]
  v_mfma_f32_16x16x32_bf16 v[120:123], v[164:167], a[200:203], v[120:123]
  v_mfma_f32_16x16x32_bf16 v[124:127], v[164:167], a[204:207], v[124:127]
  v_mfma_f32_16x16x32_bf16 v[128:131], v[168:171], a[192:195], v[128:131]
  buffer_load_dwordx4 v[252:255], v4, s[12:15], s27 offen offset:2048 sc1
  v_mfma_f32_16x16x32_bf16 v[132:135], v[168:171], a[196:199], v[132:135]
  v_mfma_f32_16x16x32_bf16 v[136:139], v[168:171], a[200:203], v[136:139]
  v_mfma_f32_16x16x32_bf16 v[140:143], v[168:171], a[204:207], v[140:143]
  s_waitcnt vmcnt(14)
  s_mul_i32 s23, s3, 21504
  v_add_u32 v9, s23, v3
  v_mfma_f32_16x16x32_bf16 v[32:35], v[172:175], a[208:211], v[32:35]
  v_mfma_f32_16x16x32_bf16 v[36:39], v[172:175], a[212:215], v[36:39]
  v_mfma_f32_16x16x32_bf16 v[40:43], v[172:175], a[216:219], v[40:43]
  buffer_load_dwordx2 v[16:17], v10, s[64:67], 0 offen offset:0 sc1
  v_mfma_f32_16x16x32_bf16 v[44:47], v[172:175], a[220:223], v[44:47]
  v_mfma_f32_16x16x32_bf16 v[48:51], v[176:179], a[208:211], v[48:51]
  v_mfma_f32_16x16x32_bf16 v[52:55], v[176:179], a[212:215], v[52:55]
  v_mfma_f32_16x16x32_bf16 v[56:59], v[176:179], a[216:219], v[56:59]
  buffer_load_dwordx2 v[18:19], v10, s[64:67], 0 offen offset:512 sc1
  v_mfma_f32_16x16x32_bf16 v[60:63], v[176:179], a[220:223], v[60:63]
  v_mfma_f32_16x16x32_bf16 v[64:67], v[180:183], a[208:211], v[64:67]
  v_mfma_f32_16x16x32_bf16 v[68:71], v[180:183], a[212:215], v[68:71]
  v_mfma_f32_16x16x32_bf16 v[72:75], v[180:183], a[216:219], v[72:75]
  buffer_load_dwordx2 v[20:21], v10, s[64:67], 0 offen offset:1024 sc1
  v_mfma_f32_16x16x32_bf16 v[76:79], v[180:183], a[220:223], v[76:79]
  v_mfma_f32_16x16x32_bf16 v[80:83], v[184:187], a[208:211], v[80:83]
  v_mfma_f32_16x16x32_bf16 v[84:87], v[184:187], a[212:215], v[84:87]
  v_mfma_f32_16x16x32_bf16 v[88:91], v[184:187], a[216:219], v[88:91]
  buffer_load_dwordx2 v[22:23], v10, s[64:67], 0 offen offset:1536 sc1
  v_mfma_f32_16x16x32_bf16 v[92:95], v[184:187], a[220:223], v[92:95]
  v_mfma_f32_16x16x32_bf16 v[96:99], v[188:191], a[208:211], v[96:99]
  v_mfma_f32_16x16x32_bf16 v[100:103], v[188:191], a[212:215], v[100:103]
  v_mfma_f32_16x16x32_bf16 v[104:107], v[188:191], a[216:219], v[104:107]
  buffer_load_dwordx2 v[24:25], v10, s[64:67], 0 offen offset:2048 sc1
  v_mfma_f32_16x16x32_bf16 v[108:111], v[188:191], a[220:223], v[108:111]
  v_mfma_f32_16x16x32_bf16 v[112:115], v[192:195], a[208:211], v[112:115]
  v_mfma_f32_16x16x32_bf16 v[116:119], v[192:195], a[212:215], v[116:119]
  v_mfma_f32_16x16x32_bf16 v[120:123], v[192:195], a[216:219], v[120:123]
  buffer_load_dwordx2 v[26:27], v10, s[64:67], 0 offen offset:2560 sc1
  v_mfma_f32_16x16x32_bf16 v[124:127], v[192:195], a[220:223], v[124:127]
  v_mfma_f32_16x16x32_bf16 v[128:131], v[196:199], a[208:211], v[128:131]
  v_mfma_f32_16x16x32_bf16 v[132:135], v[196:199], a[212:215], v[132:135]
  v_mfma_f32_16x16x32_bf16 v[136:139], v[196:199], a[216:219], v[136:139]
  buffer_load_dwordx2 v[28:29], v10, s[64:67], 0 offen offset:3072 sc1
  v_mfma_f32_16x16x32_bf16 v[140:143], v[196:199], a[220:223], v[140:143]
  s_waitcnt vmcnt(14)
  v_mfma_f32_16x16x32_bf16 v[32:35], v[200:203], a[224:227], v[32:35]
  v_mfma_f32_16x16x32_bf16 v[36:39], v[200:203], a[228:231], v[36:39]
  v_mfma_f32_16x16x32_bf16 v[40:43], v[200:203], a[232:235], v[40:43]
  global_load_ushort v30, v11, s[48:49]
  v_mfma_f32_16x16x32_bf16 v[44:47], v[200:203], a[236:239], v[44:47]
  v_mfma_f32_16x16x32_bf16 v[48:51], v[204:207], a[224:227], v[48:51]
  v_mfma_f32_16x16x32_bf16 v[52:55], v[204:207], a[228:231], v[52:55]
  v_mfma_f32_16x16x32_bf16 v[56:59], v[204:207], a[232:235], v[56:59]
  global_load_dword v31, v15, s[58:59] sc1
  v_mfma_f32_16x16x32_bf16 v[60:63], v[204:207], a[236:239], v[60:63]
  v_mfma_f32_16x16x32_bf16 v[64:67], v[208:211], a[224:227], v[64:67]
  v_mfma_f32_16x16x32_bf16 v[68:71], v[208:211], a[228:231], v[68:71]
  v_mfma_f32_16x16x32_bf16 v[72:75], v[208:211], a[232:235], v[72:75]
  s_add_u32 s30, s28, 0
  buffer_load_dwordx4 a[0:3], v3, s[8:11], s30 offen offset:0 sc1
  v_mfma_f32_16x16x32_bf16 v[76:79], v[208:211], a[236:239], v[76:79]
  v_mfma_f32_16x16x32_bf16 v[80:83], v[212:215], a[224:227], v[80:83]
  v_mfma_f32_16x16x32_bf16 v[84:87], v[212:215], a[228:231], v[84:87]
  v_mfma_f32_16x16x32_bf16 v[88:91], v[212:215], a[232:235], v[88:91]
  buffer_load_dwordx4 a[4:7], v3, s[8:11], s30 offen offset:1024 sc1
  v_mfma_f32_16x16x32_bf16 v[92:95], v[212:215], a[236:239], v[92:95]
  v_mfma_f32_16x16x32_bf16 v[96:99], v[216:219], a[224:227], v[96:99]
  v_mfma_f32_16x16x32_bf16 v[100:103], v[216:219], a[228:231], v[100:103]
  v_mfma_f32_16x16x32_bf16 v[104:107], v[216:219], a[232:235], v[104:107]
  buffer_load_dwordx4 a[8:11], v3, s[8:11], s30 offen offset:2048 sc1
  v_mfma_f32_16x16x32_bf16 v[108:111], v[216:219], a[236:239], v[108:111]
  v_mfma_f32_16x16x32_bf16 v[112:115], v[220:223], a[224:227], v[112:115]
  v_mfma_f32_16x16x32_bf16 v[116:119], v[220:223], a[228:231], v[116:119]
  v_mfma_f32_16x16x32_bf16 v[120:123], v[220:223], a[232:235], v[120:123]
  buffer_load_dwordx4 a[12:15], v3, s[8:11], s30 offen offset:3072 sc1
  v_mfma_f32_16x16x32_bf16 v[124:127], v[220:223], a[236:239], v[124:127]
  v_mfma_f32_16x16x32_bf16 v[128:131], v[224:227], a[224:227], v[128:131]
  v_mfma_f32_16x16x32_bf16 v[132:135], v[224:227], a[228:231], v[132:135]
  v_mfma_f32_16x16x32_bf16 v[136:139], v[224:227], a[232:235], v[136:139]
  s_add_u32 s30, s28, 4096
  buffer_load_dwordx4 a[16:19], v3, s[8:11], s30 offen offset:0 sc1
  v_mfma_f32_16x16x32_bf16 v[140:143], v[224:227], a[236:239], v[140:143]
  s_waitcnt vmcnt(14)
  v_mfma_f32_16x16x32_bf16 v[32:35], v[228:231], a[240:243], v[32:35]
  v_mfma_f32_16x16x32_bf16 v[36:39], v[228:231], a[244:247], v[36:39]
  v_mfma_f32_16x16x32_bf16 v[40:43], v[228:231], a[248:251], v[40:43]
  buffer_load_dwordx4 a[20:23], v3, s[8:11], s30 offen offset:1024 sc1
  v_mfma_f32_16x16x32_bf16 v[44:47], v[228:231], a[252:255], v[44:47]
  v_mfma_f32_16x16x32_bf16 v[48:51], v[232:235], a[240:243], v[48:51]
  v_mfma_f32_16x16x32_bf16 v[52:55], v[232:235], a[244:247], v[52:55]
  v_mfma_f32_16x16x32_bf16 v[56:59], v[232:235], a[248:251], v[56:59]
  buffer_load_dwordx4 a[24:27], v3, s[8:11], s30 offen offset:2048 sc1
  v_mfma_f32_16x16x32_bf16 v[60:63], v[232:235], a[252:255], v[60:63]
  v_mfma_f32_16x16x32_bf16 v[64:67], v[236:239], a[240:243], v[64:67]
  v_mfma_f32_16x16x32_bf16 v[68:71], v[236:239], a[244:247], v[68:71]
  v_mfma_f32_16x16x32_bf16 v[72:75], v[236:239], a[248:251], v[72:75]
  buffer_load_dwordx4 a[28:31], v3, s[8:11], s30 offen offset:3072 sc1
  v_mfma_f32_16x16x32_bf16 v[76:79], v[236:239], a[252:255], v[76:79]
  v_mfma_f32_16x16x32_bf16 v[80:83], v[240:243], a[240:243], v[80:83]
  v_mfma_f32_16x16x32_bf16 v[84:87], v[240:243], a[244:247], v[84:87]
  v_mfma_f32_16x16x32_bf16 v[88:91], v[240:243], a[248:251], v[88:91]
  s_add_u32 s30, s28, 8192
  buffer_load_dwordx4 a[32:35], v3, s[8:11], s30 offen offset:0 sc1
  v_mfma_f32_16x16x32_bf16 v[92:95], v[240:243], a[252:255], v[92:95]
  v_mfma_f32_16x16x32_bf16 v[96:99], v[244:247], a[240:243], v[96:99]
  v_mfma_f32_16x16x32_bf16 v[100:103], v[244:247], a[244:247], v[100:103]
  v_mfma_f32_16x16x32_bf16 v[104:107], v[244:247], a[248:251], v[104:107]
  buffer_load_dwordx4 a[36:39], v3, s[8:11], s30 offen offset:1024 sc1
  v_mfma_f32_16x16x32_bf16 v[108:111], v[244:247], a[252:255], v[108:111]
  v_mfma_f32_16x16x32_bf16 v[112:115], v[248:251], a[240:243], v[112:115]
  v_mfma_f32_16x16x32_bf16 v[116:119], v[248:251], a[244:247], v[116:119]
  v_mfma_f32_16x16x32_bf16 v[120:123], v[248:251], a[248:251], v[120:123]
  buffer_load_dwordx4 a[40:43], v3, s[8:11], s30 offen offset:2048 sc1
  v_mfma_f32_16x16x32_bf16 v[124:127], v[248:251], a[252:255], v[124:127]
  v_mfma_f32_16x16x32_bf16 v[128:131], v[252:255], a[240:243], v[128:131]
  v_mfma_f32_16x16x32_bf16 v[132:135], v[252:255], a[244:247], v[132:135]
  v_mfma_f32_16x16x32_bf16 v[136:139], v[252:255], a[248:251], v[136:139]
  buffer_load_dwordx4 a[44:47], v3, s[8:11], s30 offen offset:3072 sc1
  v_mfma_f32_16x16x32_bf16 v[140:143], v[252:255], a[252:255], v[140:143]
  s_branch mega_p2
mega_qrole:
  v_lshrrev_b32 v15, 3, v12
  v_and_b32 v16, 7, v12
  v_and_b32 v17, 3, v15
  v_xor_b32 v17, v16, v17
  v_lshlrev_b32 v17, 4, v17
  s_lshl_b32 s24, s20, 7
  s_sub_u32 s24, s24, 16
  s_mul_i32 s25, s3, 5
  s_add_u32 s26, s25, 0
  s_lshl_b32 s27, s26, 3
  s_add_u32 s27, s27, s24
  v_add_u32 v18, s27, v15
  v_max_i32 v18, 0, v18
  v_mul_u32_u24 v18, 896, v18
  s_and_b32 s27, s26, 1
  s_lshl_b32 s27, s27, 6
  v_xor_b32 v19, s27, v17
  s_cmp_ge_u32 s26, 18
  s_cselect_b32 s27, 2147418112, 0
  v_add3_u32 v1, v18, v19, s27
  s_add_u32 s26, s25, 1
  s_lshl_b32 s27, s26, 3
  s_add_u32 s27, s27, s24
  v_add_u32 v18, s27, v15
  v_max_i32 v18, 0, v18
  v_mul_u32_u24 v18, 896, v18
  s_and_b32 s27, s26, 1
  s_lshl_b32 s27, s27, 6
  v_xor_b32 v19, s27, v17
  s_cmp_ge_u32 s26, 18
  s_cselect_b32 s27, 2147418112, 0
  v_add3_u32 v2, v18, v19, s27
  v_subrev_u32 v2, 1024, v2
  s_add_u32 s26, s25, 2
  s_lshl_b32 s27, s26, 3
  s_add_u32 s27, s27, s24
  v_add_u32 v18, s27, v15
  v_max_i32 v18, 0, v18
  v_mul_u32_u24 v18, 896, v18
  s_and_b32 s27, s26, 1
  s_lshl_b32 s27, s27, 6
  v_xor_b32 v19, s27, v17
  s_cmp_ge_u32 s26, 18
  s_cselect_b32 s27, 2147418112, 0
  v_add3_u32 v3, v18, v19, s27
  v_subrev_u32 v3, 2048, v3
  s_add_u32 s26, s25, 3
  s_lshl_b32 s27, s26, 3
  s_add_u32 s27, s27, s24
  v_add_u32 v18, s27, v15
  v_max_i32 v18, 0, v18
  v_mul_u32_u24 v18, 896, v18
  s_and_b32 s27, s26, 1
  s_lshl_b32 s27, s27, 6
  v_xor_b32 v19, s27, v17
  s_cmp_ge_u32 s26, 18
  s_cselect_b32 s27, 2147418112, 0
  v_add3_u32 v4, v18, v19, s27
  v_subrev_u32 v4, 3072, v4
  s_add_u32 s26, s25, 4
  s_lshl_b32 s27, s26, 3
  s_add_u32 s27, s27, s24
  v_add_u32 v18, s27, v15
  v_max_i32 v18, 0, v18
  v_mul_u32_u24 v18, 896, v18
  s_and_b32 s27, s26, 1
  s_lshl_b32 s27, s27, 6
  v_xor_b32 v19, s27, v17
  s_cmp_ge_u32 s26, 18
  s_cselect_b32 s27, 2147418112, 0
  v_add3_u32 v5, v18, v19, s27
  v_and_b32 v18, 2, v15
  v_xor_b32 v18, v16, v18
  v_mul_u32_u24 v19, 2688, v15
  v_lshl_add_u32 v6, v18, 4, v19
  v_cmp_eq_u32 vcc, 7, v18
  v_mov_b32 v16, 2147418112
  s_nop 0
  v_cndmask_b32 v6, v6, v16, vcc
  v_xor_b32 v18, 4, v18
  v_lshl_add_u32 v7, v18, 4, v19
  v_add_u32 v7, 20480, v7
  v_cmp_eq_u32 vcc, 7, v18
  v_mov_b32 v16, 2147418112
  s_nop 0
  v_cndmask_b32 v7, v7, v16, vcc
  s_waitcnt lgkmcnt(0)
  s_sub_u32 s8, s36, 4096
  s_subb_u32 s9, s37, 0
  s_and_b32 s9, s9, 0xffff
  s_mov_b32 s10, 1839104
  s_mov_b32 s11, 0x20000
  v_add_u32 v1, 4096, v1
  v_add_u32 v2, 4096, v2
  v_add_u32 v3, 4096, v3
  v_add_u32 v4, 4096, v4
  v_add_u32 v5, 4096, v5
  s_mov_b32 s12, s38
  s_and_b32 s13, s39, 0xffff
  s_mov_b32 s14, 1204224
  s_mov_b32 s15, 0x20000
  s_mul_i32 s24, s3, 43008
  s_mul_i32 s25, s21, 112
  s_add_u32 s24, s24, s25
  s_mul_i32 s25, s3, 5120
  s_lshl_b32 s26, s3, 11
  s_add_u32 s26, s26, 20480
  s_mov_b32 s23, 896
  s_mov_b32 s16, s52
  s_and_b32 s17, s53, 0xffff
  s_mov_b32 s18, 896
  s_mov_b32 s19, 0x20000
  v_lshlrev_b32 v16, 4, v12
  v_mov_b32 v18, 2147418112
  s_mov_b32 m0, 135168
  s_nop 0
  buffer_load_dwordx4 v16, s[16:19], 0 offen lds
  s_mov_b32 m0, 136192
  s_nop 0
  buffer_load_dwordx4 v18, s[16:19], 0 offen lds
  s_add_u32 m0, s26, 0
  s_add_u32 s23, s24, 0
  buffer_load_dwordx4 v6, s[12:15], s23 offen offset:0 lds
  buffer_load_dwordx4 v7, s[12:15], s23 offen offset:1024 lds
  s_add_u32 m0, s26, 8192
  s_add_u32 s23, s24, 896
  buffer_load_dwordx4 v6, s[12:15], s23 offen offset:0 lds
  buffer_load_dwordx4 v7, s[12:15], s23 offen offset:1024 lds
  s_add_u32 m0, s26, 16384
  s_add_u32 s23, s24, 1792
  buffer_load_dwordx4 v6, s[12:15], s23 offen offset:0 lds
  buffer_load_dwordx4 v7, s[12:15], s23 offen offset:1024 lds
  s_add_u32 m0, s25, 0
  s_mov_b32 s23, 0
  buffer_load_dwordx4 v1, s[8:11], s23 offen offset:0 lds
  buffer_load_dwordx4 v2, s[8:11], s23 offen offset:1024 lds
  buffer_load_dwordx4 v3, s[8:11], s23 offen offset:2048 lds
  buffer_load_dwordx4 v4, s[8:11], s23 offen offset:3072 lds
  s_add_u32 m0, s25, 4096
  s_nop 0
  buffer_load_dwordx4 v5, s[8:11], s23 offen lds
  s_add_u32 m0, s26, 45056
  s_add_u32 s23, s24, 172032
  buffer_load_dwordx4 v6, s[12:15], s23 offen offset:0 lds
  buffer_load_dwordx4 v7, s[12:15], s23 offen offset:1024 lds
  s_add_u32 m0, s26, 53248
  s_add_u32 s23, s24, 172928
  buffer_load_dwordx4 v6, s[12:15], s23 offen offset:0 lds
  buffer_load_dwordx4 v7, s[12:15], s23 offen offset:1024 lds
  s_add_u32 m0, s26, 61440
  s_add_u32 s23, s24, 173824
  buffer_load_dwordx4 v6, s[12:15], s23 offen offset:0 lds
  buffer_load_dwordx4 v7, s[12:15], s23 offen offset:1024 lds
  s_add_u32 m0, s25, 45056
  s_mov_b32 s23, 128
  buffer_load_dwordx4 v1, s[8:11], s23 offen offset:0 lds
  buffer_load_dwordx4 v2, s[8:11], s23 offen offset:1024 lds
  buffer_load_dwordx4 v3, s[8:11], s23 offen offset:2048 lds
  buffer_load_dwordx4 v4, s[8:11], s23 offen offset:3072 lds
  s_add_u32 m0, s25, 49152
  s_nop 0
  buffer_load_dwordx4 v5, s[8:11], s23 offen lds
  v_lshrrev_b32 v15, 3, v13
  v_lshlrev_b32 v15, 2, v15
  v_and_b32 v16, 3, v13
  v_or_b32 v15, v15, v16
  v_xor_b32 v15, v15, v14
  v_lshlrev_b32 v15, 4, v15
  v_lshl_add_u32 v20, v13, 7, v15
  v_xor_b32 v21, 64, v20
  s_lshl_b32 s23, s3, 12
  s_add_u32 s23, s23, 2048
  v_add_u32 v22, s23, v20
  v_add_u32 v23, s23, v21
  s_lshr_b32 s23, s3, 1
  s_mul_i32 s23, s23, 56
  s_and_b32 s33, s3, 1
  s_lshl_b32 s34, s33, 5
  s_add_u32 s23, s23, s34
  v_and_b32 v15, 3, v13
  v_lshlrev_b32 v16, 3, v15
  v_add_u32 v16, s23, v16
  v_cmp_eq_u32 vcc, 3, v15
  s_cmp_eq_u32 s33, 1
  s_cselect_b64 s[34:35], vcc, 0
  v_mov_b32 v17, 112
  v_cndmask_b32 v16, v16, v17, s[34:35]
  v_lshrrev_b32 v17, 3, v13
  v_lshlrev_b32 v17, 1, v17
  v_and_b32 v18, 1, v14
  v_lshl_or_b32 v17, v18, 2, v17
  v_lshrrev_b32 v18, 4, v16
  v_xor_b32 v18, v18, v17
  v_and_b32 v16, 8, v16
  v_lshl_or_b32 v16, v18, 4, v16
  v_lshrrev_b32 v17, 2, v13
  v_lshl_add_u32 v17, v14, 3, v17
  v_lshl_add_u32 v24, v17, 7, v16
  v_add_u32 v24, 20480, v24
  v_cmp_eq_u32 vcc, 0, v13
  v_mov_b32 v16, 136192
  v_mov_b32 v17, 135168
  v_cndmask_b32 v25, v16, v17, vcc
  v_lshl_add_u32 v25, v14, 4, v25
  s_waitcnt vmcnt(11)
  s_barrier
  ds_read_b64_tr_b16 a[88:89], v24 offset:0
  ds_read_b64_tr_b16 a[90:91], v24 offset:512
  ds_read_b64_tr_b16 a[92:93], v24 offset:8192
  ds_read_b64_tr_b16 a[94:95], v24 offset:8704
  ds_read_b64_tr_b16 a[96:97], v24 offset:16384
  ds_read_b64_tr_b16 a[98:99], v24 offset:16896
  ds_read_b128 a[100:103], v25 offset:0
  ds_read_b128 a[0:3], v20 offset:0
  ds_read_b128 a[4:7], v20 offset:2048
  ds_read_b128 a[8:11], v20 offset:4096
  ds_read_b128 a[12:15], v20 offset:6144
  ds_read_b128 a[16:19], v20 offset:8192
  ds_read_b128 a[20:23], v20 offset:10240
  ds_read_b128 a[24:27], v20 offset:12288
  ds_read_b128 a[28:31], v20 offset:14336
  ds_read_b128 a[32:35], v20 offset:16384
  ds_read_b128 a[36:39], v22 offset:0
  ds_read_b128 a[40:43], v22 offset:2048
  s_waitcnt lgkmcnt(0)
  v_mfma_f32_16x16x32_bf16 v[96:99], a[92:95], a[0:3], 0
  ds_read_b64_tr_b16 a[104:105], v24 offset:4096
  s_add_u32 m0, s26, 90112
  v_mfma_f32_16x16x32_bf16 v[132:135], a[96:99], a[0:3], 0
  ds_read_b64_tr_b16 a[106:107], v24 offset:4608
  s_add_u32 s23, s24, 344064
  v_mfma_f32_16x16x32_bf16 v[64:67], a[88:91], a[4:7], 0
  ds_read_b64_tr_b16 a[108:109], v24 offset:12288
  buffer_load_dwordx4 v6, s[12:15], s23 offen offset:0 lds
  v_mfma_f32_16x16x32_bf16 v[100:103], a[92:95], a[4:7], 0
  ds_read_b64_tr_b16 a[110:111], v24 offset:12800
  buffer_load_dwordx4 v7, s[12:15], s23 offen offset:1024 lds
  v_mfma_f32_16x16x32_bf16 v[136:139], a[96:99], a[4:7], 0
  ds_read_b64_tr_b16 a[112:113], v24 offset:20480
  s_add_u32 m0, s26, 98304
  v_mfma_f32_16x16x32_bf16 v[68:71], a[88:91], a[8:11], 0
  ds_read_b64_tr_b16 a[114:115], v24 offset:20992
  s_add_u32 s23, s24, 344960
  v_mfma_f32_16x16x32_bf16 v[104:107], a[92:95], a[8:11], 0
  ds_read_b128 a[116:119], v25 offset:64
  buffer_load_dwordx4 v6, s[12:15], s23 offen offset:0 lds
  v_mfma_f32_16x16x32_bf16 v[140:143], a[96:99], a[8:11], 0
  ds_read_b128 a[44:47], v21 offset:0
  buffer_load_dwordx4 v7, s[12:15], s23 offen offset:1024 lds
  v_mfma_f32_16x16x32_bf16 v[72:75], a[88:91], a[12:15], 0
  ds_read_b128 a[48:51], v21 offset:2048
  s_add_u32 m0, s26, 106496
  v_mfma_f32_16x16x32_bf16 v[108:111], a[92:95], a[12:15], 0
  ds_read_b128 a[52:55], v21 offset:4096
  s_add_u32 s23, s24, 345856
  v_mfma_f32_16x16x32_bf16 v[144:147], a[96:99], a[12:15], 0
  ds_read_b128 a[56:59], v21 offset:6144
  buffer_load_dwordx4 v6, s[12:15], s23 offen offset:0 lds
  v_mfma_f32_16x16x32_bf16 v[76:79], a[88:91], a[16:19], 0
  ds_read_b128 a[60:63], v21 offset:8192
  buffer_load_dwordx4 v7, s[12:15], s23 offen offset:1024 lds
  v_mfma_f32_16x16x32_bf16 v[112:115], a[92:95], a[16:19], 0
  ds_read_b128 a[64:67], v21 offset:10240
  s_add_u32 m0, s25, 90112
  v_mfma_f32_16x16x32_bf16 v[148:151], a[96:99], a[16:19], 0
  ds_read_b128 a[68:71], v21 offset:12288
  s_mov_b32 s23, 256
  v_mfma_f32_16x16x32_bf16 v[80:83], a[88:91], a[20:23], 0
  ds_read_b128 a[72:75], v21 offset:14336
  buffer_load_dwordx4 v1, s[8:11], s23 offen offset:0 lds
  v_mfma_f32_16x16x32_bf16 v[116:119], a[92:95], a[20:23], 0
  ds_read_b128 a[76:79], v21 offset:16384
  buffer_load_dwordx4 v2, s[8:11], s23 offen offset:1024 lds
  v_mfma_f32_16x16x32_bf16 v[152:155], a[96:99], a[20:23], 0
  ds_read_b128 a[80:83], v23 offset:0
  buffer_load_dwordx4 v3, s[8:11], s23 offen offset:2048 lds
  v_mfma_f32_16x16x32_bf16 v[84:87], a[88:91], a[24:27], 0
  ds_read_b128 a[84:87], v23 offset:2048
  buffer_load_dwordx4 v4, s[8:11], s23 offen offset:3072 lds
  v_mfma_f32_16x16x32_bf16 v[120:123], a[92:95], a[24:27], 0
  s_add_u32 m0, s25, 94208
  v_mfma_f32_16x16x32_bf16 v[156:159], a[96:99], a[24:27], 0
  buffer_load_dwordx4 v5, s[8:11], s23 offen lds
  v_mfma_f32_16x16x32_bf16 v[88:91], a[88:91], a[28:31], 0
  v_mfma_f32_16x16x32_bf16 v[124:127], a[92:95], a[28:31], 0
  v_mfma_f32_16x16x32_bf16 v[160:163], a[96:99], a[28:31], 0
  v_mfma_f32_16x16x32_bf16 v[92:95], a[88:91], a[32:35], 0
  v_mfma_f32_16x16x32_bf16 v[128:131], a[92:95], a[32:35], 0
  v_mfma_f32_16x16x32_bf16 v[164:167], a[96:99], a[32:35], 0
  v_mfma_f32_16x16x32_bf16 v[168:171], a[100:103], a[36:39], 0
  v_mfma_f32_16x16x32_bf16 v[172:175], a[100:103], a[40:43], 0
  s_waitcnt vmcnt(11)
  s_waitcnt lgkmcnt(0)
  s_barrier
  v_add_u32 v20, 45056, v20
  v_add_u32 v21, 45056, v21
  v_add_u32 v22, 45056, v22
  v_add_u32 v23, 45056, v23
  v_add_u32 v24, 45056, v24
  v_mfma_f32_16x16x32_bf16 v[96:99], a[108:111], a[44:47], v[96:99]
  ds_read_b64_tr_b16 a[88:89], v24 offset:0
  s_add_u32 m0, s26, 0
  v_mfma_f32_16x16x32_bf16 v[132:135], a[112:115], a[44:47], v[132:135]
  ds_read_b64_tr_b16 a[90:91], v24 offset:512
  s_add_u32 s23, s24, 516096
  v_mfma_f32_16x16x32_bf16 v[64:67], a[104:107], a[48:51], v[64:67]
  ds_read_b64_tr_b16 a[92:93], v24 offset:8192
  buffer_load_dwordx4 v6, s[12:15], s23 offen offset:0 lds
  v_mfma_f32_16x16x32_bf16 v[100:103], a[108:111], a[48:51], v[100:103]
  ds_read_b64_tr_b16 a[94:95], v24 offset:8704
  buffer_load_dwordx4 v7, s[12:15], s23 offen offset:1024 lds
  v_mfma_f32_16x16x32_bf16 v[136:139], a[112:115], a[48:51], v[136:139]
  ds_read_b64_tr_b16 a[96:97], v24 offset:16384
  s_add_u32 m0, s26, 8192
  v_mfma_f32_16x16x32_bf16 v[68:71], a[104:107], a[52:55], v[68:71]
  ds_read_b64_tr_b16 a[98:99], v24 offset:16896
  s_add_u32 s23, s24, 516992
  v_mfma_f32_16x16x32_bf16 v[104:107], a[108:111], a[52:55], v[104:107]
  ds_read_b128 a[100:103], v25 offset:128
  buffer_load_dwordx4 v6, s[12:15], s23 offen offset:0 lds
  v_mfma_f32_16x16x32_bf16 v[140:143], a[112:115], a[52:55], v[140:143]
  ds_read_b128 a[0:3], v20 offset:0
  buffer_load_dwordx4 v7, s[12:15], s23 offen offset:1024 lds
  v_mfma_f32_16x16x32_bf16 v[72:75], a[104:107], a[56:59], v[72:75]
  ds_read_b128 a[4:7], v20 offset:2048
  s_add_u32 m0, s26, 16384
  v_mfma_f32_16x16x32_bf16 v[108:111], a[108:111], a[56:59], v[108:111]
  ds_read_b128 a[8:11], v20 offset:4096
  s_add_u32 s23, s24, 517888
  v_mfma_f32_16x16x32_bf16 v[144:147], a[112:115], a[56:59], v[144:147]
  ds_read_b128 a[12:15], v20 offset:6144
  buffer_load_dwordx4 v6, s[12:15], s23 offen offset:0 lds
  v_mfma_f32_16x16x32_bf16 v[76:79], a[104:107], a[60:63], v[76:79]
  ds_read_b128 a[16:19], v20 offset:8192
  buffer_load_dwordx4 v7, s[12:15], s23 offen offset:1024 lds
  v_mfma_f32_16x16x32_bf16 v[112:115], a[108:111], a[60:63], v[112:115]
  ds_read_b128 a[20:23], v20 offset:10240
  s_add_u32 m0, s25, 0
  v_mfma_f32_16x16x32_bf16 v[148:151], a[112:115], a[60:63], v[148:151]
  ds_read_b128 a[24:27], v20 offset:12288
  s_mov_b32 s23, 384
  v_mfma_f32_16x16x32_bf16 v[80:83], a[104:107], a[64:67], v[80:83]
  ds_read_b128 a[28:31], v20 offset:14336
  buffer_load_dwordx4 v1, s[8:11], s23 offen offset:0 lds
  v_mfma_f32_16x16x32_bf16 v[116:119], a[108:111], a[64:67], v[116:119]
  ds_read_b128 a[32:35], v20 offset:16384
  buffer_load_dwordx4 v2, s[8:11], s23 offen offset:1024 lds
  v_mfma_f32_16x16x32_bf16 v[152:155], a[112:115], a[64:67], v[152:155]
  ds_read_b128 a[36:39], v22 offset:0
  buffer_load_dwordx4 v3, s[8:11], s23 offen offset:2048 lds
  v_mfma_f32_16x16x32_bf16 v[84:87], a[104:107], a[68:71], v[84:87]
  ds_read_b128 a[40:43], v22 offset:2048
  buffer_load_dwordx4 v4, s[8:11], s23 offen offset:3072 lds
  v_mfma_f32_16x16x32_bf16 v[120:123], a[108:111], a[68:71], v[120:123]
  s_add_u32 m0, s25, 4096
  v_mfma_f32_16x16x32_bf16 v[156:159], a[112:115], a[68:71], v[156:159]
  buffer_load_dwordx4 v5, s[8:11], s23 offen lds
  v_mfma_f32_16x16x32_bf16 v[88:91], a[104:107], a[72:75], v[88:91]
  v_mfma_f32_16x16x32_bf16 v[124:127], a[108:111], a[72:75], v[124:127]
  v_mfma_f32_16x16x32_bf16 v[160:163], a[112:115], a[72:75], v[160:163]
  v_mfma_f32_16x16x32_bf16 v[92:95], a[104:107], a[76:79], v[92:95]
  v_mfma_f32_16x16x32_bf16 v[128:131], a[108:111], a[76:79], v[128:131]
  v_mfma_f32_16x16x32_bf16 v[164:167], a[112:115], a[76:79], v[164:167]
  v_mfma_f32_16x16x32_bf16 v[168:171], a[116:119], a[80:83], v[168:171]
  v_mfma_f32_16x16x32_bf16 v[172:175], a[116:119], a[84:87], v[172:175]
  s_waitcnt lgkmcnt(0)
  v_mfma_f32_16x16x32_bf16 v[96:99], a[92:95], a[0:3], v[96:99]
  ds_read_b64_tr_b16 a[104:105], v24 offset:4096
  v_mfma_f32_16x16x32_bf16 v[132:135], a[96:99], a[0:3], v[132:135]
  ds_read_b64_tr_b16 a[106:107], v24 offset:4608
  v_mfma_f32_16x16x32_bf16 v[64:67], a[88:91], a[4:7], v[64:67]
  ds_read_b64_tr_b16 a[108:109], v24 offset:12288
  v_mfma_f32_16x16x32_bf16 v[100:103], a[92:95], a[4:7], v[100:103]
  ds_read_b64_tr_b16 a[110:111], v24 offset:12800
  v_mfma_f32_16x16x32_bf16 v[136:139], a[96:99], a[4:7], v[136:139]
  ds_read_b64_tr_b16 a[112:113], v24 offset:20480
  v_mfma_f32_16x16x32_bf16 v[68:71], a[88:91], a[8:11], v[68:71]
  ds_read_b64_tr_b16 a[114:115], v24 offset:20992
  v_mfma_f32_16x16x32_bf16 v[104:107], a[92:95], a[8:11], v[104:107]
  ds_read_b128 a[116:119], v25 offset:192
  v_mfma_f32_16x16x32_bf16 v[140:143], a[96:99], a[8:11], v[140:143]
  ds_read_b128 a[44:47], v21 offset:0
  v_mfma_f32_16x16x32_bf16 v[72:75], a[88:91], a[12:15], v[72:75]
  ds_read_b128 a[48:51], v21 offset:2048
  v_mfma_f32_16x16x32_bf16 v[108:111], a[92:95], a[12:15], v[108:111]
  ds_read_b128 a[52:55], v21 offset:4096
  v_mfma_f32_16x16x32_bf16 v[144:147], a[96:99], a[12:15], v[144:147]
  ds_read_b128 a[56:59], v21 offset:6144
  v_mfma_f32_16x16x32_bf16 v[76:79], a[88:91], a[16:19], v[76:79]
  ds_read_b128 a[60:63], v21 offset:8192
  v_mfma_f32_16x16x32_bf16 v[112:115], a[92:95], a[16:19], v[112:115]
  ds_read_b128 a[64:67], v21 offset:10240
  v_mfma_f32_16x16x32_bf16 v[148:151], a[96:99], a[16:19], v[148:151]
  ds_read_b128 a[68:71], v21 offset:12288
  v_mfma_f32_16x16x32_bf16 v[80:83], a[88:91], a[20:23], v[80:83]
  ds_read_b128 a[72:75], v21 offset:14336
  v_mfma_f32_16x16x32_bf16 v[116:119], a[92:95], a[20:23], v[116:119]
  ds_read_b128 a[76:79], v21 offset:16384
  v_mfma_f32_16x16x32_bf16 v[152:155], a[96:99], a[20:23], v[152:155]
  ds_read_b128 a[80:83], v23 offset:0
  v_mfma_f32_16x16x32_bf16 v[84:87], a[88:91], a[24:27], v[84:87]
  ds_read_b128 a[84:87], v23 offset:2048
  v_mfma_f32_16x16x32_bf16 v[120:123], a[92:95], a[24:27], v[120:123]
  v_mfma_f32_16x16x32_bf16 v[156:159], a[96:99], a[24:27], v[156:159]
  v_mfma_f32_16x16x32_bf16 v[88:91], a[88:91], a[28:31], v[88:91]
  v_mfma_f32_16x16x32_bf16 v[124:127], a[92:95], a[28:31], v[124:127]
  v_mfma_f32_16x16x32_bf16 v[160:163], a[96:99], a[28:31], v[160:163]
  v_mfma_f32_16x16x32_bf16 v[92:95], a[88:91], a[32:35], v[92:95]
  v_mfma_f32_16x16x32_bf16 v[128:131], a[92:95], a[32:35], v[128:131]
  v_mfma_f32_16x16x32_bf16 v[164:167], a[96:99], a[32:35], v[164:167]
  v_mfma_f32_16x16x32_bf16 v[168:171], a[100:103], a[36:39], v[168:171]
  v_mfma_f32_16x16x32_bf16 v[172:175], a[100:103], a[40:43], v[172:175]
  s_waitcnt vmcnt(11)
  s_waitcnt lgkmcnt(0)
  s_barrier
  v_add_u32 v20, 45056, v20
  v_add_u32 v21, 45056, v21
  v_add_u32 v22, 45056, v22
  v_add_u32 v23, 45056, v23
  v_add_u32 v24, 45056, v24
  v_mfma_f32_16x16x32_bf16 v[96:99], a[108:111], a[44:47], v[96:99]
  ds_read_b64_tr_b16 a[88:89], v24 offset:0
  s_add_u32 m0, s26, 45056
  v_mfma_f32_16x16x32_bf16 v[132:135], a[112:115], a[44:47], v[132:135]
  ds_read_b64_tr_b16 a[90:91], v24 offset:512
  s_add_u32 s23, s24, 688128
  v_mfma_f32_16x16x32_bf16 v[64:67], a[104:107], a[48:51], v[64:67]
  ds_read_b64_tr_b16 a[92:93], v24 offset:8192
  buffer_load_dwordx4 v6, s[12:15], s23 offen offset:0 lds
  v_mfma_f32_16x16x32_bf16 v[100:103], a[108:111], a[48:51], v[100:103]
  ds_read_b64_tr_b16 a[94:95], v24 offset:8704
  buffer_load_dwordx4 v7, s[12:15], s23 offen offset:1024 lds
  v_mfma_f32_16x16x32_bf16 v[136:139], a[112:115], a[48:51], v[136:139]
  ds_read_b64_tr_b16 a[96:97], v24 offset:16384
  s_add_u32 m0, s26, 53248
  v_mfma_f32_16x16x32_bf16 v[68:71], a[104:107], a[52:55], v[68:71]
  ds_read_b64_tr_b16 a[98:99], v24 offset:16896
  s_add_u32 s23, s24, 689024
  v_mfma_f32_16x16x32_bf16 v[104:107], a[108:111], a[52:55], v[104:107]
  ds_read_b128 a[100:103], v25 offset:256
  buffer_load_dwordx4 v6, s[12:15], s23 offen offset:0 lds
  v_mfma_f32_16x16x32_bf16 v[140:143], a[112:115], a[52:55], v[140:143]
  ds_read_b128 a[0:3], v20 offset:0
  buffer_load_dwordx4 v7, s[12:15], s23 offen offset:1024 lds
  v_mfma_f32_16x16x32_bf16 v[72:75], a[104:107], a[56:59], v[72:75]
  ds_read_b128 a[4:7], v20 offset:2048
  s_add_u32 m0, s26, 61440
  v_mfma_f32_16x16x32_bf16 v[108:111], a[108:111], a[56:59], v[108:111]
  ds_read_b128 a[8:11], v20 offset:4096
  s_add_u32 s23, s24, 689920
  v_mfma_f32_16x16x32_bf16 v[144:147], a[112:115], a[56:59], v[144:147]
  ds_read_b128 a[12:15], v20 offset:6144
  buffer_load_dwordx4 v6, s[12:15], s23 offen offset:0 lds
  v_mfma_f32_16x16x32_bf16 v[76:79], a[104:107], a[60:63], v[76:79]
  ds_read_b128 a[16:19], v20 offset:8192
  buffer_load_dwordx4 v7, s[12:15], s23 offen offset:1024 lds
  v_mfma_f32_16x16x32_bf16 v[112:115], a[108:111], a[60:63], v[112:115]
  ds_read_b128 a[20:23], v20 offset:10240
  s_add_u32 m0, s25, 45056
  v_mfma_f32_16x16x32_bf16 v[148:151], a[112:115], a[60:63], v[148:151]
  ds_read_b128 a[24:27], v20 offset:12288
  s_mov_b32 s23, 512
  v_mfma_f32_16x16x32_bf16 v[80:83], a[104:107], a[64:67], v[80:83]
  ds_read_b128 a[28:31], v20 offset:14336
  buffer_load_dwordx4 v1, s[8:11], s23 offen offset:0 lds
  v_mfma_f32_16x16x32_bf16 v[116:119], a[108:111], a[64:67], v[116:119]
  ds_read_b128 a[32:35], v20 offset:16384
  buffer_load_dwordx4 v2, s[8:11], s23 offen offset:1024 lds
  v_mfma_f32_16x16x32_bf16 v[152:155], a[112:115], a[64:67], v[152:155]
  ds_read_b128 a[36:39], v22 offset:0
  buffer_load_dwordx4 v3, s[8:11], s23 offen offset:2048 lds
  v_mfma_f32_16x16x32_bf16 v[84:87], a[104:107], a[68:71], v[84:87]
  ds_read_b128 a[40:43], v22 offset:2048
  buffer_load_dwordx4 v4, s[8:11], s23 offen offset:3072 lds
  v_mfma_f32_16x16x32_bf16 v[120:123], a[108:111], a[68:71], v[120:123]
  s_add_u32 m0, s25, 49152
  v_mfma_f32_16x16x32_bf16 v[156:159], a[112:115], a[68:71], v[156:159]
  buffer_load_dwordx4 v5, s[8:11], s23 offen lds
  v_mfma_f32_16x16x32_bf16 v[88:91], a[104:107], a[72:75], v[88:91]
  v_mfma_f32_16x16x32_bf16 v[124:127], a[108:111], a[72:75], v[124:127]
  v_mfma_f32_16x16x32_bf16 v[160:163], a[112:115], a[72:75], v[160:163]
  v_mfma_f32_16x16x32_bf16 v[92:95], a[104:107], a[76:79], v[92:95]
  v_mfma_f32_16x16x32_bf16 v[128:131], a[108:111], a[76:79], v[128:131]
  v_mfma_f32_16x16x32_bf16 v[164:167], a[112:115], a[76:79], v[164:167]
  v_mfma_f32_16x16x32_bf16 v[168:171], a[116:119], a[80:83], v[168:171]
  v_mfma_f32_16x16x32_bf16 v[172:175], a[116:119], a[84:87], v[172:175]
  s_waitcnt lgkmcnt(0)
  v_mfma_f32_16x16x32_bf16 v[96:99], a[92:95], a[0:3], v[96:99]
  ds_read_b64_tr_b16 a[104:105], v24 offset:4096
  v_mfma_f32_16x16x32_bf16 v[132:135], a[96:99], a[0:3], v[132:135]
  ds_read_b64_tr_b16 a[106:107], v24 offset:4608
  v_mfma_f32_16x16x32_bf16 v[64:67], a[88:91], a[4:7], v[64:67]
  ds_read_b64_tr_b16 a[108:109], v24 offset:12288
  v_mfma_f32_16x16x32_bf16 v[100:103], a[92:95], a[4:7], v[100:103]
  ds_read_b64_tr_b16 a[110:111], v24 offset:12800
  v_mfma_f32_16x16x32_bf16 v[136:139], a[96:99], a[4:7], v[136:139]
  ds_read_b64_tr_b16 a[112:113], v24 offset:20480
  v_mfma_f32_16x16x32_bf16 v[68:71], a[88:91], a[8:11], v[68:71]
  ds_read_b64_tr_b16 a[114:115], v24 offset:20992
  v_mfma_f32_16x16x32_bf16 v[104:107], a[92:95], a[8:11], v[104:107]
  ds_read_b128 a[116:119], v25 offset:320
  v_mfma_f32_16x16x32_bf16 v[140:143], a[96:99], a[8:11], v[140:143]
  ds_read_b128 a[44:47], v21 offset:0
  v_mfma_f32_16x16x32_bf16 v[72:75], a[88:91], a[12:15], v[72:75]
  ds_read_b128 a[48:51], v21 offset:2048
  v_mfma_f32_16x16x32_bf16 v[108:111], a[92:95], a[12:15], v[108:111]
  ds_read_b128 a[52:55], v21 offset:4096
  v_mfma_f32_16x16x32_bf16 v[144:147], a[96:99], a[12:15], v[144:147]
  ds_read_b128 a[56:59], v21 offset:6144
  v_mfma_f32_16x16x32_bf16 v[76:79], a[88:91], a[16:19], v[76:79]
  ds_read_b128 a[60:63], v21 offset:8192
  v_mfma_f32_16x16x32_bf16 v[112:115], a[92:95], a[16:19], v[112:115]
  ds_read_b128 a[64:67], v21 offset:10240
  v_mfma_f32_16x16x32_bf16 v[148:151], a[96:99], a[16:19], v[148:151]
  ds_read_b128 a[68:71], v21 offset:12288
  v_mfma_f32_16x16x32_bf16 v[80:83], a[88:91], a[20:23], v[80:83]
  ds_read_b128 a[72:75], v21 offset:14336
  v_mfma_f32_16x16x32_bf16 v[116:119], a[92:95], a[20:23], v[116:119]
  ds_read_b128 a[76:79], v21 offset:16384
  v_mfma_f32_16x16x32_bf16 v[152:155], a[96:99], a[20:23], v[152:155]
  ds_read_b128 a[80:83], v23 offset:0
  v_mfma_f32_16x16x32_bf16 v[84:87], a[88:91], a[24:27], v[84:87]
  ds_read_b128 a[84:87], v23 offset:2048
  v_mfma_f32_16x16x32_bf16 v[120:123], a[92:95], a[24:27], v[120:123]
  v_mfma_f32_16x16x32_bf16 v[156:159], a[96:99], a[24:27], v[156:159]
  v_mfma_f32_16x16x32_bf16 v[88:91], a[88:91], a[28:31], v[88:91]
  v_mfma_f32_16x16x32_bf16 v[124:127], a[92:95], a[28:31], v[124:127]
  v_mfma_f32_16x16x32_bf16 v[160:163], a[96:99], a[28:31], v[160:163]
  v_mfma_f32_16x16x32_bf16 v[92:95], a[88:91], a[32:35], v[92:95]
  v_mfma_f32_16x16x32_bf16 v[128:131], a[92:95], a[32:35], v[128:131]
  v_mfma_f32_16x16x32_bf16 v[164:167], a[96:99], a[32:35], v[164:167]
  v_mfma_f32_16x16x32_bf16 v[168:171], a[100:103], a[36:39], v[168:171]
  v_mfma_f32_16x16x32_bf16 v[172:175], a[100:103], a[40:43], v[172:175]
  s_waitcnt vmcnt(11)
  s_waitcnt lgkmcnt(0)
  s_barrier
  v_subrev_u32 v20, 90112, v20
  v_subrev_u32 v21, 90112, v21
  v_subrev_u32 v22, 90112, v22
  v_subrev_u32 v23, 90112, v23
  v_subrev_u32 v24, 90112, v24
  v_mfma_f32_16x16x32_bf16 v[96:99], a[108:111], a[44:47], v[96:99]
  ds_read_b64_tr_b16 a[88:89], v24 offset:0
  s_add_u32 m0, s26, 90112
  v_mfma_f32_16x16x32_bf16 v[132:135], a[112:115], a[44:47], v[132:135]
  ds_read_b64_tr_b16 a[90:91], v24 offset:512
  s_add_u32 s23, s24, 860160
  v_mfma_f32_16x16x32_bf16 v[64:67], a[104:107], a[48:51], v[64:67]
  ds_read_b64_tr_b16 a[92:93], v24 offset:8192
  buffer_load_dwordx4 v6, s[12:15], s23 offen offset:0 lds
  v_mfma_f32_16x16x32_bf16 v[100:103], a[108:111], a[48:51], v[100:103]
  ds_read_b64_tr_b16 a[94:95], v24 offset:8704
  buffer_load_dwordx4 v7, s[12:15], s23 offen offset:1024 lds
  v_mfma_f32_16x16x32_bf16 v[136:139], a[112:115], a[48:51], v[136:139]
  ds_read_b64_tr_b16 a[96:97], v24 offset:16384
  s_add_u32 m0, s26, 98304
  v_mfma_f32_16x16x32_bf16 v[68:71], a[104:107], a[52:55], v[68:71]
  ds_read_b64_tr_b16 a[98:99], v24 offset:16896
  s_add_u32 s23, s24, 861056
  v_mfma_f32_16x16x32_bf16 v[104:107], a[108:111], a[52:55], v[104:107]
  ds_read_b128 a[100:103], v25 offset:384
  buffer_load_dwordx4 v6, s[12:15], s23 offen offset:0 lds
  v_mfma_f32_16x16x32_bf16 v[140:143], a[112:115], a[52:55], v[140:143]
  ds_read_b128 a[0:3], v20 offset:0
  buffer_load_dwordx4 v7, s[12:15], s23 offen offset:1024 lds
  v_mfma_f32_16x16x32_bf16 v[72:75], a[104:107], a[56:59], v[72:75]
  ds_read_b128 a[4:7], v20 offset:2048
  s_add_u32 m0, s26, 106496
  v_mfma_f32_16x16x32_bf16 v[108:111], a[108:111], a[56:59], v[108:111]
  ds_read_b128 a[8:11], v20 offset:4096
  s_add_u32 s23, s24, 861952
  v_mfma_f32_16x16x32_bf16 v[144:147], a[112:115], a[56:59], v[144:147]
  ds_read_b128 a[12:15], v20 offset:6144
  buffer_load_dwordx4 v6, s[12:15], s23 offen offset:0 lds
  v_mfma_f32_16x16x32_bf16 v[76:79], a[104:107], a[60:63], v[76:79]
  ds_read_b128 a[16:19], v20 offset:8192
  buffer_load_dwordx4 v7, s[12:15], s23 offen offset:1024 lds
  v_mfma_f32_16x16x32_bf16 v[112:115], a[108:111], a[60:63], v[112:115]
  ds_read_b128 a[20:23], v20 offset:10240
  s_add_u32 m0, s25, 90112
  v_mfma_f32_16x16x32_bf16 v[148:151], a[112:115], a[60:63], v[148:151]
  ds_read_b128 a[24:27], v20 offset:12288
  s_mov_b32 s23, 640
  v_mfma_f32_16x16x32_bf16 v[80:83], a[104:107], a[64:67], v[80:83]
  ds_read_b128 a[28:31], v20 offset:14336
  buffer_load_dwordx4 v1, s[8:11], s23 offen offset:0 lds
  v_mfma_f32_16x16x32_bf16 v[116:119], a[108:111], a[64:67], v[116:119]
  ds_read_b128 a[32:35], v20 offset:16384
  buffer_load_dwordx4 v2, s[8:11], s23 offen offset:1024 lds
  v_mfma_f32_16x16x32_bf16 v[152:155], a[112:115], a[64:67], v[152:155]
  ds_read_b128 a[36:39], v22 offset:0
  buffer_load_dwordx4 v3, s[8:11], s23 offen offset:2048 lds
  v_mfma_f32_16x16x32_bf16 v[84:87], a[104:107], a[68:71], v[84:87]
  ds_read_b128 a[40:43], v22 offset:2048
  buffer_load_dwordx4 v4, s[8:11], s23 offen offset:3072 lds
  v_mfma_f32_16x16x32_bf16 v[120:123], a[108:111], a[68:71], v[120:123]
  s_add_u32 m0, s25, 94208
  v_mfma_f32_16x16x32_bf16 v[156:159], a[112:115], a[68:71], v[156:159]
  buffer_load_dwordx4 v5, s[8:11], s23 offen lds
  v_mfma_f32_16x16x32_bf16 v[88:91], a[104:107], a[72:75], v[88:91]
  v_mfma_f32_16x16x32_bf16 v[124:127], a[108:111], a[72:75], v[124:127]
  v_mfma_f32_16x16x32_bf16 v[160:163], a[112:115], a[72:75], v[160:163]
  v_mfma_f32_16x16x32_bf16 v[92:95], a[104:107], a[76:79], v[92:95]
  v_mfma_f32_16x16x32_bf16 v[128:131], a[108:111], a[76:79], v[128:131]
  v_mfma_f32_16x16x32_bf16 v[164:167], a[112:115], a[76:79], v[164:167]
  v_mfma_f32_16x16x32_bf16 v[168:171], a[116:119], a[80:83], v[168:171]
  v_mfma_f32_16x16x32_bf16 v[172:175], a[116:119], a[84:87], v[172:175]
  s_waitcnt lgkmcnt(0)
  v_mfma_f32_16x16x32_bf16 v[96:99], a[92:95], a[0:3], v[96:99]
  ds_read_b64_tr_b16 a[104:105], v24 offset:4096
  v_mfma_f32_16x16x32_bf16 v[132:135], a[96:99], a[0:3], v[132:135]
  ds_read_b64_tr_b16 a[106:107], v24 offset:4608
  v_mfma_f32_16x16x32_bf16 v[64:67], a[88:91], a[4:7], v[64:67]
  ds_read_b64_tr_b16 a[108:109], v24 offset:12288
  v_mfma_f32_16x16x32_bf16 v[100:103], a[92:95], a[4:7], v[100:103]
  ds_read_b64_tr_b16 a[110:111], v24 offset:12800
  v_mfma_f32_16x16x32_bf16 v[136:139], a[96:99], a[4:7], v[136:139]
  ds_read_b64_tr_b16 a[112:113], v24 offset:20480
  v_mfma_f32_16x16x32_bf16 v[68:71], a[88:91], a[8:11], v[68:71]
  ds_read_b64_tr_b16 a[114:115], v24 offset:20992
  v_mfma_f32_16x16x32_bf16 v[104:107], a[92:95], a[8:11], v[104:107]
  ds_read_b128 a[116:119], v25 offset:448
  v_mfma_f32_16x16x32_bf16 v[140:143], a[96:99], a[8:11], v[140:143]
  ds_read_b128 a[44:47], v21 offset:0
  v_mfma_f32_16x16x32_bf16 v[72:75], a[88:91], a[12:15], v[72:75]
  ds_read_b128 a[48:51], v21 offset:2048
  v_mfma_f32_16x16x32_bf16 v[108:111], a[92:95], a[12:15], v[108:111]
  ds_read_b128 a[52:55], v21 offset:4096
  v_mfma_f32_16x16x32_bf16 v[144:147], a[96:99], a[12:15], v[144:147]
  ds_read_b128 a[56:59], v21 offset:6144
  v_mfma_f32_16x16x32_bf16 v[76:79], a[88:91], a[16:19], v[76:79]
  ds_read_b128 a[60:63], v21 offset:8192
  v_mfma_f32_16x16x32_bf16 v[112:115], a[92:95], a[16:19], v[112:115]
  ds_read_b128 a[64:67], v21 offset:10240
  v_mfma_f32_16x16x32_bf16 v[148:151], a[96:99], a[16:19], v[148:151]
  ds_read_b128 a[68:71], v21 offset:12288
  v_mfma_f32_16x16x32_bf16 v[80:83], a[88:91], a[20:23], v[80:83]
  ds_read_b128 a[72:75], v21 offset:14336
  v_mfma_f32_16x16x32_bf16 v[116:119], a[92:95], a[20:23], v[116:119]
  ds_read_b128 a[76:79], v21 offset:16384
  v_mfma_f32_16x16x32_bf16 v[152:155], a[96:99], a[20:23], v[152:155]
  ds_read_b128 a[80:83], v23 offset:0
  v_mfma_f32_16x16x32_bf16 v[84:87], a[88:91], a[24:27], v[84:87]
  ds_read_b128 a[84:87], v23 offset:2048
  v_mfma_f32_16x16x32_bf16 v[120:123], a[92:95], a[24:27], v[120:123]
  v_mfma_f32_16x16x32_bf16 v[156:159], a[96:99], a[24:27], v[156:159]
  v_mfma_f32_16x16x32_bf16 v[88:91], a[88:91], a[28:31], v[88:91]
  v_mfma_f32_16x16x32_bf16 v[124:127], a[92:95], a[28:31], v[124:127]
  v_mfma_f32_16x16x32_bf16 v[160:163], a[96:99], a[28:31], v[160:163]
  v_mfma_f32_16x16x32_bf16 v[92:95], a[88:91], a[32:35], v[92:95]
  v_mfma_f32_16x16x32_bf16 v[128:131], a[92:95], a[32:35], v[128:131]
  v_mfma_f32_16x16x32_bf16 v[164:167], a[96:99], a[32:35], v[164:167]
  v_mfma_f32_16x16x32_bf16 v[168:171], a[100:103], a[36:39], v[168:171]
  v_mfma_f32_16x16x32_bf16 v[172:175], a[100:103], a[40:43], v[172:175]
  s_waitcnt vmcnt(11)
  s_waitcnt lgkmcnt(0)
  s_barrier
  v_add_u32 v20, 45056, v20
  v_add_u32 v21, 45056, v21
  v_add_u32 v22, 45056, v22
  v_add_u32 v23, 45056, v23
  v_add_u32 v24, 45056, v24
  v_mfma_f32_16x16x32_bf16 v[96:99], a[108:111], a[44:47], v[96:99]
  ds_read_b64_tr_b16 a[88:89], v24 offset:0
  s_add_u32 m0, s26, 0
  v_mfma_f32_16x16x32_bf16 v[132:135], a[112:115], a[44:47], v[132:135]
  ds_read_b64_tr_b16 a[90:91], v24 offset:512
  s_add_u32 s23, s24, 1032192
  v_mfma_f32_16x16x32_bf16 v[64:67], a[104:107], a[48:51], v[64:67]
  ds_read_b64_tr_b16 a[92:93], v24 offset:8192
  buffer_load_dwordx4 v6, s[12:15], s23 offen offset:0 lds
  v_mfma_f32_16x16x32_bf16 v[100:103], a[108:111], a[48:51], v[100:103]
  ds_read_b64_tr_b16 a[94:95], v24 offset:8704
  buffer_load_dwordx4 v7, s[12:15], s23 offen offset:1024 lds
  v_mfma_f32_16x16x32_bf16 v[136:139], a[112:115], a[48:51], v[136:139]
  ds_read_b64_tr_b16 a[96:97], v24 offset:16384
  s_add_u32 m0, s26, 8192
  v_mfma_f32_16x16x32_bf16 v[68:71], a[104:107], a[52:55], v[68:71]
  ds_read_b64_tr_b16 a[98:99], v24 offset:16896
  s_add_u32 s23, s24, 1033088
  v_mfma_f32_16x16x32_bf16 v[104:107], a[108:111], a[52:55], v[104:107]
  ds_read_b128 a[100:103], v25 offset:512
  buffer_load_dwordx4 v6, s[12:15], s23 offen offset:0 lds
  v_mfma_f32_16x16x32_bf16 v[140:143], a[112:115], a[52:55], v[140:143]
  ds_read_b128 a[0:3], v20 offset:0
  buffer_load_dwordx4 v7, s[12:15], s23 offen offset:1024 lds
  v_mfma_f32_16x16x32_bf16 v[72:75], a[104:107], a[56:59], v[72:75]
  ds_read_b128 a[4:7], v20 offset:2048
  s_add_u32 m0, s26, 16384
  v_mfma_f32_16x16x32_bf16 v[108:111], a[108:111], a[56:59], v[108:111]
  ds_read_b128 a[8:11], v20 offset:4096
  s_add_u32 s23, s24, 1033984
  v_mfma_f32_16x16x32_bf16 v[144:147], a[112:115], a[56:59], v[144:147]
  ds_read_b128 a[12:15], v20 offset:6144
  buffer_load_dwordx4 v6, s[12:15], s23 offen offset:0 lds
  v_mfma_f32_16x16x32_bf16 v[76:79], a[104:107], a[60:63], v[76:79]
  ds_read_b128 a[16:19], v20 offset:8192
  buffer_load_dwordx4 v7, s[12:15], s23 offen offset:1024 lds
  v_mfma_f32_16x16x32_bf16 v[112:115], a[108:111], a[60:63], v[112:115]
  ds_read_b128 a[20:23], v20 offset:10240
  s_add_u32 m0, s25, 0
  v_mfma_f32_16x16x32_bf16 v[148:151], a[112:115], a[60:63], v[148:151]
  ds_read_b128 a[24:27], v20 offset:12288
  s_mov_b32 s23, 768
  v_mfma_f32_16x16x32_bf16 v[80:83], a[104:107], a[64:67], v[80:83]
  ds_read_b128 a[28:31], v20 offset:14336
  buffer_load_dwordx4 v1, s[8:11], s23 offen offset:0 lds
  v_mfma_f32_16x16x32_bf16 v[116:119], a[108:111], a[64:67], v[116:119]
  ds_read_b128 a[32:35], v20 offset:16384
  buffer_load_dwordx4 v2, s[8:11], s23 offen offset:1024 lds
  v_mfma_f32_16x16x32_bf16 v[152:155], a[112:115], a[64:67], v[152:155]
  ds_read_b128 a[36:39], v22 offset:0
  buffer_load_dwordx4 v3, s[8:11], s23 offen offset:2048 lds
  v_mfma_f32_16x16x32_bf16 v[84:87], a[104:107], a[68:71], v[84:87]
  ds_read_b128 a[40:43], v22 offset:2048
  buffer_load_dwordx4 v4, s[8:11], s23 offen offset:3072 lds
  v_mfma_f32_16x16x32_bf16 v[120:123], a[108:111], a[68:71], v[120:123]
  s_add_u32 m0, s25, 4096
  v_mfma_f32_16x16x32_bf16 v[156:159], a[112:115], a[68:71], v[156:159]
  buffer_load_dwordx4 v5, s[8:11], s23 offen lds
  v_mfma_f32_16x16x32_bf16 v[88:91], a[104:107], a[72:75], v[88:91]
  v_mfma_f32_16x16x32_bf16 v[124:127], a[108:111], a[72:75], v[124:127]
  v_mfma_f32_16x16x32_bf16 v[160:163], a[112:115], a[72:75], v[160:163]
  v_mfma_f32_16x16x32_bf16 v[92:95], a[104:107], a[76:79], v[92:95]
  v_mfma_f32_16x16x32_bf16 v[128:131], a[108:111], a[76:79], v[128:131]
  v_mfma_f32_16x16x32_bf16 v[164:167], a[112:115], a[76:79], v[164:167]
  v_mfma_f32_16x16x32_bf16 v[168:171], a[116:119], a[80:83], v[168:171]
  v_mfma_f32_16x16x32_bf16 v[172:175], a[116:119], a[84:87], v[172:175]
  s_waitcnt lgkmcnt(0)
  v_mfma_f32_16x16x32_bf16 v[96:99], a[92:95], a[0:3], v[96:99]
  ds_read_b64_tr_b16 a[104:105], v24 offset:4096
  v_mfma_f32_16x16x32_bf16 v[132:135], a[96:99], a[0:3], v[132:135]
  ds_read_b64_tr_b16 a[106:107], v24 offset:4608
  v_mfma_f32_16x16x32_bf16 v[64:67], a[88:91], a[4:7], v[64:67]
  ds_read_b64_tr_b16 a[108:109], v24 offset:12288
  v_mfma_f32_16x16x32_bf16 v[100:103], a[92:95], a[4:7], v[100:103]
  ds_read_b64_tr_b16 a[110:111], v24 offset:12800
  v_mfma_f32_16x16x32_bf16 v[136:139], a[96:99], a[4:7], v[136:139]
  ds_read_b64_tr_b16 a[112:113], v24 offset:20480
  v_mfma_f32_16x16x32_bf16 v[68:71], a[88:91], a[8:11], v[68:71]
  ds_read_b64_tr_b16 a[114:115], v24 offset:20992
  v_mfma_f32_16x16x32_bf16 v[104:107], a[92:95], a[8:11], v[104:107]
  ds_read_b128 a[116:119], v25 offset:576
  v_mfma_f32_16x16x32_bf16 v[140:143], a[96:99], a[8:11], v[140:143]
  ds_read_b128 a[44:47], v21 offset:0
  v_mfma_f32_16x16x32_bf16 v[72:75], a[88:91], a[12:15], v[72:75]
  ds_read_b128 a[48:51], v21 offset:2048
  v_mfma_f32_16x16x32_bf16 v[108:111], a[92:95], a[12:15], v[108:111]
  ds_read_b128 a[52:55], v21 offset:4096
  v_mfma_f32_16x16x32_bf16 v[144:147], a[96:99], a[12:15], v[144:147]
  ds_read_b128 a[56:59], v21 offset:6144
  v_mfma_f32_16x16x32_bf16 v[76:79], a[88:91], a[16:19], v[76:79]
  ds_read_b128 a[60:63], v21 offset:8192
  v_mfma_f32_16x16x32_bf16 v[112:115], a[92:95], a[16:19], v[112:115]
  ds_read_b128 a[64:67], v21 offset:10240
  v_mfma_f32_16x16x32_bf16 v[148:151], a[96:99], a[16:19], v[148:151]
  ds_read_b128 a[68:71], v21 offset:12288
  v_mfma_f32_16x16x32_bf16 v[80:83], a[88:91], a[20:23], v[80:83]
  ds_read_b128 a[72:75], v21 offset:14336
  v_mfma_f32_16x16x32_bf16 v[116:119], a[92:95], a[20:23], v[116:119]
  ds_read_b128 a[76:79], v21 offset:16384
  v_mfma_f32_16x16x32_bf16 v[152:155], a[96:99], a[20:23], v[152:155]
  ds_read_b128 a[80:83], v23 offset:0
  v_mfma_f32_16x16x32_bf16 v[84:87], a[88:91], a[24:27], v[84:87]
  ds_read_b128 a[84:87], v23 offset:2048
  v_mfma_f32_16x16x32_bf16 v[120:123], a[92:95], a[24:27], v[120:123]
  v_mfma_f32_16x16x32_bf16 v[156:159], a[96:99], a[24:27], v[156:159]
  v_mfma_f32_16x16x32_bf16 v[88:91], a[88:91], a[28:31], v[88:91]
  v_mfma_f32_16x16x32_bf16 v[124:127], a[92:95], a[28:31], v[124:127]
  v_mfma_f32_16x16x32_bf16 v[160:163], a[96:99], a[28:31], v[160:163]
  v_mfma_f32_16x16x32_bf16 v[92:95], a[88:91], a[32:35], v[92:95]
  v_mfma_f32_16x16x32_bf16 v[128:131], a[92:95], a[32:35], v[128:131]
  v_mfma_f32_16x16x32_bf16 v[164:167], a[96:99], a[32:35], v[164:167]
  v_mfma_f32_16x16x32_bf16 v[168:171], a[100:103], a[36:39], v[168:171]
  v_mfma_f32_16x16x32_bf16 v[172:175], a[100:103], a[40:43], v[172:175]
  s_waitcnt vmcnt(11)
  s_waitcnt lgkmcnt(0)
  s_barrier
  v_add_u32 v20, 45056, v20
  v_add_u32 v21, 45056, v21
  v_add_u32 v22, 45056, v22
  v_add_u32 v23, 45056, v23
  v_add_u32 v24, 45056, v24
  v_mfma_f32_16x16x32_bf16 v[96:99], a[108:111], a[44:47], v[96:99]
  ds_read_b64_tr_b16 a[88:89], v24 offset:0
  v_mfma_f32_16x16x32_bf16 v[132:135], a[112:115], a[44:47], v[132:135]
  ds_read_b64_tr_b16 a[90:91], v24 offset:512
  v_mfma_f32_16x16x32_bf16 v[64:67], a[104:107], a[48:51], v[64:67]
  ds_read_b64_tr_b16 a[92:93], v24 offset:8192
  v_mfma_f32_16x16x32_bf16 v[100:103], a[108:111], a[48:51], v[100:103]
  ds_read_b64_tr_b16 a[94:95], v24 offset:8704
  v_mfma_f32_16x16x32_bf16 v[136:139], a[112:115], a[48:51], v[136:139]
  ds_read_b64_tr_b16 a[96:97], v24 offset:16384
  v_mfma_f32_16x16x32_bf16 v[68:71], a[104:107], a[52:55], v[68:71]
  ds_read_b64_tr_b16 a[98:99], v24 offset:16896
  v_mfma_f32_16x16x32_bf16 v[104:107], a[108:111], a[52:55], v[104:107]
  ds_read_b128 a[100:103], v25 offset:640
  v_mfma_f32_16x16x32_bf16 v[140:143], a[112:115], a[52:55], v[140:143]
  ds_read_b128 a[0:3], v20 offset:0
  v_mfma_f32_16x16x32_bf16 v[72:75], a[104:107], a[56:59], v[72:75]
  ds_read_b128 a[4:7], v20 offset:2048
  v_mfma_f32_16x16x32_bf16 v[108:111], a[108:111], a[56:59], v[108:111]
  ds_read_b128 a[8:11], v20 offset:4096
  v_mfma_f32_16x16x32_bf16 v[144:147], a[112:115], a[56:59], v[144:147]
  ds_read_b128 a[12:15], v20 offset:6144
  v_mfma_f32_16x16x32_bf16 v[76:79], a[104:107], a[60:63], v[76:79]
  ds_read_b128 a[16:19], v20 offset:8192
  v_mfma_f32_16x16x32_bf16 v[112:115], a[108:111], a[60:63], v[112:115]
  ds_read_b128 a[20:23], v20 offset:10240
  v_mfma_f32_16x16x32_bf16 v[148:151], a[112:115], a[60:63], v[148:151]
  ds_read_b128 a[24:27], v20 offset:12288
  v_mfma_f32_16x16x32_bf16 v[80:83], a[104:107], a[64:67], v[80:83]
  ds_read_b128 a[28:31], v20 offset:14336
  v_mfma_f32_16x16x32_bf16 v[116:119], a[108:111], a[64:67], v[116:119]
  ds_read_b128 a[32:35], v20 offset:16384
  v_mfma_f32_16x16x32_bf16 v[152:155], a[112:115], a[64:67], v[152:155]
  ds_read_b128 a[36:39], v22 offset:0
  v_mfma_f32_16x16x32_bf16 v[84:87], a[104:107], a[68:71], v[84:87]
  ds_read_b128 a[40:43], v22 offset:2048
  v_mfma_f32_16x16x32_bf16 v[120:123], a[108:111], a[68:71], v[120:123]
  v_mfma_f32_16x16x32_bf16 v[156:159], a[112:115], a[68:71], v[156:159]
  v_mfma_f32_16x16x32_bf16 v[88:91], a[104:107], a[72:75], v[88:91]
  v_mfma_f32_16x16x32_bf16 v[124:127], a[108:111], a[72:75], v[124:127]
  v_mfma_f32_16x16x32_bf16 v[160:163], a[112:115], a[72:75], v[160:163]
  v_mfma_f32_16x16x32_bf16 v[92:95], a[104:107], a[76:79], v[92:95]
  v_mfma_f32_16x16x32_bf16 v[128:131], a[108:111], a[76:79], v[128:131]
  v_mfma_f32_16x16x32_bf16 v[164:167], a[112:115], a[76:79], v[164:167]
  v_mfma_f32_16x16x32_bf16 v[168:171], a[116:119], a[80:83], v[168:171]
  v_mfma_f32_16x16x32_bf16 v[172:175], a[116:119], a[84:87], v[172:175]
  s_lshl_b32 s75, s22, 18
  s_lshl_b32 s100, s21, 15
  s_add_u32 s75, s75, s100
  s_lshl_b32 s100, s3, 13
  s_add_u32 s75, s75, s100
  v_lshlrev_b32 v60, 7, v12
  v_add_u32 v60, s75, v60
  global_load_dword v56, v60, s[46:47]
  s_lshl_b32 s27, s20, 3
  s_add_u32 s27, s27, s21
  s_lshl_b32 s27, s27, 2
  s_add_u32 s27, s27, s3
  s_min_u32 s27, s27, 447
  s_mul_i32 s28, s27, 1792
  v_min_u32 v57, 13, v12
  v_lshlrev_b32 v57, 7, v57
  v_add_u32 v58, s28, v57
  global_load_dword v56, v58, s[50:51]
  s_mul_i32 s28, s27, 896
  v_min_u32 v57, 6, v12
  v_lshlrev_b32 v57, 7, v57
  v_add_u32 v58, s28, v57
  global_load_dword v56, v58, s[40:41]
  s_waitcnt lgkmcnt(0)
  v_mfma_f32_16x16x32_bf16 v[96:99], a[92:95], a[0:3], v[96:99]
  ds_read_b64_tr_b16 a[104:105], v24 offset:4096
  v_mfma_f32_16x16x32_bf16 v[132:135], a[96:99], a[0:3], v[132:135]
  ds_read_b64_tr_b16 a[106:107], v24 offset:4608
  v_mfma_f32_16x16x32_bf16 v[64:67], a[88:91], a[4:7], v[64:67]
  ds_read_b64_tr_b16 a[108:109], v24 offset:12288
  v_mfma_f32_16x16x32_bf16 v[100:103], a[92:95], a[4:7], v[100:103]
  ds_read_b64_tr_b16 a[110:111], v24 offset:12800
  v_mfma_f32_16x16x32_bf16 v[136:139], a[96:99], a[4:7], v[136:139]
  ds_read_b64_tr_b16 a[112:113], v24 offset:20480
  v_mfma_f32_16x16x32_bf16 v[68:71], a[88:91], a[8:11], v[68:71]
  ds_read_b64_tr_b16 a[114:115], v24 offset:20992
  v_mfma_f32_16x16x32_bf16 v[104:107], a[92:95], a[8:11], v[104:107]
  ds_read_b128 a[116:119], v25 offset:704
  v_mfma_f32_16x16x32_bf16 v[140:143], a[96:99], a[8:11], v[140:143]
  ds_read_b128 a[44:47], v21 offset:0
  v_mfma_f32_16x16x32_bf16 v[72:75], a[88:91], a[12:15], v[72:75]
  ds_read_b128 a[48:51], v21 offset:2048
  v_mfma_f32_16x16x32_bf16 v[108:111], a[92:95], a[12:15], v[108:111]
  ds_read_b128 a[52:55], v21 offset:4096
  v_mfma_f32_16x16x32_bf16 v[144:147], a[96:99], a[12:15], v[144:147]
  ds_read_b128 a[56:59], v21 offset:6144
  v_mfma_f32_16x16x32_bf16 v[76:79], a[88:91], a[16:19], v[76:79]
  ds_read_b128 a[60:63], v21 offset:8192
  v_mfma_f32_16x16x32_bf16 v[112:115], a[92:95], a[16:19], v[112:115]
  ds_read_b128 a[64:67], v21 offset:10240
  v_mfma_f32_16x16x32_bf16 v[148:151], a[96:99], a[16:19], v[148:151]
  ds_read_b128 a[68:71], v21 offset:12288
  v_mfma_f32_16x16x32_bf16 v[80:83], a[88:91], a[20:23], v[80:83]
  ds_read_b128 a[72:75], v21 offset:14336
  v_mfma_f32_16x16x32_bf16 v[116:119], a[92:95], a[20:23], v[116:119]
  ds_read_b128 a[76:79], v21 offset:16384
  v_mfma_f32_16x16x32_bf16 v[152:155], a[96:99], a[20:23], v[152:155]
  ds_read_b128 a[80:83], v23 offset:0
  v_mfma_f32_16x16x32_bf16 v[84:87], a[88:91], a[24:27], v[84:87]
  ds_read_b128 a[84:87], v23 offset:2048
  v_mfma_f32_16x16x32_bf16 v[120:123], a[92:95], a[24:27], v[120:123]
  v_mfma_f32_16x16x32_bf16 v[156:159], a[96:99], a[24:27], v[156:159]
  v_mfma_f32_16x16x32_bf16 v[88:91], a[88:91], a[28:31], v[88:91]
  v_mfma_f32_16x16x32_bf16 v[124:127], a[92:95], a[28:31], v[124:127]
  v_mfma_f32_16x16x32_bf16 v[160:163], a[96:99], a[28:31], v[160:163]
  v_mfma_f32_16x16x32_bf16 v[92:95], a[88:91], a[32:35], v[92:95]
  v_mfma_f32_16x16x32_bf16 v[128:131], a[92:95], a[32:35], v[128:131]
  v_mfma_f32_16x16x32_bf16 v[164:167], a[96:99], a[32:35], v[164:167]
  v_mfma_f32_16x16x32_bf16 v[168:171], a[100:103], a[36:39], v[168:171]
  v_mfma_f32_16x16x32_bf16 v[172:175], a[100:103], a[40:43], v[172:175]
  s_waitcnt vmcnt(3)
  s_waitcnt lgkmcnt(0)
  s_barrier
  v_subrev_u32 v20, 90112, v20
  v_subrev_u32 v21, 90112, v21
  v_subrev_u32 v22, 90112, v22
  v_subrev_u32 v23, 90112, v23
  v_subrev_u32 v24, 90112, v24
  v_mfma_f32_16x16x32_bf16 v[96:99], a[108:111], a[44:47], v[96:99]
  ds_read_b64_tr_b16 a[88:89], v24 offset:0
  v_mfma_f32_16x16x32_bf16 v[132:135], a[112:115], a[44:47], v[132:135]
  ds_read_b64_tr_b16 a[90:91], v24 offset:512
  v_mfma_f32_16x16x32_bf16 v[64:67], a[104:107], a[48:51], v[64:67]
  ds_read_b64_tr_b16 a[92:93], v24 offset:8192
  v_mfma_f32_16x16x32_bf16 v[100:103], a[108:111], a[48:51], v[100:103]
  ds_read_b64_tr_b16 a[94:95], v24 offset:8704
  v_mfma_f32_16x16x32_bf16 v[136:139], a[112:115], a[48:51], v[136:139]
  ds_read_b64_tr_b16 a[96:97], v24 offset:16384
  v_mfma_f32_16x16x32_bf16 v[68:71], a[104:107], a[52:55], v[68:71]
  ds_read_b64_tr_b16 a[98:99], v24 offset:16896
  v_mfma_f32_16x16x32_bf16 v[104:107], a[108:111], a[52:55], v[104:107]
  ds_read_b128 a[100:103], v25 offset:768
  v_mfma_f32_16x16x32_bf16 v[140:143], a[112:115], a[52:55], v[140:143]
  ds_read_b128 a[0:3], v20 offset:0
  v_mfma_f32_16x16x32_bf16 v[72:75], a[104:107], a[56:59], v[72:75]
  ds_read_b128 a[4:7], v20 offset:2048
  v_mfma_f32_16x16x32_bf16 v[108:111], a[108:111], a[56:59], v[108:111]
  ds_read_b128 a[8:11], v20 offset:4096
  v_mfma_f32_16x16x32_bf16 v[144:147], a[112:115], a[56:59], v[144:147]
  ds_read_b128 a[12:15], v20 offset:6144
  v_mfma_f32_16x16x32_bf16 v[76:79], a[104:107], a[60:63], v[76:79]
  ds_read_b128 a[16:19], v20 offset:8192
  v_mfma_f32_16x16x32_bf16 v[112:115], a[108:111], a[60:63], v[112:115]
  ds_read_b128 a[20:23], v20 offset:10240
  v_mfma_f32_16x16x32_bf16 v[148:151], a[112:115], a[60:63], v[148:151]
  ds_read_b128 a[24:27], v20 offset:12288
  v_mfma_f32_16x16x32_bf16 v[80:83], a[104:107], a[64:67], v[80:83]
  ds_read_b128 a[28:31], v20 offset:14336
  v_mfma_f32_16x16x32_bf16 v[116:119], a[108:111], a[64:67], v[116:119]
  ds_read_b128 a[32:35], v20 offset:16384
  v_mfma_f32_16x16x32_bf16 v[152:155], a[112:115], a[64:67], v[152:155]
  ds_read_b128 a[36:39], v22 offset:0
  v_mfma_f32_16x16x32_bf16 v[84:87], a[104:107], a[68:71], v[84:87]
  ds_read_b128 a[40:43], v22 offset:2048
  v_mfma_f32_16x16x32_bf16 v[120:123], a[108:111], a[68:71], v[120:123]
  v_mfma_f32_16x16x32_bf16 v[156:159], a[112:115], a[68:71], v[156:159]
  v_mfma_f32_16x16x32_bf16 v[88:91], a[104:107], a[72:75], v[88:91]
  v_mfma_f32_16x16x32_bf16 v[124:127], a[108:111], a[72:75], v[124:127]
  v_mfma_f32_16x16x32_bf16 v[160:163], a[112:115], a[72:75], v[160:163]
  v_mfma_f32_16x16x32_bf16 v[92:95], a[104:107], a[76:79], v[92:95]
  v_mfma_f32_16x16x32_bf16 v[128:131], a[108:111], a[76:79], v[128:131]
  v_mfma_f32_16x16x32_bf16 v[164:167], a[112:115], a[76:79], v[164:167]
  v_mfma_f32_16x16x32_bf16 v[168:171], a[116:119], a[80:83], v[168:171]
  v_mfma_f32_16x16x32_bf16 v[172:175], a[116:119], a[84:87], v[172:175]
  s_waitcnt lgkmcnt(0)
  v_mfma_f32_16x16x32_bf16 v[96:99], a[92:95], a[0:3], v[96:99]
  ds_read_b64_tr_b16 a[104:105], v24 offset:4096
  v_mfma_f32_16x16x32_bf16 v[132:135], a[96:99], a[0:3], v[132:135]
  ds_read_b64_tr_b16 a[106:107], v24 offset:4608
  v_mfma_f32_16x16x32_bf16 v[64:67], a[88:91], a[4:7], v[64:67]
  ds_read_b64_tr_b16 a[108:109], v24 offset:12288
  v_mfma_f32_16x16x32_bf16 v[100:103], a[92:95], a[4:7], v[100:103]
  ds_read_b64_tr_b16 a[110:111], v24 offset:12800
  v_mfma_f32_16x16x32_bf16 v[136:139], a[96:99], a[4:7], v[136:139]
  ds_read_b64_tr_b16 a[112:113], v24 offset:20480
  v_mfma_f32_16x16x32_bf16 v[68:71], a[88:91], a[8:11], v[68:71]
  ds_read_b64_tr_b16 a[114:115], v24 offset:20992
  v_mfma_f32_16x16x32_bf16 v[104:107], a[92:95], a[8:11], v[104:107]
  ds_read_b128 a[116:119], v25 offset:832
  v_mfma_f32_16x16x32_bf16 v[140:143], a[96:99], a[8:11], v[140:143]
  ds_read_b128 a[44:47], v21 offset:0
  v_mfma_f32_16x16x32_bf16 v[72:75], a[88:91], a[12:15], v[72:75]
  ds_read_b128 a[48:51], v21 offset:2048
  v_mfma_f32_16x16x32_bf16 v[108:111], a[92:95], a[12:15], v[108:111]
  ds_read_b128 a[52:55], v21 offset:4096
  v_mfma_f32_16x16x32_bf16 v[144:147], a[96:99], a[12:15], v[144:147]
  ds_read_b128 a[56:59], v21 offset:6144
  v_mfma_f32_16x16x32_bf16 v[76:79], a[88:91], a[16:19], v[76:79]
  ds_read_b128 a[60:63], v21 offset:8192
  v_mfma_f32_16x16x32_bf16 v[112:115], a[92:95], a[16:19], v[112:115]
  ds_read_b128 a[64:67], v21 offset:10240
  v_mfma_f32_16x16x32_bf16 v[148:151], a[96:99], a[16:19], v[148:151]
  ds_read_b128 a[68:71], v21 offset:12288
  v_mfma_f32_16x16x32_bf16 v[80:83], a[88:91], a[20:23], v[80:83]
  ds_read_b128 a[72:75], v21 offset:14336
  v_mfma_f32_16x16x32_bf16 v[116:119], a[92:95], a[20:23], v[116:119]
  ds_read_b128 a[76:79], v21 offset:16384
  v_mfma_f32_16x16x32_bf16 v[152:155], a[96:99], a[20:23], v[152:155]
  ds_read_b128 a[80:83], v23 offset:0
  v_mfma_f32_16x16x32_bf16 v[84:87], a[88:91], a[24:27], v[84:87]
  ds_read_b128 a[84:87], v23 offset:2048
  v_mfma_f32_16x16x32_bf16 v[120:123], a[92:95], a[24:27], v[120:123]
  v_mfma_f32_16x16x32_bf16 v[156:159], a[96:99], a[24:27], v[156:159]
  v_mfma_f32_16x16x32_bf16 v[88:91], a[88:91], a[28:31], v[88:91]
  v_mfma_f32_16x16x32_bf16 v[124:127], a[92:95], a[28:31], v[124:127]
  v_mfma_f32_16x16x32_bf16 v[160:163], a[96:99], a[28:31], v[160:163]
  v_mfma_f32_16x16x32_bf16 v[92:95], a[88:91], a[32:35], v[92:95]
  v_mfma_f32_16x16x32_bf16 v[128:131], a[92:95], a[32:35], v[128:131]
  v_mfma_f32_16x16x32_bf16 v[164:167], a[96:99], a[32:35], v[164:167]
  v_mfma_f32_16x16x32_bf16 v[168:171], a[100:103], a[36:39], v[168:171]
  v_mfma_f32_16x16x32_bf16 v[172:175], a[100:103], a[40:43], v[172:175]
  s_waitcnt lgkmcnt(0)
  s_barrier
  v_mfma_f32_16x16x32_bf16 v[96:99], a[108:111], a[44:47], v[96:99]
  v_mfma_f32_16x16x32_bf16 v[132:135], a[112:115], a[44:47], v[132:135]
  v_mfma_f32_16x16x32_bf16 v[64:67], a[104:107], a[48:51], v[64:67]
  v_mfma_f32_16x16x32_bf16 v[100:103], a[108:111], a[48:51], v[100:103]
  v_mfma_f32_16x16x32_bf16 v[136:139], a[112:115], a[48:51], v[136:139]
  v_mfma_f32_16x16x32_bf16 v[68:71], a[104:107], a[52:55], v[68:71]
  v_mfma_f32_16x16x32_bf16 v[104:107], a[108:111], a[52:55], v[104:107]
  v_mfma_f32_16x16x32_bf16 v[140:143], a[112:115], a[52:55], v[140:143]
  v_mfma_f32_16x16x32_bf16 v[72:75], a[104:107], a[56:59], v[72:75]
  v_mfma_f32_16x16x32_bf16 v[108:111], a[108:111], a[56:59], v[108:111]
  v_mfma_f32_16x16x32_bf16 v[144:147], a[112:115], a[56:59], v[144:147]
  v_mfma_f32_16x16x32_bf16 v[76:79], a[104:107], a[60:63], v[76:79]
  v_mfma_f32_16x16x32_bf16 v[112:115], a[108:111], a[60:63], v[112:115]
  v_mfma_f32_16x16x32_bf16 v[148:151], a[112:115], a[60:63], v[148:151]
  v_mfma_f32_16x16x32_bf16 v[80:83], a[104:107], a[64:67], v[80:83]
  v_mfma_f32_16x16x32_bf16 v[116:119], a[108:111], a[64:67], v[116:119]
  v_mfma_f32_16x16x32_bf16 v[152:155], a[112:115], a[64:67], v[152:155]
  v_mfma_f32_16x16x32_bf16 v[84:87], a[104:107], a[68:71], v[84:87]
  v_mfma_f32_16x16x32_bf16 v[120:123], a[108:111], a[68:71], v[120:123]
  v_mfma_f32_16x16x32_bf16 v[156:159], a[112:115], a[68:71], v[156:159]
  v_mfma_f32_16x16x32_bf16 v[88:91], a[104:107], a[72:75], v[88:91]
  v_mfma_f32_16x16x32_bf16 v[124:127], a[108:111], a[72:75], v[124:127]
  v_mfma_f32_16x16x32_bf16 v[160:163], a[112:115], a[72:75], v[160:163]
  v_mfma_f32_16x16x32_bf16 v[92:95], a[104:107], a[76:79], v[92:95]
  v_mfma_f32_16x16x32_bf16 v[128:131], a[108:111], a[76:79], v[128:131]
  v_mfma_f32_16x16x32_bf16 v[164:167], a[112:115], a[76:79], v[164:167]
  v_mfma_f32_16x16x32_bf16 v[168:171], a[116:119], a[80:83], v[168:171]
  v_mfma_f32_16x16x32_bf16 v[172:175], a[116:119], a[84:87], v[172:175]
  v_mov_b32 v9, 16
  global_load_dwordx2 v[10:11], v9, s[56:57] sc1
  s_lshl_b32 s33, s22, 18
  s_add_u32 s60, s46, s33
  s_addc_u32 s61, s47, 0
  s_and_b32 s61, s61, 0xffff
  s_mov_b32 s62, 262144
  s_mov_b32 s63, 0x20000
  v_lshrrev_b32 v16, 3, v12
  v_and_b32 v17, 7, v12
  v_and_b32 v18, 3, v16
  v_xor_b32 v17, v17, v18
  v_lshlrev_b32 v17, 4, v17
  v_lshl_add_u32 v17, v16, 12, v17
  v_mov_b32 v232, v17
  v_xor_b32 v233, 64, v17
  v_add_u32 v233, 31744, v233
  v_mov_b32 v234, v17
  v_add_u32 v234, 63488, v234
  v_xor_b32 v235, 64, v17
  v_add_u32 v235, 95232, v235
  v_lshrrev_b32 v16, 2, v13
  v_lshlrev_b32 v16, 3, v16
  v_and_b32 v17, 3, v13
  v_add_u32 v16, v16, v17
  v_and_b32 v17, 7, v13
  v_xor_b32 v17, v17, v14
  v_lshlrev_b32 v17, 4, v17
  v_lshl_add_u32 v240, v16, 7, v17
  s_lshr_b32 s33, s3, 1
  s_lshl_b32 s68, s33, 17
  s_lshl_b32 s33, s3, 10
  s_add_u32 s68, s68, s33
  s_xor_b32 s69, s68, 0x20000
  s_mul_i32 s74, s3, 24576
  s_add_u32 s74, s74, 58368
  s_and_b32 s33, s3, 1
  s_lshl_b32 s33, s33, 9
  s_add_u32 s33, s33, s74
  v_add_u32 v236, s33, v240
  v_xor_b32 v237, 64, v236
  s_xor_b32 s33, s33, 512
  v_add_u32 v238, s33, v240
  v_xor_b32 v239, 64, v238
  s_mul_i32 s75, s3, 14336
  s_add_u32 s75, s75, 0
  s_and_b32 s33, s3, 1
  s_lshl_b32 s33, s33, 9
  s_add_u32 s33, s33, s75
  v_add_u32 v241, s33, v240
  v_xor_b32 v242, 64, v241
  s_xor_b32 s33, s33, 512
  v_add_u32 v243, s33, v240
  v_xor_b32 v244, 64, v243
  v_mul_u32_u24 v15, 400, v13
  s_lshr_b32 s23, s3, 1
  s_lshl_b32 s23, s23, 6
  s_and_b32 s33, s3, 1
  s_lshl_b32 s33, s33, 5
  s_add_u32 s23, s23, s33
  v_lshl_add_u32 v15, v14, 3, v15
  v_add_u32 v26, s23, v15
  v_cvt_pk_bf16_f32 v176, v64, v65
  v_cvt_pk_bf16_f32 v177, v66, v67
  ds_write_b64 v26, v[176:177] offset:6400
  v_cvt_pk_bf16_f32 v178, v68, v69
  s_add_u32 m0, s74, 0
  s_add_u32 s70, s68, 0
  buffer_load_dwordx4 v232, s[60:63], s70 offen offset:0 lds
  v_cvt_pk_bf16_f32 v179, v70, v71
  ds_write_b64 v26, v[178:179] offset:12800
  v_cvt_pk_bf16_f32 v180, v72, v73
  v_cvt_pk_bf16_f32 v181, v74, v75
  ds_write_b64 v26, v[180:181] offset:19200
  v_cvt_pk_bf16_f32 v182, v76, v77
  v_cvt_pk_bf16_f32 v183, v78, v79
  ds_write_b64 v26, v[182:183] offset:25600
  v_cvt_pk_bf16_f32 v184, v80, v81
  buffer_load_dwordx4 v233, s[60:63], s70 offen offset:1024 lds
  v_cvt_pk_bf16_f32 v185, v82, v83
  ds_write_b64 v26, v[184:185] offset:32000
  v_cvt_pk_bf16_f32 v186, v84, v85
  v_cvt_pk_bf16_f32 v187, v86, v87
  ds_write_b64 v26, v[186:187] offset:38400
  v_cvt_pk_bf16_f32 v188, v88, v89
  v_cvt_pk_bf16_f32 v189, v90, v91
  ds_write_b64 v26, v[188:189] offset:44800
  v_cvt_pk_bf16_f32 v190, v92, v93
  buffer_load_dwordx4 v234, s[60:63], s70 offen offset:2048 lds
  v_cvt_pk_bf16_f32 v191, v94, v95
  ds_write_b64 v26, v[190:191] offset:51200
  v_cvt_pk_bf16_f32 v176, v96, v97
  v_cvt_pk_bf16_f32 v177, v98, v99
  ds_write_b64 v26, v[176:177] offset:128
  v_cvt_pk_bf16_f32 v178, v100, v101
  v_cvt_pk_bf16_f32 v179, v102, v103
  ds_write_b64 v26, v[178:179] offset:6528
  v_cvt_pk_bf16_f32 v180, v104, v105
  buffer_load_dwordx4 v235, s[60:63], s70 offen offset:3072 lds
  v_cvt_pk_bf16_f32 v181, v106, v107
  ds_write_b64 v26, v[180:181] offset:12928
  v_cvt_pk_bf16_f32 v182, v108, v109
  v_cvt_pk_bf16_f32 v183, v110, v111
  ds_write_b64 v26, v[182:183] offset:19328
  v_cvt_pk_bf16_f32 v184, v112, v113
  v_cvt_pk_bf16_f32 v185, v114, v115
  ds_write_b64 v26, v[184:185] offset:25728
  v_cvt_pk_bf16_f32 v186, v116, v117
  s_add_u32 m0, s74, 4096
  s_add_u32 s70, s69, 0
  buffer_load_dwordx4 v232, s[60:63], s70 offen offset:0 lds
  v_cvt_pk_bf16_f32 v187, v118, v119
  ds_write_b64 v26, v[186:187] offset:32128
  v_cvt_pk_bf16_f32 v188, v120, v121
  v_cvt_pk_bf16_f32 v189, v122, v123
  ds_write_b64 v26, v[188:189] offset:38528
  v_cvt_pk_bf16_f32 v190, v124, v125
  v_cvt_pk_bf16_f32 v191, v126, v127
  ds_write_b64 v26, v[190:191] offset:44928
  v_cvt_pk_bf16_f32 v176, v128, v129
  buffer_load_dwordx4 v233, s[60:63], s70 offen offset:1024 lds
  v_cvt_pk_bf16_f32 v177, v130, v131
  ds_write_b64 v26, v[176:177] offset:51328
  v_cvt_pk_bf16_f32 v178, v132, v133
  v_cvt_pk_bf16_f32 v179, v134, v135
  ds_write_b64 v26, v[178:179] offset:256
  v_cvt_pk_bf16_f32 v180, v136, v137
  v_cvt_pk_bf16_f32 v181, v138, v139
  ds_write_b64 v26, v[180:181] offset:6656
  v_cvt_pk_bf16_f32 v182, v140, v141
  buffer_load_dwordx4 v234, s[60:63], s70 offen offset:2048 lds
  v_cvt_pk_bf16_f32 v183, v142, v143
  ds_write_b64 v26, v[182:183] offset:13056
  v_cvt_pk_bf16_f32 v184, v144, v145
  v_cvt_pk_bf16_f32 v185, v146, v147
  ds_write_b64 v26, v[184:185] offset:19456
  v_cvt_pk_bf16_f32 v186, v148, v149
  v_cvt_pk_bf16_f32 v187, v150, v151
  ds_write_b64 v26, v[186:187] offset:25856
  v_cvt_pk_bf16_f32 v188, v152, v153
  buffer_load_dwordx4 v235, s[60:63], s70 offen offset:3072 lds
  v_cvt_pk_bf16_f32 v189, v154, v155
  ds_write_b64 v26, v[188:189] offset:32256
  v_cvt_pk_bf16_f32 v190, v156, v157
  v_cvt_pk_bf16_f32 v191, v158, v159
  ds_write_b64 v26, v[190:191] offset:38656
  v_cvt_pk_bf16_f32 v176, v160, v161
  v_cvt_pk_bf16_f32 v177, v162, v163
  ds_write_b64 v26, v[176:177] offset:45056
  v_cvt_pk_bf16_f32 v178, v164, v165
  s_add_u32 m0, s74, 8192
  s_add_u32 s70, s68, 128
  buffer_load_dwordx4 v232, s[60:63], s70 offen offset:0 lds
  v_cvt_pk_bf16_f32 v179, v166, v167
  ds_write_b64 v26, v[178:179] offset:51456
  v_mul_f32 v168, 0xbfb8aa3b, v168
  v_exp_f32 v168, v168
  s_nop 0
  v_add_f32 v168, 1.0, v168
  v_rcp_f32 v168, v168
  v_mul_f32 v172, 0xbfb8aa3b, v172
  buffer_load_dwordx4 v233, s[60:63], s70 offen offset:1024 lds
  v_exp_f32 v172, v172
  s_nop 0
  v_add_f32 v172, 1.0, v172
  v_rcp_f32 v172, v172
  s_lshl_b32 s23, s3, 7
  s_add_u32 s23, s23, 160768
  v_lshlrev_b32 v15, 2, v13
  v_add_u32 v16, s23, v15
  s_mov_b64 s[34:35], exec
  s_mov_b64 exec, 0xffff
  ds_write_b32 v16, v168 offset:0
  ds_write_b32 v16, v172 offset:64
  s_mov_b32 s23, 14368768
  s_add_u32 s16, s58, s23
  s_addc_u32 s17, s59, 0
  s_and_b32 s17, s17, 0xffff
  s_mov_b32 s18, 8192
  s_mov_b32 s19, 0x20000
  s_cmp_eq_u32 s21, 0
  s_cselect_b32 s18, s18, 0
  s_lshl_b32 s23, s20, 9
  s_lshl_b32 s33, s3, 7
  s_add_u32 s23, s23, s33
  buffer_store_dword v168, v15, s[16:19], s23 offen offset:0 sc1
  buffer_store_dword v172, v15, s[16:19], s23 offen offset:64 sc1
  s_mov_b64 exec, s[34:35]
  s_waitcnt lgkmcnt(0)
  s_barrier
  s_lshr_b32 s33, s3, 1
  s_and_b32 s34, s3, 1
  s_lshl_b32 s35, s33, 6
  s_mul_i32 s32, s34, 25600
  s_add_u32 s35, s35, s32
  v_lshlrev_b32 v15, 1, v13
  buffer_load_dwordx4 v234, s[60:63], s70 offen offset:2048 lds
  v_mul_u32_u24 v16, 400, v15
  v_lshl_add_u32 v16, v14, 4, v16
  v_add_u32 v16, s35, v16
  v_add_u32 v20, 6400, v16
  v_add_u32 v21, 128, v16
  v_lshlrev_b32 v17, 2, v15
  buffer_load_dwordx4 v235, s[60:63], s70 offen offset:3072 lds
  s_lshl_b32 s32, s34, 8
  s_add_u32 s32, s32, 160768
  v_add_u32 v22, s32, v17
  v_lshrrev_b32 v17, 2, v13
  v_and_b32 v18, 3, v13
  v_lshlrev_b32 v18, 3, v18
  v_add_u32 v18, s35, v18
  v_add_u32 v18, 256, v18
  s_add_u32 m0, s74, 12288
  s_add_u32 s70, s69, 128
  buffer_load_dwordx4 v232, s[60:63], s70 offen offset:0 lds
  v_lshl_add_u32 v19, v14, 2, v17
  v_lshlrev_b32 v19, 1, v19
  v_mul_u32_u24 v19, 400, v19
  v_add_u32 v23, v19, v18
  v_and_b32 v19, 1, v14
  v_lshl_add_u32 v19, v19, 2, v17
  buffer_load_dwordx4 v233, s[60:63], s70 offen offset:1024 lds
  v_add_u32 v19, 16, v19
  v_lshlrev_b32 v19, 1, v19
  v_mul_u32_u24 v19, 400, v19
  v_add_u32 v24, v19, v18
  ds_read_b128 v[64:67], v20 offset:0
  ds_read_b128 v[68:71], v21 offset:0
  ds_read_b128 v[72:75], v21 offset:12800
  ds_read_b128 v[88:91], v20 offset:400
  ds_read_b128 v[92:95], v21 offset:400
  ds_read_b128 v[96:99], v21 offset:13200
  ds_read_b128 v[112:115], v20 offset:12800
  ds_read_b128 v[116:119], v21 offset:12800
  ds_read_b128 v[120:123], v21 offset:25600
  ds_read_b128 v[136:139], v20 offset:13200
  ds_read_b128 v[140:143], v21 offset:13200
  ds_read_b128 v[144:147], v21 offset:26000
  ds_read_b64_tr_b16 v[76:77], v23 offset:0
  ds_read_b64_tr_b16 v[78:79], v24 offset:0
  ds_read_b64_tr_b16 v[80:81], v23 offset:32
  ds_read_b64_tr_b16 v[82:83], v24 offset:32
  ds_read_b32 v84, v22 offset:0
  ds_read_b64_tr_b16 v[100:101], v23 offset:400
  ds_read_b64_tr_b16 v[102:103], v24 offset:400
  ds_read_b64_tr_b16 v[104:105], v23 offset:432
  ds_read_b64_tr_b16 v[106:107], v24 offset:432
  ds_read_b32 v108, v22 offset:4
  ds_read_b64_tr_b16 v[124:125], v23 offset:12800
  ds_read_b64_tr_b16 v[126:127], v24 offset:12800
  ds_read_b64_tr_b16 v[128:129], v23 offset:12832
  ds_read_b64_tr_b16 v[130:131], v24 offset:12832
  ds_read_b32 v132, v22 offset:128
  ds_read_b64_tr_b16 v[148:149], v23 offset:13200
  ds_read_b64_tr_b16 v[150:151], v24 offset:13200
  ds_read_b64_tr_b16 v[152:153], v23 offset:13232
  ds_read_b64_tr_b16 v[154:155], v24 offset:13232
  ds_read_b32 v156, v22 offset:132
  s_waitcnt lgkmcnt(15)
  v_mfma_f32_16x16x32_bf16 v[160:163], v[68:71], v[64:67], 0
  v_mfma_f32_16x16x32_bf16 v[164:167], v[72:75], v[64:67], 0
  buffer_load_dwordx4 v234, s[60:63], s70 offen offset:2048 lds
  v_mfma_f32_16x16x32_bf16 v[168:171], v[92:95], v[88:91], 0
  v_mfma_f32_16x16x32_bf16 v[172:175], v[96:99], v[88:91], 0
  v_mfma_f32_16x16x32_bf16 v[176:179], v[116:119], v[112:115], 0
  v_mfma_f32_16x16x32_bf16 v[180:183], v[120:123], v[112:115], 0
  v_mfma_f32_16x16x32_bf16 v[184:187], v[140:143], v[136:139], 0
  v_mfma_f32_16x16x32_bf16 v[188:191], v[144:147], v[136:139], 0
  buffer_load_dwordx4 v235, s[60:63], s70 offen offset:3072 lds
  s_waitcnt lgkmcnt(0)
  s_barrier
  s_add_u32 m0, s74, 16384
  s_add_u32 s70, s68, 256
  buffer_load_dwordx4 v232, s[60:63], s70 offen offset:0 lds
  buffer_load_dwordx4 v233, s[60:63], s70 offen offset:1024 lds
  buffer_load_dwordx4 v234, s[60:63], s70 offen offset:2048 lds
  buffer_load_dwordx4 v235, s[60:63], s70 offen offset:3072 lds
  s_add_u32 m0, s74, 20480
  s_add_u32 s70, s69, 256
  buffer_load_dwordx4 v232, s[60:63], s70 offen offset:0 lds
  buffer_load_dwordx4 v233, s[60:63], s70 offen offset:1024 lds
  buffer_load_dwordx4 v234, s[60:63], s70 offen offset:2048 lds
  buffer_load_dwordx4 v235, s[60:63], s70 offen offset:3072 lds
  s_waitcnt vmcnt(0)
  ds_read_b128 a[0:3], v236 offset:0
  ds_read_b128 a[16:19], v237 offset:0
  ds_read_b128 a[4:7], v238 offset:0
  ds_read_b128 a[20:23], v239 offset:0
  ds_read_b128 a[8:11], v236 offset:4096
  ds_read_b128 a[24:27], v237 offset:4096
  ds_read_b128 a[12:15], v238 offset:4096
  ds_read_b128 a[28:31], v239 offset:4096
  ds_read_b128 a[32:35], v236 offset:8192
  ds_read_b128 a[48:51], v237 offset:8192
  ds_read_b128 a[36:39], v238 offset:8192
  ds_read_b128 a[52:55], v239 offset:8192
  ds_read_b128 a[40:43], v236 offset:12288
  ds_read_b128 a[56:59], v237 offset:12288
  ds_read_b128 a[44:47], v238 offset:12288
  ds_read_b128 a[60:63], v239 offset:12288
  ds_read_b128 a[64:67], v236 offset:16384
  ds_read_b128 a[80:83], v237 offset:16384
  ds_read_b128 a[68:71], v238 offset:16384
  ds_read_b128 a[84:87], v239 offset:16384
  ds_read_b128 a[72:75], v236 offset:20480
  ds_read_b128 a[88:91], v237 offset:20480
  ds_read_b128 a[76:79], v238 offset:20480
  ds_read_b128 a[92:95], v239 offset:20480
  s_lshl_b32 s23, s20, 3
  s_add_u32 s23, s23, s21
  s_lshl_b32 s23, s23, 2
  s_add_u32 s23, s23, s3
  s_min_u32 s24, s23, 307
  s_mul_i32 s26, s24, 1490
  s_lshr_b32 s26, s26, 16
  s_mul_i32 s27, s26, 44
  s_sub_u32 s27, s24, s27
  s_mul_i32 s28, s27, 28
  s_mul_i32 s29, s27, 32
  s_sub_u32 s29, s29, 512
  s_cmp_lt_u32 s27, 16
  s_cselect_b32 s28, s28, s29
  s_cselect_b32 s8, s40, s50
  s_cselect_b32 s9, s41, s51
  s_cselect_b32 s29, 28, 32
  s_and_b32 s9, s9, 0xffff
  s_add_u32 s29, s29, s28
  s_mul_i32 s10, s29, 896
  s_mov_b32 s11, 0x20000
  s_mul_i32 s28, s28, 896
  s_lshl_b32 s26, s26, 7
  s_add_u32 s13, s28, s26
  s_lshl_b32 s14, s23, 12
  s_cmp_ge_u32 s23, 308
  s_cselect_b32 s10, 0, s10
  s_add_u32 s12, s75, 8192
  v_lshrrev_b32 v16, 3, v12
  v_and_b32 v17, 7, v12
  v_bfe_u32 v18, v16, 1, 1
  v_lshlrev_b32 v18, 2, v18
  v_xor_b32 v17, v17, v18
  v_mul_u32_u24 v16, 896, v16
  v_lshl_add_u32 v40, v17, 4, v16
  v_add_u32 v41, 6144, v40
  v_add_u32 v42, 12288, v40
  v_add_u32 v43, 18432, v40
  v_lshrrev_b32 v16, 2, v13
  v_lshl_add_u32 v16, v14, 2, v16
  v_lshlrev_b32 v16, 7, v16
  v_and_b32 v17, 3, v13
  v_bfe_u32 v18, v13, 3, 1
  v_lshlrev_b32 v18, 2, v18
  v_xor_b32 v17, v17, v18
  v_lshl_add_u32 v16, v17, 4, v16
  v_add_u32 v44, s12, v16
  v_xor_b32 v45, 64, v44
  s_waitcnt lgkmcnt(0)
  v_mov_b32 v26, 0x3e8b97f6
  v_mov_b32 v27, 0x3e8b97f6
  v_mov_b32 v28, 0xf149f2ca
  v_pk_mul_f32 v[160:161], v[160:161], v[26:27]
  v_pk_mul_f32 v[162:163], v[162:163], v[26:27]
  v_pk_mul_f32 v[164:165], v[164:165], v[26:27]
  v_pk_mul_f32 v[166:167], v[166:167], v[26:27]
  s_add_u32 m0, s75, 0
  s_add_u32 s70, s68, 384
  buffer_load_dwordx4 v232, s[60:63], s70 offen offset:0 lds
  v_pk_mul_f32 v[168:169], v[168:169], v[26:27]
  v_pk_mul_f32 v[170:171], v[170:171], v[26:27]
  v_pk_mul_f32 v[172:173], v[172:173], v[26:27]
  v_pk_mul_f32 v[174:175], v[174:175], v[26:27]
  v_pk_mul_f32 v[176:177], v[176:177], v[26:27]
  v_pk_mul_f32 v[178:179], v[178:179], v[26:27]
  v_pk_mul_f32 v[180:181], v[180:181], v[26:27]
  buffer_load_dwordx4 v233, s[60:63], s70 offen offset:1024 lds
  v_pk_mul_f32 v[182:183], v[182:183], v[26:27]
  v_pk_mul_f32 v[184:185], v[184:185], v[26:27]
  v_pk_mul_f32 v[186:187], v[186:187], v[26:27]
  v_pk_mul_f32 v[188:189], v[188:189], v[26:27]
  v_pk_mul_f32 v[190:191], v[190:191], v[26:27]
  v_lshlrev_b32 v15, 2, v14
  v_sub_u32 v15, v13, v15
  buffer_load_dwordx4 v234, s[60:63], s70 offen offset:2048 lds
  v_add_u32 v15, 8, v15
  s_and_b32 s34, s3, 1
  s_or_b32 s34, s34, s20
  v_min_u32 v16, 7, v13
  s_cmp_eq_u32 s34, 0
  s_cselect_b64 s[34:35], -1, 0
  v_mov_b32 v17, 7
  v_cndmask_b32 v16, v17, v16, s[34:35]
  v_subrev_u32 v18, 0, v15
  v_cmp_le_u32 s[24:25], v18, v17
  v_subrev_u32 v18, 1, v15
  buffer_load_dwordx4 v235, s[60:63], s70 offen offset:3072 lds
  v_cmp_le_u32 s[26:27], v18, v17
  v_subrev_u32 v18, 2, v15
  v_cmp_le_u32 s[28:29], v18, v17
  v_subrev_u32 v18, 3, v15
  v_cmp_le_u32 s[30:31], v18, v17
  v_subrev_u32 v18, 16, v15
  v_cmp_le_u32 s[64:65], v18, v17
  s_add_u32 m0, s75, 4096
  s_add_u32 s70, s69, 384
  buffer_load_dwordx4 v232, s[60:63], s70 offen offset:0 lds
  v_subrev_u32 v18, 17, v15
  v_cmp_le_u32 s[66:67], v18, v17
  v_subrev_u32 v18, 18, v15
  v_cmp_le_u32 s[32:33], v18, v17
  v_subrev_u32 v18, 19, v15
  v_cmp_le_u32 s[34:35], v18, v17
  v_cndmask_b32 v176, v28, v176, s[24:25]
  buffer_load_dwordx4 v233, s[60:63], s70 offen offset:1024 lds
  v_cndmask_b32 v177, v28, v177, s[26:27]
  v_cndmask_b32 v178, v28, v178, s[28:29]
  v_cndmask_b32 v179, v28, v179, s[30:31]
  v_cndmask_b32 v180, v28, v180, s[64:65]
  v_cndmask_b32 v181, v28, v181, s[66:67]
  v_cndmask_b32 v182, v28, v182, s[32:33]
  v_cndmask_b32 v183, v28, v183, s[34:35]
  buffer_load_dwordx4 v234, s[60:63], s70 offen offset:2048 lds
  v_cndmask_b32 v184, v28, v184, s[24:25]
  v_cndmask_b32 v185, v28, v185, s[26:27]
  v_cndmask_b32 v186, v28, v186, s[28:29]
  v_cndmask_b32 v187, v28, v187, s[30:31]
  v_cndmask_b32 v188, v28, v188, s[64:65]
  v_cndmask_b32 v189, v28, v189, s[66:67]
  v_cndmask_b32 v190, v28, v190, s[32:33]
  buffer_load_dwordx4 v235, s[60:63], s70 offen offset:3072 lds
  v_cndmask_b32 v191, v28, v191, s[34:35]
  v_subrev_u32 v18, 0, v15
  v_cmp_le_u32 s[24:25], v18, v16
  v_subrev_u32 v18, 1, v15
  v_cmp_le_u32 s[26:27], v18, v16
  v_subrev_u32 v18, 2, v15
  v_cmp_le_u32 s[28:29], v18, v16
  s_mov_b32 m0, s12
  s_nop 0
  buffer_load_dwordx4 v40, s[8:11], s13 offen offset:0 lds
  v_subrev_u32 v18, 3, v15
  v_cmp_le_u32 s[30:31], v18, v16
  v_subrev_u32 v18, 16, v15
  v_cmp_le_u32 s[64:65], v18, v16
  v_subrev_u32 v18, 17, v15
  v_cmp_le_u32 s[66:67], v18, v16
  v_subrev_u32 v18, 18, v15
  buffer_load_dwordx4 v41, s[8:11], s13 offen offset:1024 lds
  v_cmp_le_u32 s[32:33], v18, v16
  v_subrev_u32 v18, 19, v15
  v_cmp_le_u32 s[34:35], v18, v16
  v_cndmask_b32 v160, v28, v160, s[24:25]
  v_cndmask_b32 v161, v28, v161, s[26:27]
  v_cndmask_b32 v162, v28, v162, s[28:29]
  v_cndmask_b32 v163, v28, v163, s[30:31]
  buffer_load_dwordx4 v42, s[8:11], s13 offen offset:2048 lds
  v_cndmask_b32 v164, v28, v164, s[64:65]
  v_cndmask_b32 v165, v28, v165, s[66:67]
  v_cndmask_b32 v166, v28, v166, s[32:33]
  v_cndmask_b32 v167, v28, v167, s[34:35]
  v_cndmask_b32 v168, v28, v168, s[24:25]
  v_cndmask_b32 v169, v28, v169, s[26:27]
  v_cndmask_b32 v170, v28, v170, s[28:29]
  buffer_load_dwordx4 v43, s[8:11], s13 offen offset:3072 lds
  v_cndmask_b32 v171, v28, v171, s[30:31]
  v_cndmask_b32 v172, v28, v172, s[64:65]
  v_cndmask_b32 v173, v28, v173, s[66:67]
  v_cndmask_b32 v174, v28, v174, s[32:33]
  v_cndmask_b32 v175, v28, v175, s[34:35]
  v_max3_f32 v192, v160, v161, v162
  v_max3_f32 v193, v168, v169, v170
  s_add_u32 m0, s74, 0
  s_add_u32 s70, s68, 512
  buffer_load_dwordx4 v232, s[60:63], s70 offen offset:0 lds
  v_max3_f32 v194, v176, v177, v178
  v_max3_f32 v195, v184, v185, v186
  v_max3_f32 v192, v192, v163, v164
  v_max3_f32 v193, v193, v171, v172
  v_max3_f32 v194, v194, v179, v180
  v_max3_f32 v195, v195, v187, v188
  v_max3_f32 v192, v192, v165, v166
  buffer_load_dwordx4 v233, s[60:63], s70 offen offset:1024 lds
  v_max3_f32 v193, v193, v173, v174
  v_max3_f32 v194, v194, v181, v182
  v_max3_f32 v195, v195, v189, v190
  v_max_f32 v192, v192, v167
  v_max_f32 v193, v193, v175
  v_max_f32 v194, v194, v183
  v_max_f32 v195, v195, v191
  buffer_load_dwordx4 v234, s[60:63], s70 offen offset:2048 lds
  v_mov_b32 v196, v192
  v_mov_b32 v197, v193
  v_mov_b32 v198, v194
  v_mov_b32 v199, v195
  v_permlane16_swap_b32 v192, v196
  v_permlane16_swap_b32 v193, v197
  v_permlane16_swap_b32 v194, v198
  buffer_load_dwordx4 v235, s[60:63], s70 offen offset:3072 lds
  v_permlane16_swap_b32 v195, v199
  v_max_f32 v192, v192, v196
  v_max_f32 v193, v193, v197
  v_max_f32 v194, v194, v198
  v_max_f32 v195, v195, v199
  v_mov_b32 v196, v192
  v_mov_b32 v197, v193
  s_add_u32 m0, s74, 4096
  s_add_u32 s70, s69, 512
  buffer_load_dwordx4 v232, s[60:63], s70 offen offset:0 lds
  v_mov_b32 v198, v194
  v_mov_b32 v199, v195
  v_permlane32_swap_b32 v192, v196
  v_permlane32_swap_b32 v193, v197
  v_permlane32_swap_b32 v194, v198
  v_permlane32_swap_b32 v195, v199
  v_max_f32 v192, v192, v196
  buffer_load_dwordx4 v233, s[60:63], s70 offen offset:1024 lds
  v_max_f32 v193, v193, v197
  v_max_f32 v194, v194, v198
  v_max_f32 v195, v195, v199
  v_sub_f32 v160, v160, v192
  v_sub_f32 v161, v161, v192
  v_sub_f32 v162, v162, v192
  v_sub_f32 v163, v163, v192
  buffer_load_dwordx4 v234, s[60:63], s70 offen offset:2048 lds
  v_sub_f32 v164, v164, v192
  v_sub_f32 v165, v165, v192
  v_sub_f32 v166, v166, v192
  v_sub_f32 v167, v167, v192
  v_sub_f32 v168, v168, v193
  v_sub_f32 v169, v169, v193
  v_sub_f32 v170, v170, v193
  buffer_load_dwordx4 v235, s[60:63], s70 offen offset:3072 lds
  v_sub_f32 v171, v171, v193
  v_sub_f32 v172, v172, v193
  v_sub_f32 v173, v173, v193
  v_sub_f32 v174, v174, v193
  v_sub_f32 v175, v175, v193
  v_sub_f32 v176, v176, v194
  v_sub_f32 v177, v177, v194
  s_add_u32 m0, s74, 8192
  s_add_u32 s70, s68, 640
  buffer_load_dwordx4 v232, s[60:63], s70 offen offset:0 lds
  v_sub_f32 v178, v178, v194
  v_sub_f32 v179, v179, v194
  v_sub_f32 v180, v180, v194
  v_sub_f32 v181, v181, v194
  v_sub_f32 v182, v182, v194
  v_sub_f32 v183, v183, v194
  v_sub_f32 v184, v184, v195
  buffer_load_dwordx4 v233, s[60:63], s70 offen offset:1024 lds
  v_sub_f32 v185, v185, v195
  v_sub_f32 v186, v186, v195
  v_sub_f32 v187, v187, v195
  v_sub_f32 v188, v188, v195
  v_sub_f32 v189, v189, v195
  v_sub_f32 v190, v190, v195
  v_sub_f32 v191, v191, v195
  buffer_load_dwordx4 v234, s[60:63], s70 offen offset:2048 lds
  v_exp_f32 v160, v160
  v_exp_f32 v161, v161
  v_exp_f32 v162, v162
  v_exp_f32 v163, v163
  v_exp_f32 v164, v164
  v_exp_f32 v165, v165
  v_exp_f32 v166, v166
  buffer_load_dwordx4 v235, s[60:63], s70 offen offset:3072 lds
  v_exp_f32 v167, v167
  v_exp_f32 v168, v168
  v_exp_f32 v169, v169
  v_exp_f32 v170, v170
  v_exp_f32 v171, v171
  v_exp_f32 v172, v172
  v_exp_f32 v173, v173
  s_add_u32 m0, s74, 12288
  s_add_u32 s70, s69, 640
  buffer_load_dwordx4 v232, s[60:63], s70 offen offset:0 lds
  v_exp_f32 v174, v174
  v_exp_f32 v175, v175
  v_exp_f32 v176, v176
  v_exp_f32 v177, v177
  v_exp_f32 v178, v178
  v_exp_f32 v179, v179
  v_exp_f32 v180, v180
  buffer_load_dwordx4 v233, s[60:63], s70 offen offset:1024 lds
  v_exp_f32 v181, v181
  v_exp_f32 v182, v182
  v_exp_f32 v183, v183
  v_exp_f32 v184, v184
  v_exp_f32 v185, v185
  v_exp_f32 v186, v186
  v_exp_f32 v187, v187
  buffer_load_dwordx4 v234, s[60:63], s70 offen offset:2048 lds
  v_exp_f32 v188, v188
  v_exp_f32 v189, v189
  v_exp_f32 v190, v190
  v_exp_f32 v191, v191
  v_add_f32 v192, v160, v161
  v_add_f32 v193, v168, v169
  v_add_f32 v194, v176, v177
  buffer_load_dwordx4 v235, s[60:63], s70 offen offset:3072 lds
  v_add_f32 v195, v184, v185
  v_add_f32 v192, v192, v162
  v_add_f32 v193, v193, v170
  v_add_f32 v194, v194, v178
  v_add_f32 v195, v195, v186
  v_add_f32 v192, v192, v163
  v_add_f32 v193, v193, v171
  s_add_u32 m0, s74, 16384
  s_add_u32 s70, s68, 768
  buffer_load_dwordx4 v232, s[60:63], s70 offen offset:0 lds
  v_add_f32 v194, v194, v179
  v_add_f32 v195, v195, v187
  v_add_f32 v192, v192, v164
  v_add_f32 v193, v193, v172
  v_add_f32 v194, v194, v180
  v_add_f32 v195, v195, v188
  v_add_f32 v192, v192, v165
  buffer_load_dwordx4 v233, s[60:63], s70 offen offset:1024 lds
  v_add_f32 v193, v193, v173
  v_add_f32 v194, v194, v181
  v_add_f32 v195, v195, v189
  v_add_f32 v192, v192, v166
  v_add_f32 v193, v193, v174
  v_add_f32 v194, v194, v182
  v_add_f32 v195, v195, v190
  buffer_load_dwordx4 v234, s[60:63], s70 offen offset:2048 lds
  v_add_f32 v192, v192, v167
  v_add_f32 v193, v193, v175
  v_add_f32 v194, v194, v183
  v_add_f32 v195, v195, v191
  v_mov_b32 v196, v192
  v_mov_b32 v197, v193
  v_mov_b32 v198, v194
  buffer_load_dwordx4 v235, s[60:63], s70 offen offset:3072 lds
  v_mov_b32 v199, v195
  v_permlane16_swap_b32 v192, v196
  v_permlane16_swap_b32 v193, v197
  v_permlane16_swap_b32 v194, v198
  v_permlane16_swap_b32 v195, v199
  v_add_f32 v192, v192, v196
  v_add_f32 v193, v193, v197
  s_add_u32 m0, s74, 20480
  s_add_u32 s70, s69, 768
  buffer_load_dwordx4 v232, s[60:63], s70 offen offset:0 lds
  v_add_f32 v194, v194, v198
  v_add_f32 v195, v195, v199
  v_mov_b32 v196, v192
  v_mov_b32 v197, v193
  v_mov_b32 v198, v194
  v_mov_b32 v199, v195
  v_permlane32_swap_b32 v192, v196
  buffer_load_dwordx4 v233, s[60:63], s70 offen offset:1024 lds
  v_permlane32_swap_b32 v193, v197
  v_permlane32_swap_b32 v194, v198
  v_permlane32_swap_b32 v195, v199
  v_add_f32 v192, v192, v196
  v_add_f32 v193, v193, v197
  v_add_f32 v194, v194, v198
  v_add_f32 v195, v195, v199
  buffer_load_dwordx4 v234, s[60:63], s70 offen offset:2048 lds
  v_rcp_f32 v192, v192
  v_rcp_f32 v193, v193
  v_rcp_f32 v194, v194
  v_rcp_f32 v195, v195
  v_mul_f32 v160, v160, v192
  v_mul_f32 v161, v161, v192
  v_mul_f32 v162, v162, v192
  buffer_load_dwordx4 v235, s[60:63], s70 offen offset:3072 lds
  v_mul_f32 v163, v163, v192
  v_mul_f32 v164, v164, v192
  v_mul_f32 v165, v165, v192
  v_mul_f32 v166, v166, v192
  v_mul_f32 v167, v167, v192
  v_mul_f32 v168, v168, v193
  v_mul_f32 v169, v169, v193
  v_mul_f32 v170, v170, v193
  v_mul_f32 v171, v171, v193
  v_mul_f32 v172, v172, v193
  v_mul_f32 v173, v173, v193
  v_mul_f32 v174, v174, v193
  v_mul_f32 v175, v175, v193
  v_mul_f32 v176, v176, v194
  v_mul_f32 v177, v177, v194
  v_mul_f32 v178, v178, v194
  v_mul_f32 v179, v179, v194
  v_mul_f32 v180, v180, v194
  v_mul_f32 v181, v181, v194
  v_mul_f32 v182, v182, v194
  v_mul_f32 v183, v183, v194
  v_mul_f32 v184, v184, v195
  v_mul_f32 v185, v185, v195
  v_mul_f32 v186, v186, v195
  v_mul_f32 v187, v187, v195
  v_mul_f32 v188, v188, v195
  v_mul_f32 v189, v189, v195
  v_mul_f32 v190, v190, v195
  v_mul_f32 v191, v191, v195
  v_cvt_pk_bf16_f32 v200, v160, v161
  v_cvt_pk_bf16_f32 v201, v162, v163
  v_cvt_pk_bf16_f32 v202, v164, v165
  v_cvt_pk_bf16_f32 v203, v166, v167
  v_cvt_pk_bf16_f32 v204, v168, v169
  v_cvt_pk_bf16_f32 v205, v170, v171
  v_cvt_pk_bf16_f32 v206, v172, v173
  v_cvt_pk_bf16_f32 v207, v174, v175
  v_cvt_pk_bf16_f32 v208, v176, v177
  v_cvt_pk_bf16_f32 v209, v178, v179
  v_cvt_pk_bf16_f32 v210, v180, v181
  v_cvt_pk_bf16_f32 v211, v182, v183
  v_cvt_pk_bf16_f32 v212, v184, v185
  v_cvt_pk_bf16_f32 v213, v186, v187
  v_cvt_pk_bf16_f32 v214, v188, v189
  v_cvt_pk_bf16_f32 v215, v190, v191
  v_mfma_f32_16x16x32_bf16 v[160:163], v[76:79], v[200:203], 0
  v_mfma_f32_16x16x32_bf16 v[164:167], v[80:83], v[200:203], 0
  v_mfma_f32_16x16x32_bf16 v[168:171], v[100:103], v[204:207], 0
  v_mfma_f32_16x16x32_bf16 v[172:175], v[104:107], v[204:207], 0
  v_mfma_f32_16x16x32_bf16 v[176:179], v[124:127], v[208:211], 0
  v_mfma_f32_16x16x32_bf16 v[180:183], v[128:131], v[208:211], 0
  v_mfma_f32_16x16x32_bf16 v[184:187], v[148:151], v[212:215], 0
  v_mfma_f32_16x16x32_bf16 v[188:191], v[152:155], v[212:215], 0
  s_waitcnt vmcnt(24)
  ds_read_b64_tr_b16 v[48:49], v44 offset:0
  ds_read_b64_tr_b16 v[50:51], v44 offset:2048
  ds_read_b64_tr_b16 v[52:53], v44 offset:8
  ds_read_b64_tr_b16 v[54:55], v44 offset:2056
  ds_read_b64_tr_b16 v[56:57], v45 offset:0
  ds_read_b64_tr_b16 v[58:59], v45 offset:2048
  ds_read_b64_tr_b16 v[60:61], v45 offset:8
  ds_read_b64_tr_b16 v[62:63], v45 offset:2056
  s_mov_b32 s23, 13107200
  s_add_u32 s8, s58, s23
  s_addc_u32 s9, s59, 0
  s_and_b32 s9, s9, 0xffff
  s_mov_b32 s10, 1261568
  s_mov_b32 s11, 0x20000
  v_lshlrev_b32 v40, 4, v12
  s_cmp_ge_u32 s14, 1261568
  s_cselect_b32 s10, 0, s10
  s_waitcnt lgkmcnt(0)
  buffer_store_dwordx4 v[48:51], v40, s[8:11], s14 offen offset:0 sc1
  buffer_store_dwordx4 v[52:55], v40, s[8:11], s14 offen offset:1024 sc1
  buffer_store_dwordx4 v[56:59], v40, s[8:11], s14 offen offset:2048 sc1
  buffer_store_dwordx4 v[60:63], v40, s[8:11], s14 offen offset:3072 sc1
  ds_read_b128 a[96:99], v241 offset:0
  ds_read_b128 a[112:115], v242 offset:0
  ds_read_b128 a[100:103], v243 offset:0
  ds_read_b128 a[116:119], v244 offset:0
  ds_read_b128 a[104:107], v241 offset:4096
  ds_read_b128 a[120:123], v242 offset:4096
  ds_read_b128 a[108:111], v243 offset:4096
  ds_read_b128 a[124:127], v244 offset:4096
  s_waitcnt lgkmcnt(0)
  v_and_b32 v15, 1, v13
  v_lshlrev_b32 v15, 1, v15
  v_bfe_u32 v16, v13, 1, 1
  v_or_b32 v15, v15, v16
  v_and_b32 v16, 12, v13
  v_or_b32 v15, v15, v16
  v_lshl_add_u32 v15, v14, 4, v15
  s_add_u32 m0, s75, 0
  s_add_u32 s70, s68, 896
  buffer_load_dwordx4 v232, s[60:63], s70 offen offset:0 lds
  v_lshlrev_b32 v29, 4, v15
  s_lshl_b32 s23, s20, 1
  s_and_b32 s33, s3, 1
  s_add_u32 s23, s23, s33
  s_mul_i32 s23, s23, 44
  s_lshl_b32 s33, s21, 1
  s_add_u32 s23, s23, s33
  s_lshr_b32 s33, s3, 1
  s_add_u32 s23, s23, s33
  s_lshl_b32 s23, s23, 12
  s_add_u32 s23, s23, 7340032
  s_add_u32 s16, s58, s23
  s_addc_u32 s17, s59, 0
  s_and_b32 s17, s17, 0xffff
  s_mov_b32 s18, 4096
  s_mov_b32 s19, 0x20000
  v_and_b32 v15, 2, v13
  v_cmp_eq_u32 vcc, 0, v15
  v_cmp_ne_u32 s[24:25], 0, v15
  v_mul_f32 v160, v160, v84
  v_mul_f32 v161, v161, v84
  v_mul_f32 v162, v162, v84
  buffer_load_dwordx4 v233, s[60:63], s70 offen offset:1024 lds
  v_mul_f32 v163, v163, v84
  v_mul_f32 v164, v164, v84
  v_mul_f32 v165, v165, v84
  v_mul_f32 v166, v166, v84
  v_mul_f32 v167, v167, v84
  v_cvt_pk_bf16_f32 v200, v160, v161
  v_cvt_pk_bf16_f32 v201, v162, v163
  buffer_load_dwordx4 v234, s[60:63], s70 offen offset:2048 lds
  v_cvt_pk_bf16_f32 v202, v164, v165
  v_cvt_pk_bf16_f32 v203, v166, v167
  v_mul_f32 v168, v168, v108
  v_mul_f32 v169, v169, v108
  v_mul_f32 v170, v170, v108
  v_mul_f32 v171, v171, v108
  v_mul_f32 v172, v172, v108
  buffer_load_dwordx4 v235, s[60:63], s70 offen offset:3072 lds
  v_mul_f32 v173, v173, v108
  v_mul_f32 v174, v174, v108
  v_mul_f32 v175, v175, v108
  v_cvt_pk_bf16_f32 v204, v168, v169
  v_cvt_pk_bf16_f32 v205, v170, v171
  v_cvt_pk_bf16_f32 v206, v172, v173
  v_cvt_pk_bf16_f32 v207, v174, v175
  s_add_u32 m0, s75, 4096
  s_add_u32 s70, s69, 896
  buffer_load_dwordx4 v232, s[60:63], s70 offen offset:0 lds
  v_mul_f32 v176, v176, v132
  v_mul_f32 v177, v177, v132
  v_mul_f32 v178, v178, v132
  v_mul_f32 v179, v179, v132
  v_mul_f32 v180, v180, v132
  v_mul_f32 v181, v181, v132
  v_mul_f32 v182, v182, v132
  buffer_load_dwordx4 v233, s[60:63], s70 offen offset:1024 lds
  v_mul_f32 v183, v183, v132
  v_cvt_pk_bf16_f32 v208, v176, v177
  v_cvt_pk_bf16_f32 v209, v178, v179
  v_cvt_pk_bf16_f32 v210, v180, v181
  v_cvt_pk_bf16_f32 v211, v182, v183
  v_mul_f32 v184, v184, v156
  v_mul_f32 v185, v185, v156
  buffer_load_dwordx4 v234, s[60:63], s70 offen offset:2048 lds
  v_mul_f32 v186, v186, v156
  v_mul_f32 v187, v187, v156
  v_mul_f32 v188, v188, v156
  v_mul_f32 v189, v189, v156
  v_mul_f32 v190, v190, v156
  v_mul_f32 v191, v191, v156
  v_cvt_pk_bf16_f32 v212, v184, v185
  buffer_load_dwordx4 v235, s[60:63], s70 offen offset:3072 lds
  v_cvt_pk_bf16_f32 v213, v186, v187
  v_cvt_pk_bf16_f32 v214, v188, v189
  v_cvt_pk_bf16_f32 v215, v190, v191
  v_mov_b32_dpp v216, v204 quad_perm:[2,3,0,1] row_mask:0xf bank_mask:0xf
  v_mov_b32_dpp v220, v200 quad_perm:[2,3,0,1] row_mask:0xf bank_mask:0xf
  v_mov_b32_dpp v217, v205 quad_perm:[2,3,0,1] row_mask:0xf bank_mask:0xf
  v_mov_b32_dpp v221, v201 quad_perm:[2,3,0,1] row_mask:0xf bank_mask:0xf
  v_mov_b32_dpp v218, v206 quad_perm:[2,3,0,1] row_mask:0xf bank_mask:0xf
  v_mov_b32_dpp v222, v202 quad_perm:[2,3,0,1] row_mask:0xf bank_mask:0xf
  v_mov_b32_dpp v219, v207 quad_perm:[2,3,0,1] row_mask:0xf bank_mask:0xf
  v_mov_b32_dpp v223, v203 quad_perm:[2,3,0,1] row_mask:0xf bank_mask:0xf
  v_cndmask_b32 v216, v216, v200, vcc
  v_cndmask_b32 v220, v220, v204, s[24:25]
  v_cndmask_b32 v217, v217, v201, vcc
  v_cndmask_b32 v221, v221, v205, s[24:25]
  v_cndmask_b32 v218, v218, v202, vcc
  v_cndmask_b32 v222, v222, v206, s[24:25]
  v_cndmask_b32 v219, v219, v203, vcc
  v_cndmask_b32 v223, v223, v207, s[24:25]
  buffer_store_dwordx4 v[216:219], v29, s[16:19], 0 offen offset:0 sc1
  buffer_store_dwordx4 v[220:223], v29, s[16:19], 0 offen offset:1024 sc1
  v_mov_b32_dpp v224, v212 quad_perm:[2,3,0,1] row_mask:0xf bank_mask:0xf
  v_mov_b32_dpp v228, v208 quad_perm:[2,3,0,1] row_mask:0xf bank_mask:0xf
  v_mov_b32_dpp v225, v213 quad_perm:[2,3,0,1] row_mask:0xf bank_mask:0xf
  v_mov_b32_dpp v229, v209 quad_perm:[2,3,0,1] row_mask:0xf bank_mask:0xf
  v_mov_b32_dpp v226, v214 quad_perm:[2,3,0,1] row_mask:0xf bank_mask:0xf
  v_mov_b32_dpp v230, v210 quad_perm:[2,3,0,1] row_mask:0xf bank_mask:0xf
  v_mov_b32_dpp v227, v215 quad_perm:[2,3,0,1] row_mask:0xf bank_mask:0xf
  v_mov_b32_dpp v231, v211 quad_perm:[2,3,0,1] row_mask:0xf bank_mask:0xf
  v_cndmask_b32 v224, v224, v208, vcc
  v_cndmask_b32 v228, v228, v212, s[24:25]
  v_cndmask_b32 v225, v225, v209, vcc
  v_cndmask_b32 v229, v229, v213, s[24:25]
  v_cndmask_b32 v226, v226, v210, vcc
  v_cndmask_b32 v230, v230, v214, s[24:25]
  v_cndmask_b32 v227, v227, v211, vcc
  v_cndmask_b32 v231, v231, v215, s[24:25]
  buffer_store_dwordx4 v[224:227], v29, s[16:19], 0 offen offset:2048 sc1
  buffer_store_dwordx4 v[228:231], v29, s[16:19], 0 offen offset:3072 sc1
  s_waitcnt vmcnt(0)
  v_readfirstlane_b32 s76, v10
  v_readfirstlane_b32 s77, v11
  s_cmp_lg_u32 s76, 0
  s_cbranch_scc1 mega_qtagd
  s_mov_b32 s33, 0
mega_qtagl:
  global_load_dwordx2 v[10:11], v9, s[56:57] sc1
  s_add_u32 s33, s33, 1
  s_waitcnt vmcnt(0)
  v_readfirstlane_b32 s76, v10
  v_readfirstlane_b32 s77, v11
  s_nop 1
  s_cmp_lg_u32 s76, 0
  s_cbranch_scc1 mega_qtagd
  s_cmp_lt_u32 s33, 0x20000
  s_cbranch_scc1 mega_qtagl
mega_qtagd:
  s_barrier
  s_mul_i32 s27, s20, 4352
  s_lshl_b32 s28, s21, 3
  s_add_u32 s27, s27, s28
  s_add_u32 s27, s27, 15073280
  s_cmp_lg_u32 s3, 0
  s_cbranch_scc1 mega_sigqd
  v_mov_b32 v18, s27
  v_mov_b32 v16, s76
  v_mov_b32 v17, s77
  s_mov_b64 s[34:35], exec
  s_mov_b64 exec, 1
  global_store_dwordx2 v18, v[16:17], s[58:59] sc1
  s_mov_b64 exec, s[34:35]
mega_sigqd:
  v_lshlrev_b32 v3, 4, v12
  v_add_u32 v4, 4096, v3
  s_mul_i32 s23, s21, 458752
  s_add_u32 s12, s58, s23
  s_addc_u32 s13, s59, 0
  s_and_b32 s13, s13, 0xffff
  s_mov_b32 s14, 458752
  s_mov_b32 s15, 0x20000
  s_mul_i32 s26, s3, 114688
  s_mov_b32 s25, 0
  s_and_b32 s23, s22, 7
  s_mul_i32 s23, s23, 896
  v_and_b32 v31, 7, v12
  v_min_u32 v31, 6, v31
  v_lshlrev_b32 v31, 7, v31
  v_bfe_u32 v30, v12, 3, 2
  v_mul_u32_u24 v30, 7168, v30
  v_add3_u32 v31, v31, v30, s23
  s_mul_i32 s27, s21, 4352
  s_lshl_b32 s23, s3, 5
  s_add_u32 s27, s27, s23
  s_add_u32 s27, s27, 14942208
  v_and_b32 v9, 3, v12
  v_lshl_add_u32 v9, v9, 3, s27
  global_load_dwordx2 v[10:11], v9, s[58:59] sc1
  s_waitcnt vmcnt(0)
  v_xor_b32 v10, s76, v10
  v_xor_b32 v11, s77, v11
  v_or_b32 v10, v10, v11
  v_cmp_eq_u32 vcc, 0, v10
  s_nop 1
  s_cmp_eq_u64 vcc, exec
  s_cbranch_scc1 mega_qfaok
  s_mov_b32 s33, 0
mega_qpaw_loop:
  global_load_dwordx2 v[18:19], v9, s[58:59] sc1
  s_add_u32 s33, s33, 1
  s_waitcnt vmcnt(0)
  v_xor_b32 v18, s76, v18
  v_xor_b32 v19, s77, v19
  v_or_b32 v18, v18, v19
  v_cmp_eq_u32 vcc, 0, v18
  s_nop 1
  s_cmp_eq_u64 vcc, exec
  s_cbranch_scc1 mega_qpaw_out
  s_sleep 2
  s_cmp_lt_u32 s33, 0x20000
  s_cbranch_scc1 mega_qpaw_loop
mega_qpaw_out:
mega_qfaok:
  s_add_u32 s27, s26, 0
  buffer_load_dwordx4 v[144:147], v3, s[12:15], s27 offen offset:0 sc1
  buffer_load_dwordx4 v[148:151], v3, s[12:15], s27 offen offset:1024 sc1
  buffer_load_dwordx4 v[152:155], v3, s[12:15], s27 offen offset:2048 sc1
  buffer_load_dwordx4 v[156:159], v3, s[12:15], s27 offen offset:3072 sc1
  buffer_load_dwordx4 v[160:163], v4, s[12:15], s27 offen offset:0 sc1
  buffer_load_dwordx4 v[164:167], v4, s[12:15], s27 offen offset:1024 sc1
  buffer_load_dwordx4 v[168:171], v4, s[12:15], s27 offen offset:2048 sc1
  ds_read_b128 a[128:131], v236 offset:0
  ds_read_b128 a[144:147], v237 offset:0
  ds_read_b128 a[132:135], v238 offset:0
  ds_read_b128 a[148:151], v239 offset:0
  ds_read_b128 a[136:139], v236 offset:4096
  ds_read_b128 a[152:155], v237 offset:4096
  ds_read_b128 a[140:143], v238 offset:4096
  ds_read_b128 a[156:159], v239 offset:4096
  ds_read_b128 a[160:163], v236 offset:8192
  ds_read_b128 a[176:179], v237 offset:8192
  ds_read_b128 a[164:167], v238 offset:8192
  ds_read_b128 a[180:183], v239 offset:8192
  ds_read_b128 a[168:171], v236 offset:12288
  ds_read_b128 a[184:187], v237 offset:12288
  ds_read_b128 a[172:175], v238 offset:12288
  ds_read_b128 a[188:191], v239 offset:12288
  ds_read_b128 a[192:195], v236 offset:16384
  ds_read_b128 a[208:211], v237 offset:16384
  ds_read_b128 a[196:199], v238 offset:16384
  ds_read_b128 a[212:215], v239 offset:16384
  ds_read_b128 a[200:203], v236 offset:20480
  ds_read_b128 a[216:219], v237 offset:20480
  ds_read_b128 a[204:207], v238 offset:20480
  ds_read_b128 a[220:223], v239 offset:20480
  ds_read_b128 a[224:227], v241 offset:0
  ds_read_b128 a[240:243], v242 offset:0
  ds_read_b128 a[228:231], v243 offset:0
  ds_read_b128 a[244:247], v244 offset:0
  ds_read_b128 a[232:235], v241 offset:4096
  ds_read_b128 a[248:251], v242 offset:4096
  ds_read_b128 a[236:239], v243 offset:4096
  ds_read_b128 a[252:255], v244 offset:4096
  s_add_u32 s24, s26, 21504
  buffer_load_dword v30, v31, s[12:15], s24 offen sc1
  s_add_u32 s27, s26, 7168
  buffer_load_dwordx4 v[172:175], v3, s[12:15], s27 offen offset:0 sc1
  buffer_load_dwordx4 v[176:179], v3, s[12:15], s27 offen offset:1024 sc1
  buffer_load_dwordx4 v[180:183], v3, s[12:15], s27 offen offset:2048 sc1
  buffer_load_dwordx4 v[184:187], v3, s[12:15], s27 offen offset:3072 sc1
  buffer_load_dwordx4 v[188:191], v4, s[12:15], s27 offen offset:0 sc1
  buffer_load_dwordx4 v[192:195], v4, s[12:15], s27 offen offset:1024 sc1
  buffer_load_dwordx4 v[196:199], v4, s[12:15], s27 offen offset:2048 sc1
  s_add_u32 s27, s26, 14336
  buffer_load_dwordx4 v[200:203], v3, s[12:15], s27 offen offset:0 sc1
  buffer_load_dwordx4 v[204:207], v3, s[12:15], s27 offen offset:1024 sc1
  buffer_load_dwordx4 v[208:211], v3, s[12:15], s27 offen offset:2048 sc1
  buffer_load_dwordx4 v[212:215], v3, s[12:15], s27 offen offset:3072 sc1
  buffer_load_dwordx4 v[216:219], v4, s[12:15], s27 offen offset:0 sc1
  buffer_load_dwordx4 v[220:223], v4, s[12:15], s27 offen offset:1024 sc1
  buffer_load_dwordx4 v[224:227], v4, s[12:15], s27 offen offset:2048 sc1
  s_waitcnt lgkmcnt(0)
  s_waitcnt vmcnt(15)
  v_mfma_f32_16x16x32_bf16 v[32:35], v[144:147], a[0:3], 0
  s_mul_i32 s33, s21, 180224
  s_add_u32 s33, s33, 13107200
  s_add_u32 s8, s58, s33
  s_addc_u32 s9, s59, 0
  s_and_b32 s9, s9, 0xffff
  s_mov_b32 s10, 180224
  s_mov_b32 s11, 0x20000
  s_cmp_eq_u32 s21, 7
  s_cselect_b32 s10, 0, s10
  s_add_u32 s27, s26, 21504
  buffer_load_dwordx4 v[228:231], v3, s[12:15], s27 offen offset:0 sc1
  v_mfma_f32_16x16x32_bf16 v[36:39], v[144:147], a[4:7], 0
  s_mul_i32 s33, s22, 180224
  s_add_u32 s33, s33, 7340032
  s_add_u32 s16, s58, s33
  s_addc_u32 s17, s59, 0
  s_and_b32 s17, s17, 0xffff
  s_mov_b32 s18, 180224
  s_mov_b32 s19, 0x20000
  v_mfma_f32_16x16x32_bf16 v[40:43], v[144:147], a[8:11], 0
  s_xor_b32 s33, s3, 0
  s_lshl_b32 s33, s33, 10
  v_add_u32 v5, s33, v3
  buffer_load_dwordx4 v[232:235], v3, s[12:15], s27 offen offset:1024 sc1
  v_mfma_f32_16x16x32_bf16 v[44:47], v[144:147], a[12:15], 0
  s_xor_b32 s33, s3, 1
  s_lshl_b32 s33, s33, 10
  v_add_u32 v6, s33, v3
  v_mfma_f32_16x16x32_bf16 v[48:51], v[148:151], a[0:3], 0
  s_xor_b32 s33, s3, 2
  s_lshl_b32 s33, s33, 10
  v_add_u32 v7, s33, v3
  buffer_load_dwordx4 v[236:239], v3, s[12:15], s27 offen offset:2048 sc1
  v_mfma_f32_16x16x32_bf16 v[52:55], v[148:151], a[4:7], 0
  s_xor_b32 s33, s3, 3
  s_lshl_b32 s33, s33, 10
  v_add_u32 v8, s33, v3
  v_mfma_f32_16x16x32_bf16 v[56:59], v[148:151], a[8:11], 0
  s_lshl_b32 s28, s3, 14
  buffer_load_dwordx4 v[240:243], v3, s[12:15], s27 offen offset:3072 sc1
  v_mfma_f32_16x16x32_bf16 v[60:63], v[148:151], a[12:15], 0
  s_mul_i32 s29, s3, 28672
  s_add_u32 s29, s29, 65536
  v_mfma_f32_16x16x32_bf16 v[64:67], v[152:155], a[0:3], 0
  s_lshl_b32 s30, s22, 2
  s_add_u32 s30, s30, s3
  s_mul_i32 s31, s30, 56
  s_mul_i32 s32, s21, 7
  s_add_u32 s31, s31, s32
  s_lshl_b32 s31, s31, 9
  s_add_u32 s31, s31, 3670016
  s_add_u32 s64, s58, s31
  s_addc_u32 s65, s59, 0
  s_and_b32 s65, s65, 0xffff
  s_mov_b32 s66, 3584
  s_mov_b32 s67, 0x20000
  buffer_load_dwordx4 v[244:247], v4, s[12:15], s27 offen offset:0 sc1
  v_mfma_f32_16x16x32_bf16 v[68:71], v[152:155], a[4:7], 0
  v_lshlrev_b32 v10, 3, v12
  v_mfma_f32_16x16x32_bf16 v[72:75], v[152:155], a[8:11], 0
  s_lshl_b32 s31, s22, 6
  s_lshr_b32 s32, s3, 1
  s_lshl_b32 s32, s32, 5
  s_add_u32 s31, s31, s32
  s_and_b32 s32, s3, 1
  s_lshl_b32 s32, s32, 2
  s_add_u32 s31, s31, s32
  buffer_load_dwordx4 v[248:251], v4, s[12:15], s27 offen offset:1024 sc1
  v_mfma_f32_16x16x32_bf16 v[76:79], v[152:155], a[12:15], 0
  v_lshrrev_b32 v11, 2, v13
  v_mfma_f32_16x16x32_bf16 v[80:83], v[156:159], a[0:3], 0
  v_lshlrev_b32 v11, 3, v11
  buffer_load_dwordx4 v[252:255], v4, s[12:15], s27 offen offset:2048 sc1
  v_mfma_f32_16x16x32_bf16 v[84:87], v[156:159], a[4:7], 0
  v_and_b32 v1, 3, v13
  v_mfma_f32_16x16x32_bf16 v[88:91], v[156:159], a[8:11], 0
  v_add_u32 v11, v11, v1
  v_mfma_f32_16x16x32_bf16 v[92:95], v[156:159], a[12:15], 0
  v_add_u32 v11, s31, v11
  v_mfma_f32_16x16x32_bf16 v[96:99], v[160:163], a[0:3], 0
  v_lshlrev_b32 v15, 2, v11
  v_mfma_f32_16x16x32_bf16 v[100:103], v[160:163], a[4:7], 0
  v_add_u32 v15, 14368768, v15
  v_mfma_f32_16x16x32_bf16 v[104:107], v[160:163], a[8:11], 0
  v_lshlrev_b32 v11, 1, v11
  v_mfma_f32_16x16x32_bf16 v[108:111], v[160:163], a[12:15], 0
  s_mul_i32 s33, s21, 11
  v_mfma_f32_16x16x32_bf16 v[112:115], v[164:167], a[0:3], 0
  v_subrev_u32 v1, 8, v12
  v_mfma_f32_16x16x32_bf16 v[116:119], v[164:167], a[4:7], 0
  v_min_u32 v1, 11, v1
  v_mfma_f32_16x16x32_bf16 v[120:123], v[164:167], a[8:11], 0
  v_add_u32 v1, s33, v1
  v_mfma_f32_16x16x32_bf16 v[124:127], v[164:167], a[12:15], 0
  v_min_u32 v1, 76, v1
  v_mfma_f32_16x16x32_bf16 v[128:131], v[168:171], a[0:3], 0
  s_lshl_b32 s33, s20, 3
  v_mfma_f32_16x16x32_bf16 v[132:135], v[168:171], a[4:7], 0
  v_add_u32 v2, s33, v12
  v_mfma_f32_16x16x32_bf16 v[136:139], v[168:171], a[8:11], 0
  v_cmp_gt_u32 vcc, 8, v12
  v_mfma_f32_16x16x32_bf16 v[140:143], v[168:171], a[12:15], 0
  s_nop 0
  v_cndmask_b32 v1, v1, v2, vcc
  s_waitcnt vmcnt(14)
  s_add_u32 s24, s26, 50176
  buffer_load_dword v30, v31, s[12:15], s24 offen sc1
  v_mfma_f32_16x16x32_bf16 v[32:35], v[172:175], a[16:19], v[32:35]
  v_lshrrev_b32 v2, 3, v1
  s_add_u32 s27, s26, 28672
  buffer_load_dwordx4 v[144:147], v3, s[12:15], s27 offen offset:0 sc1
  v_mfma_f32_16x16x32_bf16 v[36:39], v[172:175], a[20:23], v[36:39]
  v_mul_u32_u24 v2, 4352, v2
  v_mfma_f32_16x16x32_bf16 v[40:43], v[172:175], a[24:27], v[40:43]
  v_and_b32 v1, 7, v1
  v_mfma_f32_16x16x32_bf16 v[44:47], v[172:175], a[28:31], v[44:47]
  v_lshl_add_u32 v2, v1, 3, v2
  v_mfma_f32_16x16x32_bf16 v[48:51], v[176:179], a[16:19], v[48:51]
  v_add_u32 v2, 15073280, v2
  buffer_load_dwordx4 v[148:151], v3, s[12:15], s27 offen offset:1024 sc1
  v_mfma_f32_16x16x32_bf16 v[52:55], v[176:179], a[20:23], v[52:55]
  s_mul_i32 s33, s20, 4352
  s_lshl_b32 s32, s21, 3
  s_add_u32 s33, s33, s32
  s_add_u32 s33, s33, 15466496
  v_mov_b32 v9, s33
  v_mfma_f32_16x16x32_bf16 v[56:59], v[176:179], a[24:27], v[56:59]
  v_mfma_f32_16x16x32_bf16 v[60:63], v[176:179], a[28:31], v[60:63]
  v_mfma_f32_16x16x32_bf16 v[64:67], v[180:183], a[16:19], v[64:67]
  buffer_load_dwordx4 v[152:155], v3, s[12:15], s27 offen offset:2048 sc1
  v_mfma_f32_16x16x32_bf16 v[68:71], v[180:183], a[20:23], v[68:71]
  v_mfma_f32_16x16x32_bf16 v[72:75], v[180:183], a[24:27], v[72:75]
  v_mfma_f32_16x16x32_bf16 v[76:79], v[180:183], a[28:31], v[76:79]
  v_mfma_f32_16x16x32_bf16 v[80:83], v[184:187], a[16:19], v[80:83]
  buffer_load_dwordx4 v[156:159], v3, s[12:15], s27 offen offset:3072 sc1
  v_mfma_f32_16x16x32_bf16 v[84:87], v[184:187], a[20:23], v[84:87]
  v_mfma_f32_16x16x32_bf16 v[88:91], v[184:187], a[24:27], v[88:91]
  v_mfma_f32_16x16x32_bf16 v[92:95], v[184:187], a[28:31], v[92:95]
  v_mfma_f32_16x16x32_bf16 v[96:99], v[188:191], a[16:19], v[96:99]
  buffer_load_dwordx4 v[160:163], v4, s[12:15], s27 offen offset:0 sc1
  v_mfma_f32_16x16x32_bf16 v[100:103], v[188:191], a[20:23], v[100:103]
  v_mfma_f32_16x16x32_bf16 v[104:107], v[188:191], a[24:27], v[104:107]
  v_mfma_f32_16x16x32_bf16 v[108:111], v[188:191], a[28:31], v[108:111]
  v_mfma_f32_16x16x32_bf16 v[112:115], v[192:195], a[16:19], v[112:115]
  buffer_load_dwordx4 v[164:167], v4, s[12:15], s27 offen offset:1024 sc1
  v_mfma_f32_16x16x32_bf16 v[116:119], v[192:195], a[20:23], v[116:119]
  v_mfma_f32_16x16x32_bf16 v[120:123], v[192:195], a[24:27], v[120:123]
  v_mfma_f32_16x16x32_bf16 v[124:127], v[192:195], a[28:31], v[124:127]
  v_mfma_f32_16x16x32_bf16 v[128:131], v[196:199], a[16:19], v[128:131]
  buffer_load_dwordx4 v[168:171], v4, s[12:15], s27 offen offset:2048 sc1
  v_mfma_f32_16x16x32_bf16 v[132:135], v[196:199], a[20:23], v[132:135]
  v_mfma_f32_16x16x32_bf16 v[136:139], v[196:199], a[24:27], v[136:139]
  v_mfma_f32_16x16x32_bf16 v[140:143], v[196:199], a[28:31], v[140:143]
  s_waitcnt vmcnt(15)
  v_mfma_f32_16x16x32_bf16 v[32:35], v[200:203], a[32:35], v[32:35]
  s_add_u32 s27, s26, 35840
  buffer_load_dwordx4 v[172:175], v3, s[12:15], s27 offen offset:0 sc1
  v_mfma_f32_16x16x32_bf16 v[36:39], v[200:203], a[36:39], v[36:39]
  v_mfma_f32_16x16x32_bf16 v[40:43], v[200:203], a[40:43], v[40:43]
  v_mfma_f32_16x16x32_bf16 v[44:47], v[200:203], a[44:47], v[44:47]
  v_mfma_f32_16x16x32_bf16 v[48:51], v[204:207], a[32:35], v[48:51]
  buffer_load_dwordx4 v[176:179], v3, s[12:15], s27 offen offset:1024 sc1
  v_mfma_f32_16x16x32_bf16 v[52:55], v[204:207], a[36:39], v[52:55]
  v_mfma_f32_16x16x32_bf16 v[56:59], v[204:207], a[40:43], v[56:59]
  v_mfma_f32_16x16x32_bf16 v[60:63], v[204:207], a[44:47], v[60:63]
  v_mfma_f32_16x16x32_bf16 v[64:67], v[208:211], a[32:35], v[64:67]
  buffer_load_dwordx4 v[180:183], v3, s[12:15], s27 offen offset:2048 sc1
  v_mfma_f32_16x16x32_bf16 v[68:71], v[208:211], a[36:39], v[68:71]
  v_mfma_f32_16x16x32_bf16 v[72:75], v[208:211], a[40:43], v[72:75]
  v_mfma_f32_16x16x32_bf16 v[76:79], v[208:211], a[44:47], v[76:79]
  v_mfma_f32_16x16x32_bf16 v[80:83], v[212:215], a[32:35], v[80:83]
  buffer_load_dwordx4 v[184:187], v3, s[12:15], s27 offen offset:3072 sc1
  v_mfma_f32_16x16x32_bf16 v[84:87], v[212:215], a[36:39], v[84:87]
  v_mfma_f32_16x16x32_bf16 v[88:91], v[212:215], a[40:43], v[88:91]
  v_mfma_f32_16x16x32_bf16 v[92:95], v[212:215], a[44:47], v[92:95]
  v_mfma_f32_16x16x32_bf16 v[96:99], v[216:219], a[32:35], v[96:99]
  buffer_load_dwordx4 v[188:191], v4, s[12:15], s27 offen offset:0 sc1
  v_mfma_f32_16x16x32_bf16 v[100:103], v[216:219], a[36:39], v[100:103]
  v_mfma_f32_16x16x32_bf16 v[104:107], v[216:219], a[40:43], v[104:107]
  v_mfma_f32_16x16x32_bf16 v[108:111], v[216:219], a[44:47], v[108:111]
  v_mfma_f32_16x16x32_bf16 v[112:115], v[220:223], a[32:35], v[112:115]
  buffer_load_dwordx4 v[192:195], v4, s[12:15], s27 offen offset:1024 sc1
  v_mfma_f32_16x16x32_bf16 v[116:119], v[220:223], a[36:39], v[116:119]
  v_mfma_f32_16x16x32_bf16 v[120:123], v[220:223], a[40:43], v[120:123]
  v_mfma_f32_16x16x32_bf16 v[124:127], v[220:223], a[44:47], v[124:127]
  v_mfma_f32_16x16x32_bf16 v[128:131], v[224:227], a[32:35], v[128:131]
  buffer_load_dwordx4 v[196:199], v4, s[12:15], s27 offen offset:2048 sc1
  v_mfma_f32_16x16x32_bf16 v[132:135], v[224:227], a[36:39], v[132:135]
  v_mfma_f32_16x16x32_bf16 v[136:139], v[224:227], a[40:43], v[136:139]
  v_mfma_f32_16x16x32_bf16 v[140:143], v[224:227], a[44:47], v[140:143]
  s_waitcnt vmcnt(15)
  v_mfma_f32_16x16x32_bf16 v[32:35], v[228:231], a[48:51], v[32:35]
  s_add_u32 s27, s26, 43008
  buffer_load_dwordx4 v[200:203], v3, s[12:15], s27 offen offset:0 sc1
  v_mfma_f32_16x16x32_bf16 v[36:39], v[228:231], a[52:55], v[36:39]
  v_mfma_f32_16x16x32_bf16 v[40:43], v[228:231], a[56:59], v[40:43]
  v_mfma_f32_16x16x32_bf16 v[44:47], v[228:231], a[60:63], v[44:47]
  v_mfma_f32_16x16x32_bf16 v[48:51], v[232:235], a[48:51], v[48:51]
  buffer_load_dwordx4 v[204:207], v3, s[12:15], s27 offen offset:1024 sc1
  v_mfma_f32_16x16x32_bf16 v[52:55], v[232:235], a[52:55], v[52:55]
  v_mfma_f32_16x16x32_bf16 v[56:59], v[232:235], a[56:59], v[56:59]
  v_mfma_f32_16x16x32_bf16 v[60:63], v[232:235], a[60:63], v[60:63]
  v_mfma_f32_16x16x32_bf16 v[64:67], v[236:239], a[48:51], v[64:67]
  buffer_load_dwordx4 v[208:211], v3, s[12:15], s27 offen offset:2048 sc1
  v_mfma_f32_16x16x32_bf16 v[68:71], v[236:239], a[52:55], v[68:71]
  v_mfma_f32_16x16x32_bf16 v[72:75], v[236:239], a[56:59], v[72:75]
  v_mfma_f32_16x16x32_bf16 v[76:79], v[236:239], a[60:63], v[76:79]
  v_mfma_f32_16x16x32_bf16 v[80:83], v[240:243], a[48:51], v[80:83]
  buffer_load_dwordx4 v[212:215], v3, s[12:15], s27 offen offset:3072 sc1
  v_mfma_f32_16x16x32_bf16 v[84:87], v[240:243], a[52:55], v[84:87]
  v_mfma_f32_16x16x32_bf16 v[88:91], v[240:243], a[56:59], v[88:91]
  v_mfma_f32_16x16x32_bf16 v[92:95], v[240:243], a[60:63], v[92:95]
  v_mfma_f32_16x16x32_bf16 v[96:99], v[244:247], a[48:51], v[96:99]
  buffer_load_dwordx4 v[216:219], v4, s[12:15], s27 offen offset:0 sc1
  v_mfma_f32_16x16x32_bf16 v[100:103], v[244:247], a[52:55], v[100:103]
  v_mfma_f32_16x16x32_bf16 v[104:107], v[244:247], a[56:59], v[104:107]
  v_mfma_f32_16x16x32_bf16 v[108:111], v[244:247], a[60:63], v[108:111]
  v_mfma_f32_16x16x32_bf16 v[112:115], v[248:251], a[48:51], v[112:115]
  buffer_load_dwordx4 v[220:223], v4, s[12:15], s27 offen offset:1024 sc1
  v_mfma_f32_16x16x32_bf16 v[116:119], v[248:251], a[52:55], v[116:119]
  v_mfma_f32_16x16x32_bf16 v[120:123], v[248:251], a[56:59], v[120:123]
  v_mfma_f32_16x16x32_bf16 v[124:127], v[248:251], a[60:63], v[124:127]
  v_mfma_f32_16x16x32_bf16 v[128:131], v[252:255], a[48:51], v[128:131]
  buffer_load_dwordx4 v[224:227], v4, s[12:15], s27 offen offset:2048 sc1
  v_mfma_f32_16x16x32_bf16 v[132:135], v[252:255], a[52:55], v[132:135]
  v_mfma_f32_16x16x32_bf16 v[136:139], v[252:255], a[56:59], v[136:139]
  v_mfma_f32_16x16x32_bf16 v[140:143], v[252:255], a[60:63], v[140:143]
  s_waitcnt vmcnt(14)
  s_barrier
  v_mfma_f32_16x16x32_bf16 v[32:35], v[144:147], a[64:67], v[32:35]
  s_add_u32 s27, s26, 50176
  buffer_load_dwordx4 v[228:231], v3, s[12:15], s27 offen offset:0 sc1
  v_mfma_f32_16x16x32_bf16 v[36:39], v[144:147], a[68:71], v[36:39]
  v_mfma_f32_16x16x32_bf16 v[40:43], v[144:147], a[72:75], v[40:43]
  v_mfma_f32_16x16x32_bf16 v[44:47], v[144:147], a[76:79], v[44:47]
  v_mfma_f32_16x16x32_bf16 v[48:51], v[148:151], a[64:67], v[48:51]
  buffer_load_dwordx4 v[232:235], v3, s[12:15], s27 offen offset:1024 sc1
  v_mfma_f32_16x16x32_bf16 v[52:55], v[148:151], a[68:71], v[52:55]
  v_mfma_f32_16x16x32_bf16 v[56:59], v[148:151], a[72:75], v[56:59]
  v_mfma_f32_16x16x32_bf16 v[60:63], v[148:151], a[76:79], v[60:63]
  v_mfma_f32_16x16x32_bf16 v[64:67], v[152:155], a[64:67], v[64:67]
  buffer_load_dwordx4 v[236:239], v3, s[12:15], s27 offen offset:2048 sc1
  v_mfma_f32_16x16x32_bf16 v[68:71], v[152:155], a[68:71], v[68:71]
  v_mfma_f32_16x16x32_bf16 v[72:75], v[152:155], a[72:75], v[72:75]
  v_mfma_f32_16x16x32_bf16 v[76:79], v[152:155], a[76:79], v[76:79]
  v_mfma_f32_16x16x32_bf16 v[80:83], v[156:159], a[64:67], v[80:83]
  buffer_load_dwordx4 v[240:243], v3, s[12:15], s27 offen offset:3072 sc1
  v_mfma_f32_16x16x32_bf16 v[84:87], v[156:159], a[68:71], v[84:87]
  v_mfma_f32_16x16x32_bf16 v[88:91], v[156:159], a[72:75], v[88:91]
  v_mfma_f32_16x16x32_bf16 v[92:95], v[156:159], a[76:79], v[92:95]
  v_mfma_f32_16x16x32_bf16 v[96:99], v[160:163], a[64:67], v[96:99]
  buffer_load_dwordx4 v[244:247], v4, s[12:15], s27 offen offset:0 sc1
  v_mfma_f32_16x16x32_bf16 v[100:103], v[160:163], a[68:71], v[100:103]
  v_mfma_f32_16x16x32_bf16 v[104:107], v[160:163], a[72:75], v[104:107]
  v_mfma_f32_16x16x32_bf16 v[108:111], v[160:163], a[76:79], v[108:111]
  v_mfma_f32_16x16x32_bf16 v[112:115], v[164:167], a[64:67], v[112:115]
  buffer_load_dwordx4 v[248:251], v4, s[12:15], s27 offen offset:1024 sc1
  v_mfma_f32_16x16x32_bf16 v[116:119], v[164:167], a[68:71], v[116:119]
  v_mfma_f32_16x16x32_bf16 v[120:123], v[164:167], a[72:75], v[120:123]
  v_mfma_f32_16x16x32_bf16 v[124:127], v[164:167], a[76:79], v[124:127]
  v_mfma_f32_16x16x32_bf16 v[128:131], v[168:171], a[64:67], v[128:131]
  buffer_load_dwordx4 v[252:255], v4, s[12:15], s27 offen offset:2048 sc1
  v_mfma_f32_16x16x32_bf16 v[132:135], v[168:171], a[68:71], v[132:135]
  v_mfma_f32_16x16x32_bf16 v[136:139], v[168:171], a[72:75], v[136:139]
  v_mfma_f32_16x16x32_bf16 v[140:143], v[168:171], a[76:79], v[140:143]
  s_waitcnt vmcnt(14)
  s_add_u32 s24, s26, 78848
  buffer_load_dword v30, v31, s[12:15], s24 offen sc1
  v_mfma_f32_16x16x32_bf16 v[32:35], v[172:175], a[80:83], v[32:35]
  s_add_u32 s27, s26, 57344
  buffer_load_dwordx4 v[144:147], v3, s[12:15], s27 offen offset:0 sc1
  v_mfma_f32_16x16x32_bf16 v[36:39], v[172:175], a[84:87], v[36:39]
  v_mfma_f32_16x16x32_bf16 v[40:43], v[172:175], a[88:91], v[40:43]
  v_mfma_f32_16x16x32_bf16 v[44:47], v[172:175], a[92:95], v[44:47]
  v_mfma_f32_16x16x32_bf16 v[48:51], v[176:179], a[80:83], v[48:51]
  buffer_load_dwordx4 v[148:151], v3, s[12:15], s27 offen offset:1024 sc1
  v_mfma_f32_16x16x32_bf16 v[52:55], v[176:179], a[84:87], v[52:55]
  v_mfma_f32_16x16x32_bf16 v[56:59], v[176:179], a[88:91], v[56:59]
  v_mfma_f32_16x16x32_bf16 v[60:63], v[176:179], a[92:95], v[60:63]
  v_mfma_f32_16x16x32_bf16 v[64:67], v[180:183], a[80:83], v[64:67]
  buffer_load_dwordx4 v[152:155], v3, s[12:15], s27 offen offset:2048 sc1
  v_mfma_f32_16x16x32_bf16 v[68:71], v[180:183], a[84:87], v[68:71]
  v_mfma_f32_16x16x32_bf16 v[72:75], v[180:183], a[88:91], v[72:75]
  v_mfma_f32_16x16x32_bf16 v[76:79], v[180:183], a[92:95], v[76:79]
  v_mfma_f32_16x16x32_bf16 v[80:83], v[184:187], a[80:83], v[80:83]
  buffer_load_dwordx4 v[156:159], v3, s[12:15], s27 offen offset:3072 sc1
  v_mfma_f32_16x16x32_bf16 v[84:87], v[184:187], a[84:87], v[84:87]
  v_mfma_f32_16x16x32_bf16 v[88:91], v[184:187], a[88:91], v[88:91]
  v_mfma_f32_16x16x32_bf16 v[92:95], v[184:187], a[92:95], v[92:95]
  v_mfma_f32_16x16x32_bf16 v[96:99], v[188:191], a[80:83], v[96:99]
  buffer_load_dwordx4 v[160:163], v4, s[12:15], s27 offen offset:0 sc1
  v_mfma_f32_16x16x32_bf16 v[100:103], v[188:191], a[84:87], v[100:103]
  v_mfma_f32_16x16x32_bf16 v[104:107], v[188:191], a[88:91], v[104:107]
  v_mfma_f32_16x16x32_bf16 v[108:111], v[188:191], a[92:95], v[108:111]
  v_mfma_f32_16x16x32_bf16 v[112:115], v[192:195], a[80:83], v[112:115]
  buffer_load_dwordx4 v[164:167], v4, s[12:15], s27 offen offset:1024 sc1
  v_mfma_f32_16x16x32_bf16 v[116:119], v[192:195], a[84:87], v[116:119]
  v_mfma_f32_16x16x32_bf16 v[120:123], v[192:195], a[88:91], v[120:123]
  v_mfma_f32_16x16x32_bf16 v[124:127], v[192:195], a[92:95], v[124:127]
  v_mfma_f32_16x16x32_bf16 v[128:131], v[196:199], a[80:83], v[128:131]
  buffer_load_dwordx4 v[168:171], v4, s[12:15], s27 offen offset:2048 sc1
  v_mfma_f32_16x16x32_bf16 v[132:135], v[196:199], a[84:87], v[132:135]
  v_mfma_f32_16x16x32_bf16 v[136:139], v[196:199], a[88:91], v[136:139]
  v_mfma_f32_16x16x32_bf16 v[140:143], v[196:199], a[92:95], v[140:143]
  s_waitcnt vmcnt(15)
  v_mfma_f32_16x16x32_bf16 v[32:35], v[200:203], a[96:99], v[32:35]
  s_add_u32 s27, s26, 64512
  buffer_load_dwordx4 v[172:175], v3, s[12:15], s27 offen offset:0 sc1
  v_mfma_f32_16x16x32_bf16 v[36:39], v[200:203], a[100:103], v[36:39]
  v_mfma_f32_16x16x32_bf16 v[40:43], v[200:203], a[104:107], v[40:43]
  v_mfma_f32_16x16x32_bf16 v[44:47], v[200:203], a[108:111], v[44:47]
  v_mfma_f32_16x16x32_bf16 v[48:51], v[204:207], a[96:99], v[48:51]
  buffer_load_dwordx4 v[176:179], v3, s[12:15], s27 offen offset:1024 sc1
  v_mfma_f32_16x16x32_bf16 v[52:55], v[204:207], a[100:103], v[52:55]
  v_mfma_f32_16x16x32_bf16 v[56:59], v[204:207], a[104:107], v[56:59]
  v_mfma_f32_16x16x32_bf16 v[60:63], v[204:207], a[108:111], v[60:63]
  v_mfma_f32_16x16x32_bf16 v[64:67], v[208:211], a[96:99], v[64:67]
  buffer_load_dwordx4 v[180:183], v3, s[12:15], s27 offen offset:2048 sc1
  v_mfma_f32_16x16x32_bf16 v[68:71], v[208:211], a[100:103], v[68:71]
  v_mfma_f32_16x16x32_bf16 v[72:75], v[208:211], a[104:107], v[72:75]
  v_mfma_f32_16x16x32_bf16 v[76:79], v[208:211], a[108:111], v[76:79]
  v_mfma_f32_16x16x32_bf16 v[80:83], v[212:215], a[96:99], v[80:83]
  buffer_load_dwordx4 v[184:187], v3, s[12:15], s27 offen offset:3072 sc1
  v_mfma_f32_16x16x32_bf16 v[84:87], v[212:215], a[100:103], v[84:87]
  v_mfma_f32_16x16x32_bf16 v[88:91], v[212:215], a[104:107], v[88:91]
  v_mfma_f32_16x16x32_bf16 v[92:95], v[212:215], a[108:111], v[92:95]
  v_mfma_f32_16x16x32_bf16 v[96:99], v[216:219], a[96:99], v[96:99]
  buffer_load_dwordx4 v[188:191], v4, s[12:15], s27 offen offset:0 sc1
  v_mfma_f32_16x16x32_bf16 v[100:103], v[216:219], a[100:103], v[100:103]
  v_mfma_f32_16x16x32_bf16 v[104:107], v[216:219], a[104:107], v[104:107]
  v_mfma_f32_16x16x32_bf16 v[108:111], v[216:219], a[108:111], v[108:111]
  v_mfma_f32_16x16x32_bf16 v[112:115], v[220:223], a[96:99], v[112:115]
  buffer_load_dwordx4 v[192:195], v4, s[12:15], s27 offen offset:1024 sc1
  v_mfma_f32_16x16x32_bf16 v[116:119], v[220:223], a[100:103], v[116:119]
  v_mfma_f32_16x16x32_bf16 v[120:123], v[220:223], a[104:107], v[120:123]
  v_mfma_f32_16x16x32_bf16 v[124:127], v[220:223], a[108:111], v[124:127]
  v_mfma_f32_16x16x32_bf16 v[128:131], v[224:227], a[96:99], v[128:131]
  buffer_load_dwordx4 v[196:199], v4, s[12:15], s27 offen offset:2048 sc1
  v_mfma_f32_16x16x32_bf16 v[132:135], v[224:227], a[100:103], v[132:135]
  v_mfma_f32_16x16x32_bf16 v[136:139], v[224:227], a[104:107], v[136:139]
  v_mfma_f32_16x16x32_bf16 v[140:143], v[224:227], a[108:111], v[140:143]
  s_waitcnt vmcnt(15)
  v_mfma_f32_16x16x32_bf16 v[32:35], v[228:231], a[112:115], v[32:35]
  s_add_u32 s27, s26, 71680
  buffer_load_dwordx4 v[200:203], v3, s[12:15], s27 offen offset:0 sc1
  v_mfma_f32_16x16x32_bf16 v[36:39], v[228:231], a[116:119], v[36:39]
  v_mfma_f32_16x16x32_bf16 v[40:43], v[228:231], a[120:123], v[40:43]
  v_mfma_f32_16x16x32_bf16 v[44:47], v[228:231], a[124:127], v[44:47]
  v_mfma_f32_16x16x32_bf16 v[48:51], v[232:235], a[112:115], v[48:51]
  buffer_load_dwordx4 v[204:207], v3, s[12:15], s27 offen offset:1024 sc1
  v_mfma_f32_16x16x32_bf16 v[52:55], v[232:235], a[116:119], v[52:55]
  v_mfma_f32_16x16x32_bf16 v[56:59], v[232:235], a[120:123], v[56:59]
  v_mfma_f32_16x16x32_bf16 v[60:63], v[232:235], a[124:127], v[60:63]
  v_mfma_f32_16x16x32_bf16 v[64:67], v[236:239], a[112:115], v[64:67]
  buffer_load_dwordx4 v[208:211], v3, s[12:15], s27 offen offset:2048 sc1
  v_mfma_f32_16x16x32_bf16 v[68:71], v[236:239], a[116:119], v[68:71]
  v_mfma_f32_16x16x32_bf16 v[72:75], v[236:239], a[120:123], v[72:75]
  v_mfma_f32_16x16x32_bf16 v[76:79], v[236:239], a[124:127], v[76:79]
  v_mfma_f32_16x16x32_bf16 v[80:83], v[240:243], a[112:115], v[80:83]
  buffer_load_dwordx4 v[212:215], v3, s[12:15], s27 offen offset:3072 sc1
  v_mfma_f32_16x16x32_bf16 v[84:87], v[240:243], a[116:119], v[84:87]
  v_mfma_f32_16x16x32_bf16 v[88:91], v[240:243], a[120:123], v[88:91]
  v_mfma_f32_16x16x32_bf16 v[92:95], v[240:243], a[124:127], v[92:95]
  v_mfma_f32_16x16x32_bf16 v[96:99], v[244:247], a[112:115], v[96:99]
  buffer_load_dwordx4 v[216:219], v4, s[12:15], s27 offen offset:0 sc1
  v_mfma_f32_16x16x32_bf16 v[100:103], v[244:247], a[116:119], v[100:103]
  v_mfma_f32_16x16x32_bf16 v[104:107], v[244:247], a[120:123], v[104:107]
  v_mfma_f32_16x16x32_bf16 v[108:111], v[244:247], a[124:127], v[108:111]
  v_mfma_f32_16x16x32_bf16 v[112:115], v[248:251], a[112:115], v[112:115]
  buffer_load_dwordx4 v[220:223], v4, s[12:15], s27 offen offset:1024 sc1
  v_mfma_f32_16x16x32_bf16 v[116:119], v[248:251], a[116:119], v[116:119]
  v_mfma_f32_16x16x32_bf16 v[120:123], v[248:251], a[120:123], v[120:123]
  v_mfma_f32_16x16x32_bf16 v[124:127], v[248:251], a[124:127], v[124:127]
  v_mfma_f32_16x16x32_bf16 v[128:131], v[252:255], a[112:115], v[128:131]
  buffer_load_dwordx4 v[224:227], v4, s[12:15], s27 offen offset:2048 sc1
  v_mfma_f32_16x16x32_bf16 v[132:135], v[252:255], a[116:119], v[132:135]
  v_mfma_f32_16x16x32_bf16 v[136:139], v[252:255], a[120:123], v[136:139]
  v_mfma_f32_16x16x32_bf16 v[140:143], v[252:255], a[124:127], v[140:143]
  s_waitcnt vmcnt(14)
  global_load_dwordx2 v[16:17], v2, s[58:59] sc1
  global_load_dwordx2 v[18:19], v9, s[58:59] sc1
  v_mfma_f32_16x16x32_bf16 v[32:35], v[144:147], a[128:131], v[32:35]
  s_add_u32 s27, s26, 78848
  buffer_load_dwordx4 v[228:231], v3, s[12:15], s27 offen offset:0 sc1
  v_mfma_f32_16x16x32_bf16 v[36:39], v[144:147], a[132:135], v[36:39]
  v_mfma_f32_16x16x32_bf16 v[40:43], v[144:147], a[136:139], v[40:43]
  v_mfma_f32_16x16x32_bf16 v[44:47], v[144:147], a[140:143], v[44:47]
  v_mfma_f32_16x16x32_bf16 v[48:51], v[148:151], a[128:131], v[48:51]
  buffer_load_dwordx4 v[232:235], v3, s[12:15], s27 offen offset:1024 sc1
  v_mfma_f32_16x16x32_bf16 v[52:55], v[148:151], a[132:135], v[52:55]
  v_mfma_f32_16x16x32_bf16 v[56:59], v[148:151], a[136:139], v[56:59]
  v_mfma_f32_16x16x32_bf16 v[60:63], v[148:151], a[140:143], v[60:63]
  v_mfma_f32_16x16x32_bf16 v[64:67], v[152:155], a[128:131], v[64:67]
  buffer_load_dwordx4 v[236:239], v3, s[12:15], s27 offen offset:2048 sc1
  v_mfma_f32_16x16x32_bf16 v[68:71], v[152:155], a[132:135], v[68:71]
  v_mfma_f32_16x16x32_bf16 v[72:75], v[152:155], a[136:139], v[72:75]
  v_mfma_f32_16x16x32_bf16 v[76:79], v[152:155], a[140:143], v[76:79]
  v_mfma_f32_16x16x32_bf16 v[80:83], v[156:159], a[128:131], v[80:83]
  buffer_load_dwordx4 v[240:243], v3, s[12:15], s27 offen offset:3072 sc1
  v_mfma_f32_16x16x32_bf16 v[84:87], v[156:159], a[132:135], v[84:87]
  v_mfma_f32_16x16x32_bf16 v[88:91], v[156:159], a[136:139], v[88:91]
  v_mfma_f32_16x16x32_bf16 v[92:95], v[156:159], a[140:143], v[92:95]
  v_mfma_f32_16x16x32_bf16 v[96:99], v[160:163], a[128:131], v[96:99]
  buffer_load_dwordx4 v[244:247], v4, s[12:15], s27 offen offset:0 sc1
  v_mfma_f32_16x16x32_bf16 v[100:103], v[160:163], a[132:135], v[100:103]
  v_mfma_f32_16x16x32_bf16 v[104:107], v[160:163], a[136:139], v[104:107]
  v_mfma_f32_16x16x32_bf16 v[108:111], v[160:163], a[140:143], v[108:111]
  v_mfma_f32_16x16x32_bf16 v[112:115], v[164:167], a[128:131], v[112:115]
  buffer_load_dwordx4 v[248:251], v4, s[12:15], s27 offen offset:1024 sc1
  v_mfma_f32_16x16x32_bf16 v[116:119], v[164:167], a[132:135], v[116:119]
  v_mfma_f32_16x16x32_bf16 v[120:123], v[164:167], a[136:139], v[120:123]
  v_mfma_f32_16x16x32_bf16 v[124:127], v[164:167], a[140:143], v[124:127]
  v_mfma_f32_16x16x32_bf16 v[128:131], v[168:171], a[128:131], v[128:131]
  buffer_load_dwordx4 v[252:255], v4, s[12:15], s27 offen offset:2048 sc1
  v_mfma_f32_16x16x32_bf16 v[132:135], v[168:171], a[132:135], v[132:135]
  v_mfma_f32_16x16x32_bf16 v[136:139], v[168:171], a[136:139], v[136:139]
  v_mfma_f32_16x16x32_bf16 v[140:143], v[168:171], a[140:143], v[140:143]
  s_waitcnt vmcnt(16)
  s_add_u32 s24, s26, 107520
  buffer_load_dword v30, v31, s[12:15], s24 offen sc1
  v_mfma_f32_16x16x32_bf16 v[32:35], v[172:175], a[144:147], v[32:35]
  s_add_u32 s27, s26, 86016
  buffer_load_dwordx4 v[144:147], v3, s[12:15], s27 offen offset:0 sc1
  v_mfma_f32_16x16x32_bf16 v[36:39], v[172:175], a[148:151], v[36:39]
  v_mfma_f32_16x16x32_bf16 v[40:43], v[172:175], a[152:155], v[40:43]
  v_mfma_f32_16x16x32_bf16 v[44:47], v[172:175], a[156:159], v[44:47]
  v_mfma_f32_16x16x32_bf16 v[48:51], v[176:179], a[144:147], v[48:51]
  buffer_load_dwordx4 v[148:151], v3, s[12:15], s27 offen offset:1024 sc1
  v_mfma_f32_16x16x32_bf16 v[52:55], v[176:179], a[148:151], v[52:55]
  v_mfma_f32_16x16x32_bf16 v[56:59], v[176:179], a[152:155], v[56:59]
  v_mfma_f32_16x16x32_bf16 v[60:63], v[176:179], a[156:159], v[60:63]
  v_mfma_f32_16x16x32_bf16 v[64:67], v[180:183], a[144:147], v[64:67]
  buffer_load_dwordx4 v[152:155], v3, s[12:15], s27 offen offset:2048 sc1
  v_mfma_f32_16x16x32_bf16 v[68:71], v[180:183], a[148:151], v[68:71]
  v_mfma_f32_16x16x32_bf16 v[72:75], v[180:183], a[152:155], v[72:75]
  v_mfma_f32_16x16x32_bf16 v[76:79], v[180:183], a[156:159], v[76:79]
  v_mfma_f32_16x16x32_bf16 v[80:83], v[184:187], a[144:147], v[80:83]
  buffer_load_dwordx4 v[156:159], v3, s[12:15], s27 offen offset:3072 sc1
  v_mfma_f32_16x16x32_bf16 v[84:87], v[184:187], a[148:151], v[84:87]
  v_mfma_f32_16x16x32_bf16 v[88:91], v[184:187], a[152:155], v[88:91]
  v_mfma_f32_16x16x32_bf16 v[92:95], v[184:187], a[156:159], v[92:95]
  v_mfma_f32_16x16x32_bf16 v[96:99], v[188:191], a[144:147], v[96:99]
  buffer_load_dwordx4 v[160:163], v4, s[12:15], s27 offen offset:0 sc1
  v_mfma_f32_16x16x32_bf16 v[100:103], v[188:191], a[148:151], v[100:103]
  v_mfma_f32_16x16x32_bf16 v[104:107], v[188:191], a[152:155], v[104:107]
  v_mfma_f32_16x16x32_bf16 v[108:111], v[188:191], a[156:159], v[108:111]
  v_mfma_f32_16x16x32_bf16 v[112:115], v[192:195], a[144:147], v[112:115]
  buffer_load_dwordx4 v[164:167], v4, s[12:15], s27 offen offset:1024 sc1
  v_mfma_f32_16x16x32_bf16 v[116:119], v[192:195], a[148:151], v[116:119]
  v_mfma_f32_16x16x32_bf16 v[120:123], v[192:195], a[152:155], v[120:123]
  v_mfma_f32_16x16x32_bf16 v[124:127], v[192:195], a[156:159], v[124:127]
  v_mfma_f32_16x16x32_bf16 v[128:131], v[196:199], a[144:147], v[128:131]
  buffer_load_dwordx4 v[168:171], v4, s[12:15], s27 offen offset:2048 sc1
  v_mfma_f32_16x16x32_bf16 v[132:135], v[196:199], a[148:151], v[132:135]
  v_mfma_f32_16x16x32_bf16 v[136:139], v[196:199], a[152:155], v[136:139]
  v_mfma_f32_16x16x32_bf16 v[140:143], v[196:199], a[156:159], v[140:143]
  s_waitcnt vmcnt(17)
  v_mfma_f32_16x16x32_bf16 v[32:35], v[200:203], a[160:163], v[32:35]
  s_add_u32 s27, s26, 93184
  buffer_load_dwordx4 v[172:175], v3, s[12:15], s27 offen offset:0 sc1
  v_mfma_f32_16x16x32_bf16 v[36:39], v[200:203], a[164:167], v[36:39]
  v_mfma_f32_16x16x32_bf16 v[40:43], v[200:203], a[168:171], v[40:43]
  v_mfma_f32_16x16x32_bf16 v[44:47], v[200:203], a[172:175], v[44:47]
  v_mfma_f32_16x16x32_bf16 v[48:51], v[204:207], a[160:163], v[48:51]
  buffer_load_dwordx4 v[176:179], v3, s[12:15], s27 offen offset:1024 sc1
  v_mfma_f32_16x16x32_bf16 v[52:55], v[204:207], a[164:167], v[52:55]
  v_mfma_f32_16x16x32_bf16 v[56:59], v[204:207], a[168:171], v[56:59]
  v_mfma_f32_16x16x32_bf16 v[60:63], v[204:207], a[172:175], v[60:63]
  v_mfma_f32_16x16x32_bf16 v[64:67], v[208:211], a[160:163], v[64:67]
  buffer_load_dwordx4 v[180:183], v3, s[12:15], s27 offen offset:2048 sc1
  v_mfma_f32_16x16x32_bf16 v[68:71], v[208:211], a[164:167], v[68:71]
  v_mfma_f32_16x16x32_bf16 v[72:75], v[208:211], a[168:171], v[72:75]
  v_mfma_f32_16x16x32_bf16 v[76:79], v[208:211], a[172:175], v[76:79]
  v_mfma_f32_16x16x32_bf16 v[80:83], v[212:215], a[160:163], v[80:83]
  buffer_load_dwordx4 v[184:187], v3, s[12:15], s27 offen offset:3072 sc1
  v_mfma_f32_16x16x32_bf16 v[84:87], v[212:215], a[164:167], v[84:87]
  v_mfma_f32_16x16x32_bf16 v[88:91], v[212:215], a[168:171], v[88:91]
  v_mfma_f32_16x16x32_bf16 v[92:95], v[212:215], a[172:175], v[92:95]
  v_mfma_f32_16x16x32_bf16 v[96:99], v[216:219], a[160:163], v[96:99]
  buffer_load_dwordx4 v[188:191], v4, s[12:15], s27 offen offset:0 sc1
  v_mfma_f32_16x16x32_bf16 v[100:103], v[216:219], a[164:167], v[100:103]
  v_mfma_f32_16x16x32_bf16 v[104:107], v[216:219], a[168:171], v[104:107]
  v_mfma_f32_16x16x32_bf16 v[108:111], v[216:219], a[172:175], v[108:111]
  v_mfma_f32_16x16x32_bf16 v[112:115], v[220:223], a[160:163], v[112:115]
  buffer_load_dwordx4 v[192:195], v4, s[12:15], s27 offen offset:1024 sc1
  v_mfma_f32_16x16x32_bf16 v[116:119], v[220:223], a[164:167], v[116:119]
  v_mfma_f32_16x16x32_bf16 v[120:123], v[220:223], a[168:171], v[120:123]
  v_mfma_f32_16x16x32_bf16 v[124:127], v[220:223], a[172:175], v[124:127]
  v_mfma_f32_16x16x32_bf16 v[128:131], v[224:227], a[160:163], v[128:131]
  buffer_load_dwordx4 v[196:199], v4, s[12:15], s27 offen offset:2048 sc1
  v_mfma_f32_16x16x32_bf16 v[132:135], v[224:227], a[164:167], v[132:135]
  v_mfma_f32_16x16x32_bf16 v[136:139], v[224:227], a[168:171], v[136:139]
  v_mfma_f32_16x16x32_bf16 v[140:143], v[224:227], a[172:175], v[140:143]
  s_waitcnt vmcnt(15)
  v_mfma_f32_16x16x32_bf16 v[32:35], v[228:231], a[176:179], v[32:35]
  s_add_u32 s27, s26, 100352
  buffer_load_dwordx4 v[200:203], v3, s[12:15], s27 offen offset:0 sc1
  v_mfma_f32_16x16x32_bf16 v[36:39], v[228:231], a[180:183], v[36:39]
  v_mfma_f32_16x16x32_bf16 v[40:43], v[228:231], a[184:187], v[40:43]
  v_mfma_f32_16x16x32_bf16 v[44:47], v[228:231], a[188:191], v[44:47]
  v_mfma_f32_16x16x32_bf16 v[48:51], v[232:235], a[176:179], v[48:51]
  buffer_load_dwordx4 v[204:207], v3, s[12:15], s27 offen offset:1024 sc1
  v_mfma_f32_16x16x32_bf16 v[52:55], v[232:235], a[180:183], v[52:55]
  v_mfma_f32_16x16x32_bf16 v[56:59], v[232:235], a[184:187], v[56:59]
  v_mfma_f32_16x16x32_bf16 v[60:63], v[232:235], a[188:191], v[60:63]
  v_mfma_f32_16x16x32_bf16 v[64:67], v[236:239], a[176:179], v[64:67]
  buffer_load_dwordx4 v[208:211], v3, s[12:15], s27 offen offset:2048 sc1
  v_mfma_f32_16x16x32_bf16 v[68:71], v[236:239], a[180:183], v[68:71]
  v_mfma_f32_16x16x32_bf16 v[72:75], v[236:239], a[184:187], v[72:75]
  v_mfma_f32_16x16x32_bf16 v[76:79], v[236:239], a[188:191], v[76:79]
  v_mfma_f32_16x16x32_bf16 v[80:83], v[240:243], a[176:179], v[80:83]
  buffer_load_dwordx4 v[212:215], v3, s[12:15], s27 offen offset:3072 sc1
  v_mfma_f32_16x16x32_bf16 v[84:87], v[240:243], a[180:183], v[84:87]
  v_mfma_f32_16x16x32_bf16 v[88:91], v[240:243], a[184:187], v[88:91]
  v_mfma_f32_16x16x32_bf16 v[92:95], v[240:243], a[188:191], v[92:95]
  v_mfma_f32_16x16x32_bf16 v[96:99], v[244:247], a[176:179], v[96:99]
  buffer_load_dwordx4 v[216:219], v4, s[12:15], s27 offen offset:0 sc1
  v_mfma_f32_16x16x32_bf16 v[100:103], v[244:247], a[180:183], v[100:103]
  v_mfma_f32_16x16x32_bf16 v[104:107], v[244:247], a[184:187], v[104:107]
  v_mfma_f32_16x16x32_bf16 v[108:111], v[244:247], a[188:191], v[108:111]
  v_mfma_f32_16x16x32_bf16 v[112:115], v[248:251], a[176:179], v[112:115]
  buffer_load_dwordx4 v[220:223], v4, s[12:15], s27 offen offset:1024 sc1
  v_mfma_f32_16x16x32_bf16 v[116:119], v[248:251], a[180:183], v[116:119]
  v_mfma_f32_16x16x32_bf16 v[120:123], v[248:251], a[184:187], v[120:123]
  v_mfma_f32_16x16x32_bf16 v[124:127], v[248:251], a[188:191], v[124:127]
  v_mfma_f32_16x16x32_bf16 v[128:131], v[252:255], a[176:179], v[128:131]
  buffer_load_dwordx4 v[224:227], v4, s[12:15], s27 offen offset:2048 sc1
  v_mfma_f32_16x16x32_bf16 v[132:135], v[252:255], a[180:183], v[132:135]
  v_mfma_f32_16x16x32_bf16 v[136:139], v[252:255], a[184:187], v[136:139]
  v_mfma_f32_16x16x32_bf16 v[140:143], v[252:255], a[188:191], v[140:143]
  s_waitcnt vmcnt(14)
  v_xor_b32 v16, s76, v16
  v_xor_b32 v17, s77, v17
  v_xor_b32 v18, s76, v18
  v_xor_b32 v19, s77, v19
  v_or3_b32 v16, v16, v17, v18
  v_or_b32 v16, v16, v19
  v_cmp_eq_u32 vcc, 0, v16
  s_nop 1
  s_cmp_eq_u64 vcc, exec
  s_cbranch_scc1 mega_qallok
  s_mov_b32 s33, 0
mega_qallloop:
  global_load_dwordx2 v[16:17], v2, s[58:59] sc1
  global_load_dwordx2 v[18:19], v9, s[58:59] sc1
  s_add_u32 s33, s33, 1
  s_waitcnt vmcnt(0)
  v_xor_b32 v16, s76, v16
  v_xor_b32 v17, s77, v17
  v_xor_b32 v18, s76, v18
  v_xor_b32 v19, s77, v19
  v_or3_b32 v16, v16, v17, v18
  v_or_b32 v16, v16, v19
  v_cmp_eq_u32 vcc, 0, v16
  s_nop 1
  s_cmp_eq_u64 vcc, exec
  s_cbranch_scc1 mega_qallok
  s_sleep 2
  s_cmp_lt_u32 s33, 0x20000
  s_cbranch_scc1 mega_qallloop
mega_qallok:
  v_mfma_f32_16x16x32_bf16 v[32:35], v[144:147], a[192:195], v[32:35]
  s_add_u32 s27, s26, 107520
  buffer_load_dwordx4 v[228:231], v3, s[12:15], s27 offen offset:0 sc1
  v_mfma_f32_16x16x32_bf16 v[36:39], v[144:147], a[196:199], v[36:39]
  v_mfma_f32_16x16x32_bf16 v[40:43], v[144:147], a[200:203], v[40:43]
  v_mfma_f32_16x16x32_bf16 v[44:47], v[144:147], a[204:207], v[44:47]
  v_mfma_f32_16x16x32_bf16 v[48:51], v[148:151], a[192:195], v[48:51]
  buffer_load_dwordx4 v[232:235], v3, s[12:15], s27 offen offset:1024 sc1
  v_mfma_f32_16x16x32_bf16 v[52:55], v[148:151], a[196:199], v[52:55]
  v_mfma_f32_16x16x32_bf16 v[56:59], v[148:151], a[200:203], v[56:59]
  v_mfma_f32_16x16x32_bf16 v[60:63], v[148:151], a[204:207], v[60:63]
  v_mfma_f32_16x16x32_bf16 v[64:67], v[152:155], a[192:195], v[64:67]
  buffer_load_dwordx4 v[236:239], v3, s[12:15], s27 offen offset:2048 sc1
  v_mfma_f32_16x16x32_bf16 v[68:71], v[152:155], a[196:199], v[68:71]
  v_mfma_f32_16x16x32_bf16 v[72:75], v[152:155], a[200:203], v[72:75]
  v_mfma_f32_16x16x32_bf16 v[76:79], v[152:155], a[204:207], v[76:79]
  v_mfma_f32_16x16x32_bf16 v[80:83], v[156:159], a[192:195], v[80:83]
  buffer_load_dwordx4 v[240:243], v3, s[12:15], s27 offen offset:3072 sc1
  v_mfma_f32_16x16x32_bf16 v[84:87], v[156:159], a[196:199], v[84:87]
  v_mfma_f32_16x16x32_bf16 v[88:91], v[156:159], a[200:203], v[88:91]
  v_mfma_f32_16x16x32_bf16 v[92:95], v[156:159], a[204:207], v[92:95]
  v_mfma_f32_16x16x32_bf16 v[96:99], v[160:163], a[192:195], v[96:99]
  buffer_load_dwordx4 v[244:247], v4, s[12:15], s27 offen offset:0 sc1
  v_mfma_f32_16x16x32_bf16 v[100:103], v[160:163], a[196:199], v[100:103]
  v_mfma_f32_16x16x32_bf16 v[104:107], v[160:163], a[200:203], v[104:107]
  v_mfma_f32_16x16x32_bf16 v[108:111], v[160:163], a[204:207], v[108:111]
  v_mfma_f32_16x16x32_bf16 v[112:115], v[164:167], a[192:195], v[112:115]
  buffer_load_dwordx4 v[248:251], v4, s[12:15], s27 offen offset:1024 sc1
  v_mfma_f32_16x16x32_bf16 v[116:119], v[164:167], a[196:199], v[116:119]
  v_mfma_f32_16x16x32_bf16 v[120:123], v[164:167], a[200:203], v[120:123]
  v_mfma_f32_16x16x32_bf16 v[124:127], v[164:167], a[204:207], v[124:127]
  v_mfma_f32_16x16x32_bf16 v[128:131], v[168:171], a[192:195], v[128:131]
  buffer_load_dwordx4 v[252:255], v4, s[12:15], s27 offen offset:2048 sc1
  v_mfma_f32_16x16x32_bf16 v[132:135], v[168:171], a[196:199], v[132:135]
  v_mfma_f32_16x16x32_bf16 v[136:139], v[168:171], a[200:203], v[136:139]
  v_mfma_f32_16x16x32_bf16 v[140:143], v[168:171], a[204:207], v[140:143]
  s_waitcnt vmcnt(14)
  s_mul_i32 s23, s3, 21504
  v_add_u32 v9, s23, v3
  v_mfma_f32_16x16x32_bf16 v[32:35], v[172:175], a[208:211], v[32:35]
  v_mfma_f32_16x16x32_bf16 v[36:39], v[172:175], a[212:215], v[36:39]
  v_mfma_f32_16x16x32_bf16 v[40:43], v[172:175], a[216:219], v[40:43]
  buffer_load_dwordx2 v[16:17], v10, s[64:67], 0 offen offset:0 sc1
  v_mfma_f32_16x16x32_bf16 v[44:47], v[172:175], a[220:223], v[44:47]
  v_mfma_f32_16x16x32_bf16 v[48:51], v[176:179], a[208:211], v[48:51]
  v_mfma_f32_16x16x32_bf16 v[52:55], v[176:179], a[212:215], v[52:55]
  v_mfma_f32_16x16x32_bf16 v[56:59], v[176:179], a[216:219], v[56:59]
  buffer_load_dwordx2 v[18:19], v10, s[64:67], 0 offen offset:512 sc1
  v_mfma_f32_16x16x32_bf16 v[60:63], v[176:179], a[220:223], v[60:63]
  v_mfma_f32_16x16x32_bf16 v[64:67], v[180:183], a[208:211], v[64:67]
  v_mfma_f32_16x16x32_bf16 v[68:71], v[180:183], a[212:215], v[68:71]
  v_mfma_f32_16x16x32_bf16 v[72:75], v[180:183], a[216:219], v[72:75]
  buffer_load_dwordx2 v[20:21], v10, s[64:67], 0 offen offset:1024 sc1
  v_mfma_f32_16x16x32_bf16 v[76:79], v[180:183], a[220:223], v[76:79]
  v_mfma_f32_16x16x32_bf16 v[80:83], v[184:187], a[208:211], v[80:83]
  v_mfma_f32_16x16x32_bf16 v[84:87], v[184:187], a[212:215], v[84:87]
  v_mfma_f32_16x16x32_bf16 v[88:91], v[184:187], a[216:219], v[88:91]
  buffer_load_dwordx2 v[22:23], v10, s[64:67], 0 offen offset:1536 sc1
  v_mfma_f32_16x16x32_bf16 v[92:95], v[184:187], a[220:223], v[92:95]
  v_mfma_f32_16x16x32_bf16 v[96:99], v[188:191], a[208:211], v[96:99]
  v_mfma_f32_16x16x32_bf16 v[100:103], v[188:191], a[212:215], v[100:103]
  v_mfma_f32_16x16x32_bf16 v[104:107], v[188:191], a[216:219], v[104:107]
  buffer_load_dwordx2 v[24:25], v10, s[64:67], 0 offen offset:2048 sc1
  v_mfma_f32_16x16x32_bf16 v[108:111], v[188:191], a[220:223], v[108:111]
  v_mfma_f32_16x16x32_bf16 v[112:115], v[192:195], a[208:211], v[112:115]
  v_mfma_f32_16x16x32_bf16 v[116:119], v[192:195], a[212:215], v[116:119]
  v_mfma_f32_16x16x32_bf16 v[120:123], v[192:195], a[216:219], v[120:123]
  buffer_load_dwordx2 v[26:27], v10, s[64:67], 0 offen offset:2560 sc1
  v_mfma_f32_16x16x32_bf16 v[124:127], v[192:195], a[220:223], v[124:127]
  v_mfma_f32_16x16x32_bf16 v[128:131], v[196:199], a[208:211], v[128:131]
  v_mfma_f32_16x16x32_bf16 v[132:135], v[196:199], a[212:215], v[132:135]
  v_mfma_f32_16x16x32_bf16 v[136:139], v[196:199], a[216:219], v[136:139]
  buffer_load_dwordx2 v[28:29], v10, s[64:67], 0 offen offset:3072 sc1
  v_mfma_f32_16x16x32_bf16 v[140:143], v[196:199], a[220:223], v[140:143]
  s_waitcnt vmcnt(14)
  v_mfma_f32_16x16x32_bf16 v[32:35], v[200:203], a[224:227], v[32:35]
  v_mfma_f32_16x16x32_bf16 v[36:39], v[200:203], a[228:231], v[36:39]
  v_mfma_f32_16x16x32_bf16 v[40:43], v[200:203], a[232:235], v[40:43]
  global_load_ushort v30, v11, s[48:49]
  v_mfma_f32_16x16x32_bf16 v[44:47], v[200:203], a[236:239], v[44:47]
  v_mfma_f32_16x16x32_bf16 v[48:51], v[204:207], a[224:227], v[48:51]
  v_mfma_f32_16x16x32_bf16 v[52:55], v[204:207], a[228:231], v[52:55]
  v_mfma_f32_16x16x32_bf16 v[56:59], v[204:207], a[232:235], v[56:59]
  global_load_dword v31, v15, s[58:59] sc1
  v_mfma_f32_16x16x32_bf16 v[60:63], v[204:207], a[236:239], v[60:63]
  v_mfma_f32_16x16x32_bf16 v[64:67], v[208:211], a[224:227], v[64:67]
  v_mfma_f32_16x16x32_bf16 v[68:71], v[208:211], a[228:231], v[68:71]
  v_mfma_f32_16x16x32_bf16 v[72:75], v[208:211], a[232:235], v[72:75]
  s_add_u32 s30, s28, 0
  buffer_load_dwordx4 a[0:3], v3, s[8:11], s30 offen offset:0 sc1
  v_mfma_f32_16x16x32_bf16 v[76:79], v[208:211], a[236:239], v[76:79]
  v_mfma_f32_16x16x32_bf16 v[80:83], v[212:215], a[224:227], v[80:83]
  v_mfma_f32_16x16x32_bf16 v[84:87], v[212:215], a[228:231], v[84:87]
  v_mfma_f32_16x16x32_bf16 v[88:91], v[212:215], a[232:235], v[88:91]
  buffer_load_dwordx4 a[4:7], v3, s[8:11], s30 offen offset:1024 sc1
  v_mfma_f32_16x16x32_bf16 v[92:95], v[212:215], a[236:239], v[92:95]
  v_mfma_f32_16x16x32_bf16 v[96:99], v[216:219], a[224:227], v[96:99]
  v_mfma_f32_16x16x32_bf16 v[100:103], v[216:219], a[228:231], v[100:103]
  v_mfma_f32_16x16x32_bf16 v[104:107], v[216:219], a[232:235], v[104:107]
  buffer_load_dwordx4 a[8:11], v3, s[8:11], s30 offen offset:2048 sc1
  v_mfma_f32_16x16x32_bf16 v[108:111], v[216:219], a[236:239], v[108:111]
  v_mfma_f32_16x16x32_bf16 v[112:115], v[220:223], a[224:227], v[112:115]
  v_mfma_f32_16x16x32_bf16 v[116:119], v[220:223], a[228:231], v[116:119]
  v_mfma_f32_16x16x32_bf16 v[120:123], v[220:223], a[232:235], v[120:123]
  buffer_load_dwordx4 a[12:15], v3, s[8:11], s30 offen offset:3072 sc1
  v_mfma_f32_16x16x32_bf16 v[124:127], v[220:223], a[236:239], v[124:127]
  v_mfma_f32_16x16x32_bf16 v[128:131], v[224:227], a[224:227], v[128:131]
  v_mfma_f32_16x16x32_bf16 v[132:135], v[224:227], a[228:231], v[132:135]
  v_mfma_f32_16x16x32_bf16 v[136:139], v[224:227], a[232:235], v[136:139]
  s_add_u32 s30, s28, 4096
  buffer_load_dwordx4 a[16:19], v3, s[8:11], s30 offen offset:0 sc1
  v_mfma_f32_16x16x32_bf16 v[140:143], v[224:227], a[236:239], v[140:143]
  s_waitcnt vmcnt(14)
  v_mfma_f32_16x16x32_bf16 v[32:35], v[228:231], a[240:243], v[32:35]
  v_mfma_f32_16x16x32_bf16 v[36:39], v[228:231], a[244:247], v[36:39]
  v_mfma_f32_16x16x32_bf16 v[40:43], v[228:231], a[248:251], v[40:43]
  buffer_load_dwordx4 a[20:23], v3, s[8:11], s30 offen offset:1024 sc1
  v_mfma_f32_16x16x32_bf16 v[44:47], v[228:231], a[252:255], v[44:47]
  v_mfma_f32_16x16x32_bf16 v[48:51], v[232:235], a[240:243], v[48:51]
  v_mfma_f32_16x16x32_bf16 v[52:55], v[232:235], a[244:247], v[52:55]
  v_mfma_f32_16x16x32_bf16 v[56:59], v[232:235], a[248:251], v[56:59]
  buffer_load_dwordx4 a[24:27], v3, s[8:11], s30 offen offset:2048 sc1
  v_mfma_f32_16x16x32_bf16 v[60:63], v[232:235], a[252:255], v[60:63]
  v_mfma_f32_16x16x32_bf16 v[64:67], v[236:239], a[240:243], v[64:67]
  v_mfma_f32_16x16x32_bf16 v[68:71], v[236:239], a[244:247], v[68:71]
  v_mfma_f32_16x16x32_bf16 v[72:75], v[236:239], a[248:251], v[72:75]
  buffer_load_dwordx4 a[28:31], v3, s[8:11], s30 offen offset:3072 sc1
  v_mfma_f32_16x16x32_bf16 v[76:79], v[236:239], a[252:255], v[76:79]
  v_mfma_f32_16x16x32_bf16 v[80:83], v[240:243], a[240:243], v[80:83]
  v_mfma_f32_16x16x32_bf16 v[84:87], v[240:243], a[244:247], v[84:87]
  v_mfma_f32_16x16x32_bf16 v[88:91], v[240:243], a[248:251], v[88:91]
  s_add_u32 s30, s28, 8192
  buffer_load_dwordx4 a[32:35], v3, s[8:11], s30 offen offset:0 sc1
  v_mfma_f32_16x16x32_bf16 v[92:95], v[240:243], a[252:255], v[92:95]
  v_mfma_f32_16x16x32_bf16 v[96:99], v[244:247], a[240:243], v[96:99]
  v_mfma_f32_16x16x32_bf16 v[100:103], v[244:247], a[244:247], v[100:103]
  v_mfma_f32_16x16x32_bf16 v[104:107], v[244:247], a[248:251], v[104:107]
  buffer_load_dwordx4 a[36:39], v3, s[8:11], s30 offen offset:1024 sc1
  v_mfma_f32_16x16x32_bf16 v[108:111], v[244:247], a[252:255], v[108:111]
  v_mfma_f32_16x16x32_bf16 v[112:115], v[248:251], a[240:243], v[112:115]
  v_mfma_f32_16x16x32_bf16 v[116:119], v[248:251], a[244:247], v[116:119]
  v_mfma_f32_16x16x32_bf16 v[120:123], v[248:251], a[248:251], v[120:123]
  buffer_load_dwordx4 a[40:43], v3, s[8:11], s30 offen offset:2048 sc1
  v_mfma_f32_16x16x32_bf16 v[124:127], v[248:251], a[252:255], v[124:127]
  v_mfma_f32_16x16x32_bf16 v[128:131], v[252:255], a[240:243], v[128:131]
  v_mfma_f32_16x16x32_bf16 v[132:135], v[252:255], a[244:247], v[132:135]
  v_mfma_f32_16x16x32_bf16 v[136:139], v[252:255], a[248:251], v[136:139]
  buffer_load_dwordx4 a[44:47], v3, s[8:11], s30 offen offset:3072 sc1
  v_mfma_f32_16x16x32_bf16 v[140:143], v[252:255], a[252:255], v[140:143]
mega_p2:
  s_xor_b32 s24, s3, 1
  s_mul_i32 s24, s24, 21504
  s_add_u32 s24, s24, 0
  v_add_u32 v10, s24, v3
  s_xor_b32 s24, s3, 2
  s_mul_i32 s24, s24, 21504
  s_add_u32 s24, s24, 7168
  v_add_u32 v11, s24, v3
  s_xor_b32 s24, s3, 3
  s_mul_i32 s24, s24, 21504
  s_add_u32 s24, s24, 14336
  v_add_u32 v15, s24, v3
  ds_write_b128 v9, v[36:39] offset:0
  ds_write_b128 v9, v[40:43] offset:7168
  s_add_u32 s30, s28, 12288
  buffer_load_dwordx4 a[48:51], v3, s[8:11], s30 offen offset:0 sc1
  ds_write_b128 v9, v[44:47] offset:14336
  ds_write_b128 v9, v[52:55] offset:1024
  ds_write_b128 v9, v[56:59] offset:8192
  ds_write_b128 v9, v[60:63] offset:15360
  ds_write_b128 v9, v[68:71] offset:2048
  buffer_load_dwordx4 a[52:55], v3, s[8:11], s30 offen offset:1024 sc1
  ds_write_b128 v9, v[72:75] offset:9216
  ds_write_b128 v9, v[76:79] offset:16384
  ds_write_b128 v9, v[84:87] offset:3072
  ds_write_b128 v9, v[88:91] offset:10240
  ds_write_b128 v9, v[92:95] offset:17408
  buffer_load_dwordx4 a[56:59], v3, s[8:11], s30 offen offset:2048 sc1
  ds_write_b128 v9, v[100:103] offset:4096
  ds_write_b128 v9, v[104:107] offset:11264
  ds_write_b128 v9, v[108:111] offset:18432
  ds_write_b128 v9, v[116:119] offset:5120
  ds_write_b128 v9, v[120:123] offset:12288
  buffer_load_dwordx4 a[60:63], v3, s[8:11], s30 offen offset:3072 sc1
  ds_write_b128 v9, v[124:127] offset:19456
  ds_write_b128 v9, v[132:135] offset:6144
  ds_write_b128 v9, v[136:139] offset:13312
  ds_write_b128 v9, v[140:143] offset:20480
  s_waitcnt lgkmcnt(0)
  s_barrier
  ds_read_b128 v[144:147], v10 offset:0
  s_add_u32 s32, s28, 0
  buffer_load_dwordx4 a[176:179], v5, s[16:19], s32 offen sc1
  ds_read_b128 v[148:151], v10 offset:1024
  ds_read_b128 v[152:155], v10 offset:2048
  ds_read_b128 v[156:159], v10 offset:3072
  ds_read_b128 v[160:163], v10 offset:4096
  ds_read_b128 v[164:167], v10 offset:5120
  buffer_load_dwordx4 a[180:183], v6, s[16:19], s32 offen sc1
  ds_read_b128 v[168:171], v10 offset:6144
  ds_read_b128 v[172:175], v11 offset:0
  ds_read_b128 v[176:179], v11 offset:1024
  ds_read_b128 v[180:183], v11 offset:2048
  ds_read_b128 v[184:187], v11 offset:3072
  buffer_load_dwordx4 a[184:187], v7, s[16:19], s32 offen sc1
  ds_read_b128 v[188:191], v11 offset:4096
  ds_read_b128 v[192:195], v11 offset:5120
  ds_read_b128 v[196:199], v11 offset:6144
  ds_read_b128 v[200:203], v15 offset:0
  ds_read_b128 v[204:207], v15 offset:1024
  buffer_load_dwordx4 a[188:191], v8, s[16:19], s32 offen sc1
  ds_read_b128 v[208:211], v15 offset:2048
  ds_read_b128 v[212:215], v15 offset:3072
  ds_read_b128 v[216:219], v15 offset:4096
  ds_read_b128 v[220:223], v15 offset:5120
  ds_read_b128 v[224:227], v15 offset:6144
  s_add_u32 s32, s28, 4096
  buffer_load_dwordx4 a[192:195], v5, s[16:19], s32 offen sc1
  s_waitcnt lgkmcnt(14)
  v_pk_add_f32 v[32:33], v[32:33], v[144:145]
  v_pk_add_f32 v[34:35], v[34:35], v[146:147]
  v_pk_add_f32 v[48:49], v[48:49], v[148:149]
  v_pk_add_f32 v[50:51], v[50:51], v[150:151]
  v_pk_add_f32 v[64:65], v[64:65], v[152:153]
  buffer_load_dwordx4 a[196:199], v6, s[16:19], s32 offen sc1
  v_pk_add_f32 v[66:67], v[66:67], v[154:155]
  v_pk_add_f32 v[80:81], v[80:81], v[156:157]
  v_pk_add_f32 v[82:83], v[82:83], v[158:159]
  v_pk_add_f32 v[96:97], v[96:97], v[160:161]
  v_pk_add_f32 v[98:99], v[98:99], v[162:163]
  buffer_load_dwordx4 a[200:203], v7, s[16:19], s32 offen sc1
  v_pk_add_f32 v[112:113], v[112:113], v[164:165]
  v_pk_add_f32 v[114:115], v[114:115], v[166:167]
  v_pk_add_f32 v[128:129], v[128:129], v[168:169]
  v_pk_add_f32 v[130:131], v[130:131], v[170:171]
  s_waitcnt lgkmcnt(7)
  v_pk_add_f32 v[32:33], v[32:33], v[172:173]
  buffer_load_dwordx4 a[204:207], v8, s[16:19], s32 offen sc1
  v_pk_add_f32 v[34:35], v[34:35], v[174:175]
  v_pk_add_f32 v[48:49], v[48:49], v[176:177]
  v_pk_add_f32 v[50:51], v[50:51], v[178:179]
  v_pk_add_f32 v[64:65], v[64:65], v[180:181]
  v_pk_add_f32 v[66:67], v[66:67], v[182:183]
  s_add_u32 s32, s28, 8192
  buffer_load_dwordx4 a[208:211], v5, s[16:19], s32 offen sc1
  v_pk_add_f32 v[80:81], v[80:81], v[184:185]
  v_pk_add_f32 v[82:83], v[82:83], v[186:187]
  v_pk_add_f32 v[96:97], v[96:97], v[188:189]
  v_pk_add_f32 v[98:99], v[98:99], v[190:191]
  v_pk_add_f32 v[112:113], v[112:113], v[192:193]
  buffer_load_dwordx4 a[212:215], v6, s[16:19], s32 offen sc1
  v_pk_add_f32 v[114:115], v[114:115], v[194:195]
  v_pk_add_f32 v[128:129], v[128:129], v[196:197]
  v_pk_add_f32 v[130:131], v[130:131], v[198:199]
  s_waitcnt lgkmcnt(0)
  v_pk_add_f32 v[32:33], v[32:33], v[200:201]
  v_pk_add_f32 v[34:35], v[34:35], v[202:203]
  buffer_load_dwordx4 a[216:219], v7, s[16:19], s32 offen sc1
  v_pk_add_f32 v[48:49], v[48:49], v[204:205]
  v_pk_add_f32 v[50:51], v[50:51], v[206:207]
  v_pk_add_f32 v[64:65], v[64:65], v[208:209]
  v_pk_add_f32 v[66:67], v[66:67], v[210:211]
  v_pk_add_f32 v[80:81], v[80:81], v[212:213]
  buffer_load_dwordx4 a[220:223], v8, s[16:19], s32 offen sc1
  v_pk_add_f32 v[82:83], v[82:83], v[214:215]
  v_pk_add_f32 v[96:97], v[96:97], v[216:217]
  v_pk_add_f32 v[98:99], v[98:99], v[218:219]
  v_pk_add_f32 v[112:113], v[112:113], v[220:221]
  v_pk_add_f32 v[114:115], v[114:115], v[222:223]
  s_add_u32 s32, s28, 12288
  buffer_load_dwordx4 a[224:227], v5, s[16:19], s32 offen sc1
  v_pk_add_f32 v[128:129], v[128:129], v[224:225]
  v_pk_add_f32 v[130:131], v[130:131], v[226:227]
  buffer_load_dwordx4 a[228:231], v6, s[16:19], s32 offen sc1
  buffer_load_dwordx4 a[232:235], v7, s[16:19], s32 offen sc1
  buffer_load_dwordx4 a[236:239], v8, s[16:19], s32 offen sc1
  s_waitcnt vmcnt(32)
  v_lshlrev_b32 v30, 16, v30
  v_sub_f32 v31, 1.0, v31
  v_mov_b32 v240, v30
  v_mov_b32 v241, v30
  v_mov_b32 v242, v31
  v_mov_b32 v243, v31
  v_lshlrev_b32 v244, 16, v16
  v_and_b32 v245, 0xffff0000, v16
  v_pk_add_f32 v[32:33], v[32:33], v[240:241]
  v_pk_mul_f32 v[244:245], v[244:245], v[242:243]
  v_pk_mul_f32 v[32:33], v[32:33], v[244:245]
  v_lshlrev_b32 v246, 16, v17
  v_and_b32 v247, 0xffff0000, v17
  v_pk_add_f32 v[34:35], v[34:35], v[240:241]
  v_pk_mul_f32 v[246:247], v[246:247], v[242:243]
  v_pk_mul_f32 v[34:35], v[34:35], v[246:247]
  v_cvt_pk_bf16_f32 v144, v32, v33
  v_cvt_pk_bf16_f32 v145, v34, v35
  v_lshlrev_b32 v244, 16, v18
  v_and_b32 v245, 0xffff0000, v18
  v_pk_add_f32 v[48:49], v[48:49], v[240:241]
  v_pk_mul_f32 v[244:245], v[244:245], v[242:243]
  v_pk_mul_f32 v[48:49], v[48:49], v[244:245]
  v_lshlrev_b32 v246, 16, v19
  v_and_b32 v247, 0xffff0000, v19
  v_pk_add_f32 v[50:51], v[50:51], v[240:241]
  v_pk_mul_f32 v[246:247], v[246:247], v[242:243]
  v_pk_mul_f32 v[50:51], v[50:51], v[246:247]
  v_cvt_pk_bf16_f32 v146, v48, v49
  v_cvt_pk_bf16_f32 v147, v50, v51
  v_lshlrev_b32 v244, 16, v20
  v_and_b32 v245, 0xffff0000, v20
  v_pk_add_f32 v[64:65], v[64:65], v[240:241]
  v_pk_mul_f32 v[244:245], v[244:245], v[242:243]
  v_pk_mul_f32 v[64:65], v[64:65], v[244:245]
  v_lshlrev_b32 v246, 16, v21
  v_and_b32 v247, 0xffff0000, v21
  v_pk_add_f32 v[66:67], v[66:67], v[240:241]
  v_pk_mul_f32 v[246:247], v[246:247], v[242:243]
  v_pk_mul_f32 v[66:67], v[66:67], v[246:247]
  v_cvt_pk_bf16_f32 v148, v64, v65
  v_cvt_pk_bf16_f32 v149, v66, v67
  v_lshlrev_b32 v244, 16, v22
  v_and_b32 v245, 0xffff0000, v22
  v_pk_add_f32 v[80:81], v[80:81], v[240:241]
  v_pk_mul_f32 v[244:245], v[244:245], v[242:243]
  v_pk_mul_f32 v[80:81], v[80:81], v[244:245]
  v_lshlrev_b32 v246, 16, v23
  v_and_b32 v247, 0xffff0000, v23
  v_pk_add_f32 v[82:83], v[82:83], v[240:241]
  v_pk_mul_f32 v[246:247], v[246:247], v[242:243]
  v_pk_mul_f32 v[82:83], v[82:83], v[246:247]
  v_cvt_pk_bf16_f32 v150, v80, v81
  v_cvt_pk_bf16_f32 v151, v82, v83
  v_lshlrev_b32 v244, 16, v24
  v_and_b32 v245, 0xffff0000, v24
  v_pk_add_f32 v[96:97], v[96:97], v[240:241]
  v_pk_mul_f32 v[244:245], v[244:245], v[242:243]
  v_pk_mul_f32 v[96:97], v[96:97], v[244:245]
  v_lshlrev_b32 v246, 16, v25
  v_and_b32 v247, 0xffff0000, v25
  v_pk_add_f32 v[98:99], v[98:99], v[240:241]
  v_pk_mul_f32 v[246:247], v[246:247], v[242:243]
  v_pk_mul_f32 v[98:99], v[98:99], v[246:247]
  v_cvt_pk_bf16_f32 v152, v96, v97
  v_cvt_pk_bf16_f32 v153, v98, v99
  v_lshlrev_b32 v244, 16, v26
  v_and_b32 v245, 0xffff0000, v26
  v_pk_add_f32 v[112:113], v[112:113], v[240:241]
  v_pk_mul_f32 v[244:245], v[244:245], v[242:243]
  v_pk_mul_f32 v[112:113], v[112:113], v[244:245]
  v_lshlrev_b32 v246, 16, v27
  v_and_b32 v247, 0xffff0000, v27
  v_pk_add_f32 v[114:115], v[114:115], v[240:241]
  v_pk_mul_f32 v[246:247], v[246:247], v[242:243]
  v_pk_mul_f32 v[114:115], v[114:115], v[246:247]
  v_cvt_pk_bf16_f32 v154, v112, v113
  v_cvt_pk_bf16_f32 v155, v114, v115
  v_lshlrev_b32 v244, 16, v28
  v_and_b32 v245, 0xffff0000, v28
  v_pk_add_f32 v[128:129], v[128:129], v[240:241]
  v_pk_mul_f32 v[244:245], v[244:245], v[242:243]
  v_pk_mul_f32 v[128:129], v[128:129], v[244:245]
  v_lshlrev_b32 v246, 16, v29
  v_and_b32 v247, 0xffff0000, v29
  v_pk_add_f32 v[130:131], v[130:131], v[240:241]
  v_pk_mul_f32 v[246:247], v[246:247], v[242:243]
  v_pk_mul_f32 v[130:131], v[130:131], v[246:247]
  v_cvt_pk_bf16_f32 v156, v128, v129
  v_cvt_pk_bf16_f32 v157, v130, v131
  s_waitcnt vmcnt(20)
  v_lshlrev_b32 v2, 3, v12
  s_mul_i32 s24, s21, 7
  s_lshr_b32 s33, s24, 1
  s_add_u32 s33, s33, 16
  s_lshl_b32 s33, s33, 12
  s_lshl_b32 s23, s3, 10
  s_add_u32 s33, s33, s23
  s_and_b32 s24, s24, 1
  s_cmp_eq_u32 s24, 0
  s_cbranch_scc0 mega_odd
  buffer_store_dwordx4 v[144:147], v3, s[16:19], s33 offen sc1
  s_add_u32 s33, s33, 4096
  buffer_store_dwordx4 v[148:151], v3, s[16:19], s33 offen sc1
  s_add_u32 s33, s33, 4096
  buffer_store_dwordx4 v[152:155], v3, s[16:19], s33 offen sc1
  s_add_u32 s33, s33, 4096
  buffer_store_dwordx2 v[156:157], v2, s[16:19], s33 offen sc1
  s_branch mega_hfin
mega_odd:
  buffer_store_dwordx2 v[144:145], v2, s[16:19], s33 offen offset:512 sc1
  s_add_u32 s33, s33, 4096
  buffer_store_dwordx4 v[146:149], v3, s[16:19], s33 offen sc1
  s_add_u32 s33, s33, 4096
  buffer_store_dwordx4 v[150:153], v3, s[16:19], s33 offen sc1
  s_add_u32 s33, s33, 4096
  buffer_store_dwordx4 v[154:157], v3, s[16:19], s33 offen sc1
mega_hfin:
  s_waitcnt vmcnt(16)
  v_mfma_f32_16x16x32_bf16 v[32:35], a[0:3], a[176:179], 0
  v_mfma_f32_16x16x32_bf16 v[48:51], a[4:7], a[176:179], 0
  s_add_u32 s30, s21, 0
  s_cmp_ge_u32 s30, 6
  s_cselect_b32 s31, 6, 0
  s_sub_u32 s30, s30, s31
  s_cmp_ge_u32 s30, 6
  s_cselect_b32 s31, 6, 0
  s_sub_u32 s30, s30, s31
  s_cmp_ge_u32 s30, 3
  s_addc_u32 s30, s30, 0
  s_lshl_b32 s30, s30, 12
  s_add_u32 s30, s30, s29
  buffer_load_dwordx4 a[64:67], v3, s[8:11], s30 offen offset:0 sc1
  v_mfma_f32_16x16x32_bf16 v[64:67], a[8:11], a[176:179], 0
  v_mfma_f32_16x16x32_bf16 v[80:83], a[12:15], a[176:179], 0
  v_mfma_f32_16x16x32_bf16 v[36:39], a[0:3], a[180:183], 0
  v_mfma_f32_16x16x32_bf16 v[52:55], a[4:7], a[180:183], 0
  buffer_load_dwordx4 a[68:71], v3, s[8:11], s30 offen offset:1024 sc1
  v_mfma_f32_16x16x32_bf16 v[68:71], a[8:11], a[180:183], 0
  v_mfma_f32_16x16x32_bf16 v[84:87], a[12:15], a[180:183], 0
  v_mfma_f32_16x16x32_bf16 v[40:43], a[0:3], a[184:187], 0
  v_mfma_f32_16x16x32_bf16 v[56:59], a[4:7], a[184:187], 0
  buffer_load_dwordx4 a[72:75], v3, s[8:11], s30 offen offset:2048 sc1
  v_mfma_f32_16x16x32_bf16 v[72:75], a[8:11], a[184:187], 0
  v_mfma_f32_16x16x32_bf16 v[88:91], a[12:15], a[184:187], 0
  v_mfma_f32_16x16x32_bf16 v[44:47], a[0:3], a[188:191], 0
  v_mfma_f32_16x16x32_bf16 v[60:63], a[4:7], a[188:191], 0
  buffer_load_dwordx4 a[76:79], v3, s[8:11], s30 offen offset:3072 sc1
  v_mfma_f32_16x16x32_bf16 v[76:79], a[8:11], a[188:191], 0
  v_mfma_f32_16x16x32_bf16 v[92:95], a[12:15], a[188:191], 0
  s_waitcnt vmcnt(16)
  v_mfma_f32_16x16x32_bf16 v[32:35], a[16:19], a[192:195], v[32:35]
  v_mfma_f32_16x16x32_bf16 v[48:51], a[20:23], a[192:195], v[48:51]
  s_add_u32 s30, s21, 1
  s_cmp_ge_u32 s30, 6
  s_cselect_b32 s31, 6, 0
  s_sub_u32 s30, s30, s31
  s_cmp_ge_u32 s30, 6
  s_cselect_b32 s31, 6, 0
  s_sub_u32 s30, s30, s31
  s_cmp_ge_u32 s30, 3
  s_addc_u32 s30, s30, 0
  s_lshl_b32 s30, s30, 12
  s_add_u32 s30, s30, s29
  buffer_load_dwordx4 a[80:83], v3, s[8:11], s30 offen offset:0 sc1
  v_mfma_f32_16x16x32_bf16 v[64:67], a[24:27], a[192:195], v[64:67]
  v_mfma_f32_16x16x32_bf16 v[80:83], a[28:31], a[192:195], v[80:83]
  v_mfma_f32_16x16x32_bf16 v[36:39], a[16:19], a[196:199], v[36:39]
  v_mfma_f32_16x16x32_bf16 v[52:55], a[20:23], a[196:199], v[52:55]
  buffer_load_dwordx4 a[84:87], v3, s[8:11], s30 offen offset:1024 sc1
  v_mfma_f32_16x16x32_bf16 v[68:71], a[24:27], a[196:199], v[68:71]
  v_mfma_f32_16x16x32_bf16 v[84:87], a[28:31], a[196:199], v[84:87]
  v_mfma_f32_16x16x32_bf16 v[40:43], a[16:19], a[200:203], v[40:43]
  v_mfma_f32_16x16x32_bf16 v[56:59], a[20:23], a[200:203], v[56:59]
  buffer_load_dwordx4 a[88:91], v3, s[8:11], s30 offen offset:2048 sc1
  v_mfma_f32_16x16x32_bf16 v[72:75], a[24:27], a[200:203], v[72:75]
  v_mfma_f32_16x16x32_bf16 v[88:91], a[28:31], a[200:203], v[88:91]
  v_mfma_f32_16x16x32_bf16 v[44:47], a[16:19], a[204:207], v[44:47]
  v_mfma_f32_16x16x32_bf16 v[60:63], a[20:23], a[204:207], v[60:63]
  buffer_load_dwordx4 a[92:95], v3, s[8:11], s30 offen offset:3072 sc1
  v_mfma_f32_16x16x32_bf16 v[76:79], a[24:27], a[204:207], v[76:79]
  v_mfma_f32_16x16x32_bf16 v[92:95], a[28:31], a[204:207], v[92:95]
  s_waitcnt vmcnt(16)
  v_mfma_f32_16x16x32_bf16 v[32:35], a[32:35], a[208:211], v[32:35]
  v_mfma_f32_16x16x32_bf16 v[48:51], a[36:39], a[208:211], v[48:51]
  s_add_u32 s30, s21, 2
  s_cmp_ge_u32 s30, 6
  s_cselect_b32 s31, 6, 0
  s_sub_u32 s30, s30, s31
  s_cmp_ge_u32 s30, 6
  s_cselect_b32 s31, 6, 0
  s_sub_u32 s30, s30, s31
  s_cmp_ge_u32 s30, 3
  s_addc_u32 s30, s30, 0
  s_lshl_b32 s30, s30, 12
  s_add_u32 s30, s30, s29
  buffer_load_dwordx4 a[96:99], v3, s[8:11], s30 offen offset:0 sc1
  v_mfma_f32_16x16x32_bf16 v[64:67], a[40:43], a[208:211], v[64:67]
  v_mfma_f32_16x16x32_bf16 v[80:83], a[44:47], a[208:211], v[80:83]
  v_mfma_f32_16x16x32_bf16 v[36:39], a[32:35], a[212:215], v[36:39]
  v_mfma_f32_16x16x32_bf16 v[52:55], a[36:39], a[212:215], v[52:55]
  buffer_load_dwordx4 a[100:103], v3, s[8:11], s30 offen offset:1024 sc1
  v_mfma_f32_16x16x32_bf16 v[68:71], a[40:43], a[212:215], v[68:71]
  v_mfma_f32_16x16x32_bf16 v[84:87], a[44:47], a[212:215], v[84:87]
  v_mfma_f32_16x16x32_bf16 v[40:43], a[32:35], a[216:219], v[40:43]
  v_mfma_f32_16x16x32_bf16 v[56:59], a[36:39], a[216:219], v[56:59]
  buffer_load_dwordx4 a[104:107], v3, s[8:11], s30 offen offset:2048 sc1
  v_mfma_f32_16x16x32_bf16 v[72:75], a[40:43], a[216:219], v[72:75]
  v_mfma_f32_16x16x32_bf16 v[88:91], a[44:47], a[216:219], v[88:91]
  v_mfma_f32_16x16x32_bf16 v[44:47], a[32:35], a[220:223], v[44:47]
  v_mfma_f32_16x16x32_bf16 v[60:63], a[36:39], a[220:223], v[60:63]
  buffer_load_dwordx4 a[108:111], v3, s[8:11], s30 offen offset:3072 sc1
  v_mfma_f32_16x16x32_bf16 v[76:79], a[40:43], a[220:223], v[76:79]
  v_mfma_f32_16x16x32_bf16 v[92:95], a[44:47], a[220:223], v[92:95]
  s_waitcnt vmcnt(16)
  v_mfma_f32_16x16x32_bf16 v[32:35], a[48:51], a[224:227], v[32:35]
  v_mfma_f32_16x16x32_bf16 v[48:51], a[52:55], a[224:227], v[48:51]
  s_add_u32 s30, s21, 3
  s_cmp_ge_u32 s30, 6
  s_cselect_b32 s31, 6, 0
  s_sub_u32 s30, s30, s31
  s_cmp_ge_u32 s30, 6
  s_cselect_b32 s31, 6, 0
  s_sub_u32 s30, s30, s31
  s_cmp_ge_u32 s30, 3
  s_addc_u32 s30, s30, 0
  s_lshl_b32 s30, s30, 12
  s_add_u32 s30, s30, s29
  buffer_load_dwordx4 a[112:115], v3, s[8:11], s30 offen offset:0 sc1
  v_mfma_f32_16x16x32_bf16 v[64:67], a[56:59], a[224:227], v[64:67]
  v_mfma_f32_16x16x32_bf16 v[80:83], a[60:63], a[224:227], v[80:83]
  v_mfma_f32_16x16x32_bf16 v[36:39], a[48:51], a[228:231], v[36:39]
  v_mfma_f32_16x16x32_bf16 v[52:55], a[52:55], a[228:231], v[52:55]
  buffer_load_dwordx4 a[116:119], v3, s[8:11], s30 offen offset:1024 sc1
  v_mfma_f32_16x16x32_bf16 v[68:71], a[56:59], a[228:231], v[68:71]
  v_mfma_f32_16x16x32_bf16 v[84:87], a[60:63], a[228:231], v[84:87]
  v_mfma_f32_16x16x32_bf16 v[40:43], a[48:51], a[232:235], v[40:43]
  v_mfma_f32_16x16x32_bf16 v[56:59], a[52:55], a[232:235], v[56:59]
  buffer_load_dwordx4 a[120:123], v3, s[8:11], s30 offen offset:2048 sc1
  v_mfma_f32_16x16x32_bf16 v[72:75], a[56:59], a[232:235], v[72:75]
  v_mfma_f32_16x16x32_bf16 v[88:91], a[60:63], a[232:235], v[88:91]
  v_mfma_f32_16x16x32_bf16 v[44:47], a[48:51], a[236:239], v[44:47]
  v_mfma_f32_16x16x32_bf16 v[60:63], a[52:55], a[236:239], v[60:63]
  buffer_load_dwordx4 a[124:127], v3, s[8:11], s30 offen offset:3072 sc1
  v_mfma_f32_16x16x32_bf16 v[76:79], a[56:59], a[236:239], v[76:79]
  v_mfma_f32_16x16x32_bf16 v[92:95], a[60:63], a[236:239], v[92:95]
  s_waitcnt vmcnt(16)
  s_barrier
  s_mul_i32 s27, s22, 4352
  s_lshl_b32 s26, s21, 3
  s_add_u32 s27, s27, s26
  s_add_u32 s27, s27, 15204352
  s_cmp_lg_u32 s3, 0
  s_cbranch_scc1 mega_sighd
  v_mov_b32 v18, s27
  v_mov_b32 v16, s76
  v_mov_b32 v17, s77
  s_mov_b64 s[34:35], exec
  s_mov_b64 exec, 1
  global_store_dwordx2 v18, v[16:17], s[58:59] sc1
  s_mov_b64 exec, s[34:35]
mega_sighd:
  s_cmp_eq_u32 s21, 7
  s_cbranch_scc1 mega_fin
  s_add_u32 s30, s21, 4
  s_cmp_ge_u32 s30, 6
  s_cselect_b32 s31, 6, 0
  s_sub_u32 s30, s30, s31
  s_cmp_ge_u32 s30, 6
  s_cselect_b32 s31, 6, 0
  s_sub_u32 s30, s30, s31
  s_cmp_ge_u32 s30, 3
  s_addc_u32 s30, s30, 0
  s_lshl_b32 s30, s30, 12
  s_add_u32 s30, s30, s29
  buffer_load_dwordx4 a[128:131], v3, s[8:11], s30 offen offset:0 sc1
  buffer_load_dwordx4 a[132:135], v3, s[8:11], s30 offen offset:1024 sc1
  buffer_load_dwordx4 a[136:139], v3, s[8:11], s30 offen offset:2048 sc1
  buffer_load_dwordx4 a[140:143], v3, s[8:11], s30 offen offset:3072 sc1
  s_add_u32 s30, s21, 5
  s_cmp_ge_u32 s30, 6
  s_cselect_b32 s31, 6, 0
  s_sub_u32 s30, s30, s31
  s_cmp_ge_u32 s30, 6
  s_cselect_b32 s31, 6, 0
  s_sub_u32 s30, s30, s31
  s_cmp_ge_u32 s30, 3
  s_addc_u32 s30, s30, 0
  s_lshl_b32 s30, s30, 12
  s_add_u32 s30, s30, s29
  buffer_load_dwordx4 a[144:147], v3, s[8:11], s30 offen offset:0 sc1
  buffer_load_dwordx4 a[148:151], v3, s[8:11], s30 offen offset:1024 sc1
  buffer_load_dwordx4 a[152:155], v3, s[8:11], s30 offen offset:2048 sc1
  buffer_load_dwordx4 a[156:159], v3, s[8:11], s30 offen offset:3072 sc1
  s_add_u32 s30, s29, 12288
  buffer_load_dwordx4 a[160:163], v3, s[8:11], s30 offen offset:0 sc1
  buffer_load_dwordx4 a[164:167], v3, s[8:11], s30 offen offset:1024 sc1
  buffer_load_dwordx4 a[168:171], v3, s[8:11], s30 offen offset:2048 sc1
  buffer_load_dwordx4 a[172:175], v3, s[8:11], s30 offen offset:3072 sc1
  s_mul_i32 s26, s3, 12288
  v_add_u32 v20, s26, v3
  s_xor_b32 s26, s3, 1
  s_mul_i32 s26, s26, 12288
  s_add_u32 s26, s26, 0
  v_add_u32 v21, s26, v3
  s_xor_b32 s26, s3, 2
  s_mul_i32 s26, s26, 12288
  s_add_u32 s26, s26, 4096
  v_add_u32 v22, s26, v3
  s_xor_b32 s26, s3, 3
  s_mul_i32 s26, s26, 12288
  s_add_u32 s26, s26, 8192
  v_add_u32 v23, s26, v3
  v_bfe_u32 v15, v13, 2, 1
  v_lshlrev_b32 v15, 3, v15
  v_and_b32 v16, 3, v13
  v_add_u32 v15, v15, v16
  s_lshl_b32 s26, s22, 6
  s_lshr_b32 s27, s3, 1
  s_lshl_b32 s27, s27, 5
  s_add_u32 s26, s26, s27
  s_and_b32 s27, s3, 1
  s_lshl_b32 s27, s27, 2
  s_add_u32 s26, s26, s27
  v_add_u32 v15, s26, v15
  v_mul_u32_u24 v15, 896, v15
  v_lshrrev_b32 v16, 3, v13
  v_lshl_add_u32 v16, v16, 2, v14
  v_lshlrev_b32 v16, 4, v16
  s_lshl_b32 s27, s21, 7
  v_add_u32 v16, s27, v16
  v_add_u32 v1, v15, v16
  s_mov_b32 s26, 14336
  s_mov_b32 s12, s54
  s_and_b32 s13, s55, 0xffff
  s_mov_b32 s14, 1835008
  s_mov_b32 s15, 0x20000
  s_xor_b32 s24, s3, 0
  s_lshl_b32 s24, s24, 10
  v_lshl_add_u32 v24, v12, 3, s24
  s_xor_b32 s24, s3, 1
  s_lshl_b32 s24, s24, 10
  v_lshl_add_u32 v25, v12, 3, s24
  s_xor_b32 s24, s3, 2
  s_lshl_b32 s24, s24, 10
  v_lshl_add_u32 v26, v12, 3, s24
  s_xor_b32 s24, s3, 3
  s_lshl_b32 s24, s24, 10
  v_lshl_add_u32 v27, v12, 3, s24
  s_mul_i32 s27, s22, 4352
  s_add_u32 s27, s27, 15204352
  v_lshl_add_u32 v17, v12, 3, s27
  s_cmp_lg_u32 s3, 0
  s_cbranch_scc1 mega_pb_done
  s_mov_b32 s33, 0
  s_mov_b64 s[34:35], exec
  s_mov_b64 exec, 0xff
mega_pb_loop:
  global_load_dwordx2 v[18:19], v17, s[58:59] sc1
  s_add_u32 s33, s33, 1
  s_waitcnt vmcnt(0)
  v_xor_b32 v18, s76, v18
  v_xor_b32 v19, s77, v19
  v_or_b32 v18, v18, v19
  v_cmp_eq_u32 vcc, 0, v18
  s_nop 1
  s_cmp_eq_u64 vcc, exec
  s_cbranch_scc1 mega_pb_out
  s_sleep 2
  s_cmp_lt_u32 s33, 0x20000
  s_cbranch_scc1 mega_pb_loop
mega_pb_out:
  s_mov_b64 exec, s[34:35]
mega_pb_done:
  s_barrier
  s_add_u32 s30, s21, 0
  s_cmp_ge_u32 s30, 6
  s_cselect_b32 s31, 6, 0
  s_sub_u32 s30, s30, s31
  s_cmp_ge_u32 s30, 6
  s_cselect_b32 s31, 6, 0
  s_sub_u32 s30, s30, s31
  s_cmp_ge_u32 s30, 3
  s_addc_u32 s30, s30, 0
  s_lshl_b32 s30, s30, 12
  s_add_u32 s30, s30, s29
  buffer_load_dwordx4 v[96:99], v5, s[16:19], s30 offen sc1
  buffer_load_dwordx4 v[100:103], v6, s[16:19], s30 offen sc1
  buffer_load_dwordx4 v[104:107], v7, s[16:19], s30 offen sc1
  buffer_load_dwordx4 v[108:111], v8, s[16:19], s30 offen sc1
  s_add_u32 s30, s21, 1
  s_cmp_ge_u32 s30, 6
  s_cselect_b32 s31, 6, 0
  s_sub_u32 s30, s30, s31
  s_cmp_ge_u32 s30, 6
  s_cselect_b32 s31, 6, 0
  s_sub_u32 s30, s30, s31
  s_cmp_ge_u32 s30, 3
  s_addc_u32 s30, s30, 0
  s_lshl_b32 s30, s30, 12
  s_add_u32 s30, s30, s29
  buffer_load_dwordx4 v[112:115], v5, s[16:19], s30 offen sc1
  buffer_load_dwordx4 v[116:119], v6, s[16:19], s30 offen sc1
  buffer_load_dwordx4 v[120:123], v7, s[16:19], s30 offen sc1
  buffer_load_dwordx4 v[124:127], v8, s[16:19], s30 offen sc1
  s_add_u32 s30, s21, 2
  s_cmp_ge_u32 s30, 6
  s_cselect_b32 s31, 6, 0
  s_sub_u32 s30, s30, s31
  s_cmp_ge_u32 s30, 6
  s_cselect_b32 s31, 6, 0
  s_sub_u32 s30, s30, s31
  s_cmp_ge_u32 s30, 3
  s_addc_u32 s30, s30, 0
  s_lshl_b32 s30, s30, 12
  s_add_u32 s30, s30, s29
  buffer_load_dwordx4 v[128:131], v5, s[16:19], s30 offen sc1
  buffer_load_dwordx4 v[132:135], v6, s[16:19], s30 offen sc1
  buffer_load_dwordx4 v[136:139], v7, s[16:19], s30 offen sc1
  buffer_load_dwordx4 v[140:143], v8, s[16:19], s30 offen sc1
  s_waitcnt vmcnt(8)
  v_mfma_f32_16x16x32_bf16 v[32:35], a[64:67], v[96:99], v[32:35]
  v_mfma_f32_16x16x32_bf16 v[48:51], a[68:71], v[96:99], v[48:51]
  v_mfma_f32_16x16x32_bf16 v[64:67], a[72:75], v[96:99], v[64:67]
  s_add_u32 s30, s21, 3
  s_cmp_ge_u32 s30, 6
  s_cselect_b32 s31, 6, 0
  s_sub_u32 s30, s30, s31
  s_cmp_ge_u32 s30, 6
  s_cselect_b32 s31, 6, 0
  s_sub_u32 s30, s30, s31
  s_cmp_ge_u32 s30, 3
  s_addc_u32 s30, s30, 0
  s_lshl_b32 s30, s30, 12
  s_add_u32 s30, s30, s29
  buffer_load_dwordx4 v[144:147], v5, s[16:19], s30 offen sc1
  v_mfma_f32_16x16x32_bf16 v[80:83], a[76:79], v[96:99], v[80:83]
  v_mfma_f32_16x16x32_bf16 v[36:39], a[64:67], v[100:103], v[36:39]
  v_mfma_f32_16x16x32_bf16 v[52:55], a[68:71], v[100:103], v[52:55]
  buffer_load_dwordx4 v[148:151], v6, s[16:19], s30 offen sc1
  v_mfma_f32_16x16x32_bf16 v[68:71], a[72:75], v[100:103], v[68:71]
  v_mfma_f32_16x16x32_bf16 v[84:87], a[76:79], v[100:103], v[84:87]
  v_mfma_f32_16x16x32_bf16 v[40:43], a[64:67], v[104:107], v[40:43]
  buffer_load_dwordx4 v[152:155], v7, s[16:19], s30 offen sc1
  v_mfma_f32_16x16x32_bf16 v[56:59], a[68:71], v[104:107], v[56:59]
  v_mfma_f32_16x16x32_bf16 v[72:75], a[72:75], v[104:107], v[72:75]
  v_mfma_f32_16x16x32_bf16 v[88:91], a[76:79], v[104:107], v[88:91]
  buffer_load_dwordx4 v[156:159], v8, s[16:19], s30 offen sc1
  v_mfma_f32_16x16x32_bf16 v[44:47], a[64:67], v[108:111], v[44:47]
  v_mfma_f32_16x16x32_bf16 v[60:63], a[68:71], v[108:111], v[60:63]
  v_mfma_f32_16x16x32_bf16 v[76:79], a[72:75], v[108:111], v[76:79]
  v_mfma_f32_16x16x32_bf16 v[92:95], a[76:79], v[108:111], v[92:95]
  s_waitcnt vmcnt(8)
  v_mfma_f32_16x16x32_bf16 v[32:35], a[80:83], v[112:115], v[32:35]
  v_mfma_f32_16x16x32_bf16 v[48:51], a[84:87], v[112:115], v[48:51]
  v_mfma_f32_16x16x32_bf16 v[64:67], a[88:91], v[112:115], v[64:67]
  s_add_u32 s30, s21, 4
  s_cmp_ge_u32 s30, 6
  s_cselect_b32 s31, 6, 0
  s_sub_u32 s30, s30, s31
  s_cmp_ge_u32 s30, 6
  s_cselect_b32 s31, 6, 0
  s_sub_u32 s30, s30, s31
  s_cmp_ge_u32 s30, 3
  s_addc_u32 s30, s30, 0
  s_lshl_b32 s30, s30, 12
  s_add_u32 s30, s30, s29
  buffer_load_dwordx4 v[160:163], v5, s[16:19], s30 offen sc1
  v_mfma_f32_16x16x32_bf16 v[80:83], a[92:95], v[112:115], v[80:83]
  v_mfma_f32_16x16x32_bf16 v[36:39], a[80:83], v[116:119], v[36:39]
  v_mfma_f32_16x16x32_bf16 v[52:55], a[84:87], v[116:119], v[52:55]
  buffer_load_dwordx4 v[164:167], v6, s[16:19], s30 offen sc1
  v_mfma_f32_16x16x32_bf16 v[68:71], a[88:91], v[116:119], v[68:71]
  v_mfma_f32_16x16x32_bf16 v[84:87], a[92:95], v[116:119], v[84:87]
  v_mfma_f32_16x16x32_bf16 v[40:43], a[80:83], v[120:123], v[40:43]
  buffer_load_dwordx4 v[168:171], v7, s[16:19], s30 offen sc1
  v_mfma_f32_16x16x32_bf16 v[56:59], a[84:87], v[120:123], v[56:59]
  v_mfma_f32_16x16x32_bf16 v[72:75], a[88:91], v[120:123], v[72:75]
  v_mfma_f32_16x16x32_bf16 v[88:91], a[92:95], v[120:123], v[88:91]
  buffer_load_dwordx4 v[172:175], v8, s[16:19], s30 offen sc1
  v_mfma_f32_16x16x32_bf16 v[44:47], a[80:83], v[124:127], v[44:47]
  v_mfma_f32_16x16x32_bf16 v[60:63], a[84:87], v[124:127], v[60:63]
  v_mfma_f32_16x16x32_bf16 v[76:79], a[88:91], v[124:127], v[76:79]
  v_mfma_f32_16x16x32_bf16 v[92:95], a[92:95], v[124:127], v[92:95]
  s_waitcnt vmcnt(8)
  v_mfma_f32_16x16x32_bf16 v[32:35], a[96:99], v[128:131], v[32:35]
  v_mfma_f32_16x16x32_bf16 v[48:51], a[100:103], v[128:131], v[48:51]
  v_mfma_f32_16x16x32_bf16 v[64:67], a[104:107], v[128:131], v[64:67]
  s_add_u32 s30, s21, 5
  s_cmp_ge_u32 s30, 6
  s_cselect_b32 s31, 6, 0
  s_sub_u32 s30, s30, s31
  s_cmp_ge_u32 s30, 6
  s_cselect_b32 s31, 6, 0
  s_sub_u32 s30, s30, s31
  s_cmp_ge_u32 s30, 3
  s_addc_u32 s30, s30, 0
  s_lshl_b32 s30, s30, 12
  s_add_u32 s30, s30, s29
  buffer_load_dwordx4 v[176:179], v5, s[16:19], s30 offen sc1
  v_mfma_f32_16x16x32_bf16 v[80:83], a[108:111], v[128:131], v[80:83]
  v_mfma_f32_16x16x32_bf16 v[36:39], a[96:99], v[132:135], v[36:39]
  v_mfma_f32_16x16x32_bf16 v[52:55], a[100:103], v[132:135], v[52:55]
  buffer_load_dwordx4 v[180:183], v6, s[16:19], s30 offen sc1
  v_mfma_f32_16x16x32_bf16 v[68:71], a[104:107], v[132:135], v[68:71]
  v_mfma_f32_16x16x32_bf16 v[84:87], a[108:111], v[132:135], v[84:87]
  v_mfma_f32_16x16x32_bf16 v[40:43], a[96:99], v[136:139], v[40:43]
  buffer_load_dwordx4 v[184:187], v7, s[16:19], s30 offen sc1
  v_mfma_f32_16x16x32_bf16 v[56:59], a[100:103], v[136:139], v[56:59]
  v_mfma_f32_16x16x32_bf16 v[72:75], a[104:107], v[136:139], v[72:75]
  v_mfma_f32_16x16x32_bf16 v[88:91], a[108:111], v[136:139], v[88:91]
  buffer_load_dwordx4 v[188:191], v8, s[16:19], s30 offen sc1
  v_mfma_f32_16x16x32_bf16 v[44:47], a[96:99], v[140:143], v[44:47]
  v_mfma_f32_16x16x32_bf16 v[60:63], a[100:103], v[140:143], v[60:63]
  v_mfma_f32_16x16x32_bf16 v[76:79], a[104:107], v[140:143], v[76:79]
  v_mfma_f32_16x16x32_bf16 v[92:95], a[108:111], v[140:143], v[92:95]
  s_waitcnt vmcnt(8)
  v_mfma_f32_16x16x32_bf16 v[32:35], a[112:115], v[144:147], v[32:35]
  v_mfma_f32_16x16x32_bf16 v[48:51], a[116:119], v[144:147], v[48:51]
  v_mfma_f32_16x16x32_bf16 v[64:67], a[120:123], v[144:147], v[64:67]
  s_add_u32 s30, s29, 12288
  buffer_load_dwordx2 v[192:193], v24, s[16:19], s30 offen sc1
  v_mfma_f32_16x16x32_bf16 v[80:83], a[124:127], v[144:147], v[80:83]
  v_mfma_f32_16x16x32_bf16 v[36:39], a[112:115], v[148:151], v[36:39]
  v_mfma_f32_16x16x32_bf16 v[52:55], a[116:119], v[148:151], v[52:55]
  buffer_load_dwordx2 v[194:195], v24, s[16:19], s30 offen offset:512 sc1
  v_mfma_f32_16x16x32_bf16 v[68:71], a[120:123], v[148:151], v[68:71]
  v_mfma_f32_16x16x32_bf16 v[84:87], a[124:127], v[148:151], v[84:87]
  v_mfma_f32_16x16x32_bf16 v[40:43], a[112:115], v[152:155], v[40:43]
  buffer_load_dwordx2 v[196:197], v25, s[16:19], s30 offen sc1
  v_mfma_f32_16x16x32_bf16 v[56:59], a[116:119], v[152:155], v[56:59]
  v_mfma_f32_16x16x32_bf16 v[72:75], a[120:123], v[152:155], v[72:75]
  v_mfma_f32_16x16x32_bf16 v[88:91], a[124:127], v[152:155], v[88:91]
  buffer_load_dwordx2 v[198:199], v25, s[16:19], s30 offen offset:512 sc1
  v_mfma_f32_16x16x32_bf16 v[44:47], a[112:115], v[156:159], v[44:47]
  v_mfma_f32_16x16x32_bf16 v[60:63], a[116:119], v[156:159], v[60:63]
  v_mfma_f32_16x16x32_bf16 v[76:79], a[120:123], v[156:159], v[76:79]
  buffer_load_dwordx2 v[200:201], v26, s[16:19], s30 offen sc1
  v_mfma_f32_16x16x32_bf16 v[92:95], a[124:127], v[156:159], v[92:95]
  buffer_load_dwordx2 v[202:203], v26, s[16:19], s30 offen offset:512 sc1
  buffer_load_dwordx2 v[204:205], v27, s[16:19], s30 offen sc1
  buffer_load_dwordx2 v[206:207], v27, s[16:19], s30 offen offset:512 sc1
  s_waitcnt vmcnt(12)
  v_mfma_f32_16x16x32_bf16 v[32:35], a[128:131], v[160:163], v[32:35]
  v_mfma_f32_16x16x32_bf16 v[48:51], a[132:135], v[160:163], v[48:51]
  v_mfma_f32_16x16x32_bf16 v[64:67], a[136:139], v[160:163], v[64:67]
  v_mfma_f32_16x16x32_bf16 v[80:83], a[140:143], v[160:163], v[80:83]
  v_mfma_f32_16x16x32_bf16 v[36:39], a[128:131], v[164:167], v[36:39]
  v_mfma_f32_16x16x32_bf16 v[52:55], a[132:135], v[164:167], v[52:55]
  v_mfma_f32_16x16x32_bf16 v[68:71], a[136:139], v[164:167], v[68:71]
  v_mfma_f32_16x16x32_bf16 v[84:87], a[140:143], v[164:167], v[84:87]
  v_mfma_f32_16x16x32_bf16 v[40:43], a[128:131], v[168:171], v[40:43]
  v_mfma_f32_16x16x32_bf16 v[56:59], a[132:135], v[168:171], v[56:59]
  v_mfma_f32_16x16x32_bf16 v[72:75], a[136:139], v[168:171], v[72:75]
  v_mfma_f32_16x16x32_bf16 v[88:91], a[140:143], v[168:171], v[88:91]
  v_mfma_f32_16x16x32_bf16 v[44:47], a[128:131], v[172:175], v[44:47]
  v_mfma_f32_16x16x32_bf16 v[60:63], a[132:135], v[172:175], v[60:63]
  v_mfma_f32_16x16x32_bf16 v[76:79], a[136:139], v[172:175], v[76:79]
  v_mfma_f32_16x16x32_bf16 v[92:95], a[140:143], v[172:175], v[92:95]
  s_waitcnt vmcnt(8)
  v_mfma_f32_16x16x32_bf16 v[32:35], a[144:147], v[176:179], v[32:35]
  v_mfma_f32_16x16x32_bf16 v[48:51], a[148:151], v[176:179], v[48:51]
  v_mfma_f32_16x16x32_bf16 v[64:67], a[152:155], v[176:179], v[64:67]
  v_mfma_f32_16x16x32_bf16 v[80:83], a[156:159], v[176:179], v[80:83]
  v_mfma_f32_16x16x32_bf16 v[36:39], a[144:147], v[180:183], v[36:39]
  v_mfma_f32_16x16x32_bf16 v[52:55], a[148:151], v[180:183], v[52:55]
  v_mfma_f32_16x16x32_bf16 v[68:71], a[152:155], v[180:183], v[68:71]
  v_mfma_f32_16x16x32_bf16 v[84:87], a[156:159], v[180:183], v[84:87]
  v_mfma_f32_16x16x32_bf16 v[40:43], a[144:147], v[184:187], v[40:43]
  v_mfma_f32_16x16x32_bf16 v[56:59], a[148:151], v[184:187], v[56:59]
  v_mfma_f32_16x16x32_bf16 v[72:75], a[152:155], v[184:187], v[72:75]
  v_mfma_f32_16x16x32_bf16 v[88:91], a[156:159], v[184:187], v[88:91]
  v_mfma_f32_16x16x32_bf16 v[44:47], a[144:147], v[188:191], v[44:47]
  v_mfma_f32_16x16x32_bf16 v[60:63], a[148:151], v[188:191], v[60:63]
  v_mfma_f32_16x16x32_bf16 v[76:79], a[152:155], v[188:191], v[76:79]
  v_mfma_f32_16x16x32_bf16 v[92:95], a[156:159], v[188:191], v[92:95]
  s_waitcnt vmcnt(0)
  v_mfma_f32_16x16x32_bf16 v[32:35], a[160:163], v[192:195], v[32:35]
  v_mfma_f32_16x16x32_bf16 v[48:51], a[164:167], v[192:195], v[48:51]
  v_mfma_f32_16x16x32_bf16 v[64:67], a[168:171], v[192:195], v[64:67]
  v_mfma_f32_16x16x32_bf16 v[80:83], a[172:175], v[192:195], v[80:83]
  v_mfma_f32_16x16x32_bf16 v[36:39], a[160:163], v[196:199], v[36:39]
  v_mfma_f32_16x16x32_bf16 v[52:55], a[164:167], v[196:199], v[52:55]
  v_mfma_f32_16x16x32_bf16 v[68:71], a[168:171], v[196:199], v[68:71]
  v_mfma_f32_16x16x32_bf16 v[84:87], a[172:175], v[196:199], v[84:87]
  v_mfma_f32_16x16x32_bf16 v[40:43], a[160:163], v[200:203], v[40:43]
  v_mfma_f32_16x16x32_bf16 v[56:59], a[164:167], v[200:203], v[56:59]
  v_mfma_f32_16x16x32_bf16 v[72:75], a[168:171], v[200:203], v[72:75]
  v_mfma_f32_16x16x32_bf16 v[88:91], a[172:175], v[200:203], v[88:91]
  v_mfma_f32_16x16x32_bf16 v[44:47], a[160:163], v[204:207], v[44:47]
  v_mfma_f32_16x16x32_bf16 v[60:63], a[164:167], v[204:207], v[60:63]
  v_mfma_f32_16x16x32_bf16 v[76:79], a[168:171], v[204:207], v[76:79]
  v_mfma_f32_16x16x32_bf16 v[92:95], a[172:175], v[204:207], v[92:95]
  ds_write_b128 v20, v[36:39] offset:0
  ds_write_b128 v20, v[52:55] offset:1024
  ds_write_b128 v20, v[68:71] offset:2048
  ds_write_b128 v20, v[84:87] offset:3072
  ds_write_b128 v20, v[40:43] offset:4096
  ds_write_b128 v20, v[56:59] offset:5120
  ds_write_b128 v20, v[72:75] offset:6144
  ds_write_b128 v20, v[88:91] offset:7168
  ds_write_b128 v20, v[44:47] offset:8192
  ds_write_b128 v20, v[60:63] offset:9216
  ds_write_b128 v20, v[76:79] offset:10240
  ds_write_b128 v20, v[92:95] offset:11264
  s_waitcnt lgkmcnt(0)
  s_barrier
  ds_read_b128 v[208:211], v21 offset:0
  ds_read_b128 v[212:215], v21 offset:1024
  ds_read_b128 v[216:219], v21 offset:2048
  ds_read_b128 v[220:223], v21 offset:3072
  ds_read_b128 v[224:227], v22 offset:0
  ds_read_b128 v[228:231], v22 offset:1024
  ds_read_b128 v[232:235], v22 offset:2048
  ds_read_b128 v[236:239], v22 offset:3072
  ds_read_b128 v[240:243], v23 offset:0
  ds_read_b128 v[244:247], v23 offset:1024
  ds_read_b128 v[248:251], v23 offset:2048
  ds_read_b128 v[252:255], v23 offset:3072
  s_waitcnt lgkmcnt(8)
  v_pk_add_f32 v[32:33], v[32:33], v[208:209]
  v_pk_add_f32 v[34:35], v[34:35], v[210:211]
  v_pk_add_f32 v[48:49], v[48:49], v[212:213]
  v_pk_add_f32 v[50:51], v[50:51], v[214:215]
  v_pk_add_f32 v[64:65], v[64:65], v[216:217]
  v_pk_add_f32 v[66:67], v[66:67], v[218:219]
  v_pk_add_f32 v[80:81], v[80:81], v[220:221]
  v_pk_add_f32 v[82:83], v[82:83], v[222:223]
  s_waitcnt lgkmcnt(4)
  v_pk_add_f32 v[32:33], v[32:33], v[224:225]
  v_pk_add_f32 v[34:35], v[34:35], v[226:227]
  v_pk_add_f32 v[48:49], v[48:49], v[228:229]
  v_pk_add_f32 v[50:51], v[50:51], v[230:231]
  v_pk_add_f32 v[64:65], v[64:65], v[232:233]
  v_pk_add_f32 v[66:67], v[66:67], v[234:235]
  v_pk_add_f32 v[80:81], v[80:81], v[236:237]
  v_pk_add_f32 v[82:83], v[82:83], v[238:239]
  s_waitcnt lgkmcnt(0)
  v_pk_add_f32 v[32:33], v[32:33], v[240:241]
  v_pk_add_f32 v[34:35], v[34:35], v[242:243]
  v_pk_add_f32 v[48:49], v[48:49], v[244:245]
  v_pk_add_f32 v[50:51], v[50:51], v[246:247]
  v_pk_add_f32 v[64:65], v[64:65], v[248:249]
  v_pk_add_f32 v[66:67], v[66:67], v[250:251]
  v_pk_add_f32 v[80:81], v[80:81], v[252:253]
  v_pk_add_f32 v[82:83], v[82:83], v[254:255]
  v_cvt_pk_bf16_f32 v96, v32, v33
  v_cvt_pk_bf16_f32 v97, v34, v35
  v_cvt_pk_bf16_f32 v98, v48, v49
  v_cvt_pk_bf16_f32 v99, v50, v51
  v_cvt_pk_bf16_f32 v100, v64, v65
  v_cvt_pk_bf16_f32 v101, v66, v67
  v_cvt_pk_bf16_f32 v102, v80, v81
  v_cvt_pk_bf16_f32 v103, v82, v83
  v_cmp_gt_u32 vcc, 8, v13
  v_cmp_le_u32 s[24:25], 8, v13
  v_mov_b32_dpp v104, v100 row_ror:8 row_mask:0xf bank_mask:0xf
  v_mov_b32_dpp v108, v96 row_ror:8 row_mask:0xf bank_mask:0xf
  v_mov_b32_dpp v105, v101 row_ror:8 row_mask:0xf bank_mask:0xf
  v_mov_b32_dpp v109, v97 row_ror:8 row_mask:0xf bank_mask:0xf
  v_mov_b32_dpp v106, v102 row_ror:8 row_mask:0xf bank_mask:0xf
  v_mov_b32_dpp v110, v98 row_ror:8 row_mask:0xf bank_mask:0xf
  v_mov_b32_dpp v107, v103 row_ror:8 row_mask:0xf bank_mask:0xf
  v_mov_b32_dpp v111, v99 row_ror:8 row_mask:0xf bank_mask:0xf
  v_cndmask_b32 v104, v104, v96, vcc
  v_cndmask_b32 v108, v108, v100, s[24:25]
  v_cndmask_b32 v105, v105, v97, vcc
  v_cndmask_b32 v109, v109, v101, s[24:25]
  v_cndmask_b32 v106, v106, v98, vcc
  v_cndmask_b32 v110, v110, v102, s[24:25]
  v_cndmask_b32 v107, v107, v99, vcc
  v_cndmask_b32 v111, v111, v103, s[24:25]
  buffer_store_dwordx4 v[104:107], v1, s[12:15], 0 offen sc1
  buffer_store_dwordx4 v[108:111], v1, s[12:15], s26 offen sc1
mega_fin:
mega_end:
  s_endpgm
.section .rodata,"a"
.p2align 6
.amdhsa_kernel gated_mix__sliding_local_dilated__mixer_gmlp__prompt_kernel
  .amdhsa_next_free_vgpr 512
  .amdhsa_next_free_sgpr 102
  .amdhsa_accum_offset 256
  .amdhsa_group_segment_fixed_size 0
  .amdhsa_kernarg_size 96
  .amdhsa_user_sgpr_count 2
  .amdhsa_user_sgpr_kernarg_segment_ptr 1
  .amdhsa_system_sgpr_workgroup_id_x 1
.end_amdhsa_kernel
```
